```python
import torch

def _softmax(x, axis=-1):
    return torch.softmax(x, dim=axis)

def _gelu(x):
    return torch.nn.functional.gelu(x, approximate='tanh')

def _silu(x):
    return torch.nn.functional.silu(x)

def _sigmoid(x):
    return torch.sigmoid(x)

def _layernorm(x, axis=-1, eps=1e-05):
    m = x.mean(dim=axis, keepdim=True)
    v = x.var(dim=axis, keepdim=True, unbiased=False)
    return (x - m) / torch.sqrt(v + eps)

def _scatter_add(tgt, idx, src, axis=0):
    return tgt.clone().index_add_(axis, idx, src)

def _segment_sum(src, seg, n):
    out = torch.zeros((n,) + src.shape[1:], dtype=src.dtype)
    return out.index_add_(0, seg, src)

def _pad(x, pw):
    flat = tuple((v for pair in reversed(pw) for v in pair))
    return torch.nn.functional.pad(x, flat)
kernel_name = 'parallel_sum__memory_aug_recurrent_mem_tr__dense_activation_mish__prompt'

def setup_inputs():

    _w = lambda a: (lambda t: t.to(torch.bfloat16) if t.is_floating_point() else t)(torch.as_tensor(a))

    def _A_setup():
        B, S, Dm = (1, 2048, 640)
        H, Dh = (32, 128)
        M, seg = (8, 32)
        seg = min(seg, S)
        S = S // seg * seg
        return {'x': _w((lambda *s: torch.randn(*s, dtype=torch.bfloat16) * 0.05)(B, S, Dm)), 'mem0': _w((lambda *s: torch.randn(*s, dtype=torch.bfloat16) * 0.2)(B, M, Dm)), 'Wq': _w((lambda *s: torch.randn(*s, dtype=torch.bfloat16) * 1.6)(Dm, H, Dh) * Dm ** (-0.5)), 'Wk': _w((lambda *s: torch.randn(*s, dtype=torch.bfloat16) * 1.6)(Dm, H, Dh) * Dm ** (-0.5)), 'Wv': _w((lambda *s: torch.randn(*s, dtype=torch.bfloat16) * 0.2)(Dm, H, Dh) * Dm ** (-0.5)), 'Wo': _w((lambda *s: torch.randn(*s, dtype=torch.bfloat16) * 0.2)(H, Dh, Dm) * (H * Dh) ** (-0.5)), 'seg_len': seg}
    _A_in = _A_setup()

    def _B_setup():
        B, S, D, F = (1, 2048, 640, 1728)
        return {'x': _w((lambda *s: torch.randn(*s, dtype=torch.bfloat16) * 0.05)(B, S, D)), 'w1': _w((lambda *s: torch.randn(*s, dtype=torch.bfloat16) * 0.8)(D, F) * D ** (-0.5)), 'b1': _w((lambda *s: torch.randn(*s, dtype=torch.bfloat16) * 0.2)(F)), 'w2': _w((lambda *s: torch.randn(*s, dtype=torch.bfloat16) * 0.1)(F, D) * F ** (-0.5))}
    _B_in = _B_setup()
    return {'A_x': _A_in['x'], 'A_mem0': _A_in['mem0'], 'A_Wq': _A_in['Wq'], 'A_Wk': _A_in['Wk'], 'A_Wv': _A_in['Wv'], 'A_Wo': _A_in['Wo'], 'A_seg_len': _A_in['seg_len'], 'B_x': _B_in['x'], 'B_w1': _B_in['w1'], 'B_b1': _B_in['b1'], 'B_w2': _B_in['w2']}

def reference(A_x, A_mem0, A_Wq, A_Wk, A_Wv, A_Wo, A_seg_len, B_x, B_w1, B_b1, B_w2):

    def _A_ref(x, mem0, Wq, Wk, Wv, Wo, seg_len):
        B, S, Dm = x.shape
        H, Dh = (Wq.shape[1], Wq.shape[2])
        M = mem0.shape[1]
        scale = Dh ** (-0.5)
        n_seg = S // seg_len
        L = M + seg_len
        idx = torch.arange(L)
        mask = (idx[:, None] < M) | (idx[:, None] >= idx[None, :])
        mem = mem0
        outs = []
        for s in range(n_seg):
            xs = x[:, s * seg_len:(s + 1) * seg_len, :].clone()
            h = torch.concatenate([mem, xs], axis=1)
            q = torch.einsum('btd,dhe->bhte', h, Wq)
            k = torch.einsum('btd,dhe->bhte', h, Wk)
            v = torch.einsum('btd,dhe->bhte', h, Wv)
            scores = torch.einsum('bhqe,bhke->bhqk', q, k) * scale
            scores = torch.where(mask[None, None], scores, -1000000000.0)
            p = _softmax(scores, axis=-1)
            o = torch.einsum('bhqk,bhke->bhqe', p, v)
            o = torch.einsum('bhte,hed->btd', o, Wo)
            mem = o[:, :M, :].clone()
            outs.append(o[:, M:, :])
        return torch.concatenate(outs, axis=1)

    def _B_ref(x, w1, b1, w2):
        h = torch.einsum('bsd,df->bsf', x, w1) + b1
        sp = torch.log1p(torch.exp(-torch.abs(h))) + torch.where(h > 0, h, torch.zeros_like(h))
        act = h * torch.tanh(sp)
        return torch.einsum('bsf,fd->bsd', act, w2)
    x = A_x
    xn = _layernorm(x, axis=-1)
    return x + _A_ref(xn, A_mem0, A_Wq, A_Wk, A_Wv, A_Wo, A_seg_len) + _B_ref(xn, B_w1, B_b1, B_w2)
```

```asm
; @launch grid=(256,1,1) block=(256,1,1) lds=163840
.amdgcn_target "amdgcn-amd-amdhsa--gfx950"
.text
.globl parallel_sum__memory_aug_recurrent_mem_tr__dense_activation_mish__prompt_kernel
.p2align 8
.type parallel_sum__memory_aug_recurrent_mem_tr__dense_activation_mish__prompt_kernel,@function
parallel_sum__memory_aug_recurrent_mem_tr__dense_activation_mish__prompt_kernel:
s_cmp_ge_u32 s2, 256
s_cbranch_scc1 L_exit
s_load_dwordx8 s[8:15], s[0:1], 0
s_load_dwordx4 s[16:19], s[0:1], 32
s_load_dwordx4 s[20:23], s[0:1], 64
s_load_dwordx8 s[24:31], s[0:1], 80
v_lshrrev_b32 v1, 6, v0
s_nop 0
v_readfirstlane_b32 s32, v1
s_getreg_b32 s36, hwreg(HW_REG_XCC_ID)
s_and_b32 s36, s36, 15
s_waitcnt lgkmcnt(0)
s_cmp_eq_u32 s32, 0
s_cbranch_scc0 L_tk_wait
v_lshlrev_b32 v2, 2, v0
s_lshl_b32 s37, s2, 8
v_add_u32 v2, s37, v2
v_mov_b32 v3, 0
global_store_dword v2, v3, s[30:31] sc1
s_and_b32 s37, s36, 3
s_lshr_b32 s38, s36, 2
s_lshl_b32 s38, s38, 5
s_add_u32 s37, s37, s38
s_cmp_lt_u32 s36, 8
s_cselect_b32 s37, s37, 10
s_lshl_b32 s37, s37, 2
s_waitcnt vmcnt(0)
s_mov_b64 exec, 1
v_mov_b32 v2, 1
v_mov_b32 v3, s37
global_atomic_add v4, v3, v2, s[28:29] sc0
s_waitcnt vmcnt(0)
v_readfirstlane_b32 s37, v4
s_cmp_lt_u32 s36, 8
s_cselect_b32 s38, 1, 0
s_nop 0
s_cmp_lt_u32 s37, 32
s_cselect_b32 s39, 1, 0
s_and_b32 s38, s38, s39
s_cmp_eq_u32 s38, 1
s_cbranch_scc0 L_tk_float
s_lshl_b32 s33, s36, 5
s_add_u32 s33, s33, s37
s_branch L_tk_have
L_tk_float:
s_mov_b32 s38, 0
s_mov_b64 exec, -1
v_and_b32 v6, 3, v0
v_bfe_u32 v7, v0, 2, 1
v_lshl_add_u32 v6, v7, 5, v6
v_lshlrev_b32 v6, 2, v6
v_cmp_eq_u32 vcc, 8, v0
v_mov_b32 v7, 40
s_nop 0
v_cndmask_b32 v6, v6, v7, vcc
v_cmp_lt_u32 vcc, 8, v0
v_mov_b32 v7, 44
s_nop 0
v_cndmask_b32 v6, v6, v7, vcc
L_tk_spin:
global_load_dword v7, v6, s[28:29] sc1
s_waitcnt vmcnt(0)
v_readlane_b32 s39, v7, 0
v_readlane_b32 s40, v7, 1
s_nop 2
s_add_u32 s39, s39, s40
v_readlane_b32 s40, v7, 2
s_nop 2
s_add_u32 s39, s39, s40
v_readlane_b32 s40, v7, 3
s_nop 2
s_add_u32 s39, s39, s40
v_readlane_b32 s40, v7, 4
s_nop 2
s_add_u32 s39, s39, s40
v_readlane_b32 s40, v7, 5
s_nop 2
s_add_u32 s39, s39, s40
v_readlane_b32 s40, v7, 6
s_nop 2
s_add_u32 s39, s39, s40
v_readlane_b32 s40, v7, 7
s_nop 2
s_add_u32 s39, s39, s40
v_readlane_b32 s40, v7, 8
s_nop 2
s_add_u32 s39, s39, s40
s_cmp_ge_u32 s39, 256
s_cbranch_scc1 L_tk_all
s_sleep 8
s_add_u32 s38, s38, 1
s_cmp_lt_u32 s38, 0x40000
s_cbranch_scc1 L_tk_spin
s_endpgm
L_tk_all:
s_mov_b64 exec, 1
v_mov_b32 v3, 36
global_atomic_add v4, v3, v2, s[28:29] sc0
s_waitcnt vmcnt(0)
v_readfirstlane_b32 s37, v4
s_mov_b32 s33, 0x7fffffff
v_readlane_b32 s39, v7, 0
s_nop 2
s_min_u32 s39, s39, 32
s_sub_u32 s40, 32, s39
s_cmp_lt_u32 s37, s40
s_cbranch_scc0 L_tk_x_1
s_add_u32 s33, s39, 0
s_add_u32 s33, s33, s37
s_branch L_tk_have
L_tk_x_1:
s_sub_u32 s37, s37, s40
v_readlane_b32 s39, v7, 1
s_nop 2
s_min_u32 s39, s39, 32
s_sub_u32 s40, 32, s39
s_cmp_lt_u32 s37, s40
s_cbranch_scc0 L_tk_x_2
s_add_u32 s33, s39, 32
s_add_u32 s33, s33, s37
s_branch L_tk_have
L_tk_x_2:
s_sub_u32 s37, s37, s40
v_readlane_b32 s39, v7, 2
s_nop 2
s_min_u32 s39, s39, 32
s_sub_u32 s40, 32, s39
s_cmp_lt_u32 s37, s40
s_cbranch_scc0 L_tk_x_3
s_add_u32 s33, s39, 64
s_add_u32 s33, s33, s37
s_branch L_tk_have
L_tk_x_3:
s_sub_u32 s37, s37, s40
v_readlane_b32 s39, v7, 3
s_nop 2
s_min_u32 s39, s39, 32
s_sub_u32 s40, 32, s39
s_cmp_lt_u32 s37, s40
s_cbranch_scc0 L_tk_x_4
s_add_u32 s33, s39, 96
s_add_u32 s33, s33, s37
s_branch L_tk_have
L_tk_x_4:
s_sub_u32 s37, s37, s40
v_readlane_b32 s39, v7, 4
s_nop 2
s_min_u32 s39, s39, 32
s_sub_u32 s40, 32, s39
s_cmp_lt_u32 s37, s40
s_cbranch_scc0 L_tk_x_5
s_add_u32 s33, s39, 128
s_add_u32 s33, s33, s37
s_branch L_tk_have
L_tk_x_5:
s_sub_u32 s37, s37, s40
v_readlane_b32 s39, v7, 5
s_nop 2
s_min_u32 s39, s39, 32
s_sub_u32 s40, 32, s39
s_cmp_lt_u32 s37, s40
s_cbranch_scc0 L_tk_x_6
s_add_u32 s33, s39, 160
s_add_u32 s33, s33, s37
s_branch L_tk_have
L_tk_x_6:
s_sub_u32 s37, s37, s40
v_readlane_b32 s39, v7, 6
s_nop 2
s_min_u32 s39, s39, 32
s_sub_u32 s40, 32, s39
s_cmp_lt_u32 s37, s40
s_cbranch_scc0 L_tk_x_7
s_add_u32 s33, s39, 192
s_add_u32 s33, s33, s37
s_branch L_tk_have
L_tk_x_7:
s_sub_u32 s37, s37, s40
v_readlane_b32 s39, v7, 7
s_nop 2
s_min_u32 s39, s39, 32
s_sub_u32 s40, 32, s39
s_cmp_lt_u32 s37, s40
s_cbranch_scc0 L_tk_x_8
s_add_u32 s33, s39, 224
s_add_u32 s33, s33, s37
s_branch L_tk_have
L_tk_x_8:
s_sub_u32 s37, s37, s40
L_tk_have:
v_mov_b32 v3, 0
v_mov_b32 v4, s33
ds_write_b32 v3, v4
s_waitcnt lgkmcnt(0)
s_mov_b64 exec, -1
L_tk_wait:
s_barrier
v_mov_b32 v3, 0
ds_read_b32 v4, v3
s_waitcnt lgkmcnt(0)
v_readfirstlane_b32 s33, v4
s_barrier
s_nop 1
s_cmp_ge_u32 s33, 256
s_cbranch_scc1 L_exit
s_lshr_b32 s35, s33, 5
s_and_b32 s34, s33, 31
s_cmp_eq_u32 s35, 0
s_cbranch_scc0 L_dx_9
s_mov_b32 s35, 0
s_branch L_R
L_dx_9:
s_cmp_eq_u32 s35, 1
s_cbranch_scc0 L_dx_10
s_mov_b32 s35, 1
s_branch L_R
L_dx_10:
s_cmp_eq_u32 s35, 2
s_cbranch_scc0 L_dx_11
s_branch L_K
L_dx_11:
s_cmp_eq_u32 s35, 3
s_cbranch_scc0 L_dx_12
s_branch L_Q
L_dx_12:
s_cmp_eq_u32 s35, 4
s_cbranch_scc0 L_dx_13
s_branch L_V
L_dx_13:
s_cmp_eq_u32 s35, 5
s_cbranch_scc0 L_dx_14
s_cmp_lt_u32 s34, 20
s_cbranch_scc0 L_dh_15
s_mov_b32 s35, 0
s_add_u32 s59, s34, 0
s_branch L_LN
L_dh_15:
s_sub_u32 s34, s34, 20
s_branch L_H
L_dx_14:
s_cmp_eq_u32 s35, 6
s_cbranch_scc0 L_dx_16
s_cmp_lt_u32 s34, 20
s_cbranch_scc0 L_dh_17
s_mov_b32 s35, 1
s_add_u32 s59, s34, 20
s_branch L_LN
L_dh_17:
s_cmp_lt_u32 s34, 22
s_cbranch_scc0 L_da_18
s_sub_u32 s34, s34, 8
s_branch L_H
L_da_18:
s_sub_u32 s34, s34, 22
s_branch L_A
L_dx_16:
s_cmp_eq_u32 s35, 7
s_cbranch_scc0 L_dx_19
s_cmp_lt_u32 s34, 20
s_cbranch_scc0 L_dh_20
s_mov_b32 s35, 2
s_add_u32 s59, s34, 40
s_branch L_LN
L_dh_20:
s_sub_u32 s34, s34, 10
s_cmp_lt_u32 s34, 16
s_cbranch_scc0 L_dl_21
s_branch L_A
L_dl_21:
s_add_u32 s59, s34, 44
s_cmp_lt_u32 s59, 64
s_cbranch_scc1 L_LN
s_endpgm
L_dx_19:
L_exit:
s_endpgm
L_LN:
s_mul_i32 s60, s59, 40960
s_add_u32 s62, s8, s60
s_addc_u32 s63, s9, 0
s_add_u32 s64, s30, 1048576
s_addc_u32 s65, s31, 0
s_add_u32 s64, s64, s60
s_addc_u32 s65, s65, 0
v_and_b32 v1, 31, v0
v_lshrrev_b32 v2, 5, v0
v_mul_u32_u24 v3, 1280, v1
v_lshl_add_u32 v3, v2, 4, v3
global_load_dwordx4 v[16:19], v3, s[62:63] offset:0
global_load_dwordx4 v[20:23], v3, s[62:63] offset:128
global_load_dwordx4 v[24:27], v3, s[62:63] offset:256
global_load_dwordx4 v[28:31], v3, s[62:63] offset:384
global_load_dwordx4 v[32:35], v3, s[62:63] offset:512
global_load_dwordx4 v[36:39], v3, s[62:63] offset:640
global_load_dwordx4 v[40:43], v3, s[62:63] offset:768
global_load_dwordx4 v[44:47], v3, s[62:63] offset:896
global_load_dwordx4 v[48:51], v3, s[62:63] offset:1024
global_load_dwordx4 v[52:55], v3, s[62:63] offset:1152
v_lshlrev_b32 v4, 2, v0
v_lshlrev_b32 v5, 2, v1
s_waitcnt vmcnt(0)
v_lshlrev_b32 v64, 16, v16
v_and_b32 v65, 0xffff0000, v16
v_lshlrev_b32 v66, 16, v17
v_and_b32 v67, 0xffff0000, v17
v_lshlrev_b32 v68, 16, v18
v_and_b32 v69, 0xffff0000, v18
v_lshlrev_b32 v70, 16, v19
v_and_b32 v71, 0xffff0000, v19
v_lshlrev_b32 v72, 16, v20
v_and_b32 v73, 0xffff0000, v20
v_lshlrev_b32 v74, 16, v21
v_and_b32 v75, 0xffff0000, v21
v_lshlrev_b32 v76, 16, v22
v_and_b32 v77, 0xffff0000, v22
v_lshlrev_b32 v78, 16, v23
v_and_b32 v79, 0xffff0000, v23
v_lshlrev_b32 v80, 16, v24
v_and_b32 v81, 0xffff0000, v24
v_lshlrev_b32 v82, 16, v25
v_and_b32 v83, 0xffff0000, v25
v_lshlrev_b32 v84, 16, v26
v_and_b32 v85, 0xffff0000, v26
v_lshlrev_b32 v86, 16, v27
v_and_b32 v87, 0xffff0000, v27
v_lshlrev_b32 v88, 16, v28
v_and_b32 v89, 0xffff0000, v28
v_lshlrev_b32 v90, 16, v29
v_and_b32 v91, 0xffff0000, v29
v_lshlrev_b32 v92, 16, v30
v_and_b32 v93, 0xffff0000, v30
v_lshlrev_b32 v94, 16, v31
v_and_b32 v95, 0xffff0000, v31
v_lshlrev_b32 v96, 16, v32
v_and_b32 v97, 0xffff0000, v32
v_lshlrev_b32 v98, 16, v33
v_and_b32 v99, 0xffff0000, v33
v_lshlrev_b32 v100, 16, v34
v_and_b32 v101, 0xffff0000, v34
v_lshlrev_b32 v102, 16, v35
v_and_b32 v103, 0xffff0000, v35
v_lshlrev_b32 v104, 16, v36
v_and_b32 v105, 0xffff0000, v36
v_lshlrev_b32 v106, 16, v37
v_and_b32 v107, 0xffff0000, v37
v_lshlrev_b32 v108, 16, v38
v_and_b32 v109, 0xffff0000, v38
v_lshlrev_b32 v110, 16, v39
v_and_b32 v111, 0xffff0000, v39
v_lshlrev_b32 v112, 16, v40
v_and_b32 v113, 0xffff0000, v40
v_lshlrev_b32 v114, 16, v41
v_and_b32 v115, 0xffff0000, v41
v_lshlrev_b32 v116, 16, v42
v_and_b32 v117, 0xffff0000, v42
v_lshlrev_b32 v118, 16, v43
v_and_b32 v119, 0xffff0000, v43
v_lshlrev_b32 v120, 16, v44
v_and_b32 v121, 0xffff0000, v44
v_lshlrev_b32 v122, 16, v45
v_and_b32 v123, 0xffff0000, v45
v_lshlrev_b32 v124, 16, v46
v_and_b32 v125, 0xffff0000, v46
v_lshlrev_b32 v126, 16, v47
v_and_b32 v127, 0xffff0000, v47
v_lshlrev_b32 v128, 16, v48
v_and_b32 v129, 0xffff0000, v48
v_lshlrev_b32 v130, 16, v49
v_and_b32 v131, 0xffff0000, v49
v_lshlrev_b32 v132, 16, v50
v_and_b32 v133, 0xffff0000, v50
v_lshlrev_b32 v134, 16, v51
v_and_b32 v135, 0xffff0000, v51
v_lshlrev_b32 v136, 16, v52
v_and_b32 v137, 0xffff0000, v52
v_lshlrev_b32 v138, 16, v53
v_and_b32 v139, 0xffff0000, v53
v_lshlrev_b32 v140, 16, v54
v_and_b32 v141, 0xffff0000, v54
v_lshlrev_b32 v142, 16, v55
v_and_b32 v143, 0xffff0000, v55
v_mov_b32 v6, 0
v_mov_b32 v7, 0
v_add_f32 v6, v6, v64
v_add_f32 v7, v7, v65
v_add_f32 v6, v6, v66
v_add_f32 v7, v7, v67
v_add_f32 v6, v6, v68
v_add_f32 v7, v7, v69
v_add_f32 v6, v6, v70
v_add_f32 v7, v7, v71
v_add_f32 v6, v6, v72
v_add_f32 v7, v7, v73
v_add_f32 v6, v6, v74
v_add_f32 v7, v7, v75
v_add_f32 v6, v6, v76
v_add_f32 v7, v7, v77
v_add_f32 v6, v6, v78
v_add_f32 v7, v7, v79
v_add_f32 v6, v6, v80
v_add_f32 v7, v7, v81
v_add_f32 v6, v6, v82
v_add_f32 v7, v7, v83
v_add_f32 v6, v6, v84
v_add_f32 v7, v7, v85
v_add_f32 v6, v6, v86
v_add_f32 v7, v7, v87
v_add_f32 v6, v6, v88
v_add_f32 v7, v7, v89
v_add_f32 v6, v6, v90
v_add_f32 v7, v7, v91
v_add_f32 v6, v6, v92
v_add_f32 v7, v7, v93
v_add_f32 v6, v6, v94
v_add_f32 v7, v7, v95
v_add_f32 v6, v6, v96
v_add_f32 v7, v7, v97
v_add_f32 v6, v6, v98
v_add_f32 v7, v7, v99
v_add_f32 v6, v6, v100
v_add_f32 v7, v7, v101
v_add_f32 v6, v6, v102
v_add_f32 v7, v7, v103
v_add_f32 v6, v6, v104
v_add_f32 v7, v7, v105
v_add_f32 v6, v6, v106
v_add_f32 v7, v7, v107
v_add_f32 v6, v6, v108
v_add_f32 v7, v7, v109
v_add_f32 v6, v6, v110
v_add_f32 v7, v7, v111
v_add_f32 v6, v6, v112
v_add_f32 v7, v7, v113
v_add_f32 v6, v6, v114
v_add_f32 v7, v7, v115
v_add_f32 v6, v6, v116
v_add_f32 v7, v7, v117
v_add_f32 v6, v6, v118
v_add_f32 v7, v7, v119
v_add_f32 v6, v6, v120
v_add_f32 v7, v7, v121
v_add_f32 v6, v6, v122
v_add_f32 v7, v7, v123
v_add_f32 v6, v6, v124
v_add_f32 v7, v7, v125
v_add_f32 v6, v6, v126
v_add_f32 v7, v7, v127
v_add_f32 v6, v6, v128
v_add_f32 v7, v7, v129
v_add_f32 v6, v6, v130
v_add_f32 v7, v7, v131
v_add_f32 v6, v6, v132
v_add_f32 v7, v7, v133
v_add_f32 v6, v6, v134
v_add_f32 v7, v7, v135
v_add_f32 v6, v6, v136
v_add_f32 v7, v7, v137
v_add_f32 v6, v6, v138
v_add_f32 v7, v7, v139
v_add_f32 v6, v6, v140
v_add_f32 v7, v7, v141
v_add_f32 v6, v6, v142
v_add_f32 v7, v7, v143
v_add_f32 v6, v6, v7
ds_write_b32 v4, v6 offset:0
s_waitcnt lgkmcnt(0)
s_barrier
ds_read_b32 v144, v5 offset:0
ds_read_b32 v145, v5 offset:128
ds_read_b32 v146, v5 offset:256
ds_read_b32 v147, v5 offset:384
ds_read_b32 v148, v5 offset:512
ds_read_b32 v149, v5 offset:640
ds_read_b32 v150, v5 offset:768
ds_read_b32 v151, v5 offset:896
s_waitcnt lgkmcnt(0)
v_add_f32 v144, v144, v145
v_add_f32 v146, v146, v147
v_add_f32 v148, v148, v149
v_add_f32 v150, v150, v151
v_add_f32 v144, v144, v146
v_add_f32 v148, v148, v150
v_add_f32 v144, v144, v148
v_mul_f32 v10, 0x3acccccd, v144
v_mov_b32 v6, 0
v_mov_b32 v7, 0
v_sub_f32 v8, v64, v10
v_fmac_f32 v6, v8, v8
v_sub_f32 v8, v65, v10
v_fmac_f32 v7, v8, v8
v_sub_f32 v8, v66, v10
v_fmac_f32 v6, v8, v8
v_sub_f32 v8, v67, v10
v_fmac_f32 v7, v8, v8
v_sub_f32 v8, v68, v10
v_fmac_f32 v6, v8, v8
v_sub_f32 v8, v69, v10
v_fmac_f32 v7, v8, v8
v_sub_f32 v8, v70, v10
v_fmac_f32 v6, v8, v8
v_sub_f32 v8, v71, v10
v_fmac_f32 v7, v8, v8
v_sub_f32 v8, v72, v10
v_fmac_f32 v6, v8, v8
v_sub_f32 v8, v73, v10
v_fmac_f32 v7, v8, v8
v_sub_f32 v8, v74, v10
v_fmac_f32 v6, v8, v8
v_sub_f32 v8, v75, v10
v_fmac_f32 v7, v8, v8
v_sub_f32 v8, v76, v10
v_fmac_f32 v6, v8, v8
v_sub_f32 v8, v77, v10
v_fmac_f32 v7, v8, v8
v_sub_f32 v8, v78, v10
v_fmac_f32 v6, v8, v8
v_sub_f32 v8, v79, v10
v_fmac_f32 v7, v8, v8
v_sub_f32 v8, v80, v10
v_fmac_f32 v6, v8, v8
v_sub_f32 v8, v81, v10
v_fmac_f32 v7, v8, v8
v_sub_f32 v8, v82, v10
v_fmac_f32 v6, v8, v8
v_sub_f32 v8, v83, v10
v_fmac_f32 v7, v8, v8
v_sub_f32 v8, v84, v10
v_fmac_f32 v6, v8, v8
v_sub_f32 v8, v85, v10
v_fmac_f32 v7, v8, v8
v_sub_f32 v8, v86, v10
v_fmac_f32 v6, v8, v8
v_sub_f32 v8, v87, v10
v_fmac_f32 v7, v8, v8
v_sub_f32 v8, v88, v10
v_fmac_f32 v6, v8, v8
v_sub_f32 v8, v89, v10
v_fmac_f32 v7, v8, v8
v_sub_f32 v8, v90, v10
v_fmac_f32 v6, v8, v8
v_sub_f32 v8, v91, v10
v_fmac_f32 v7, v8, v8
v_sub_f32 v8, v92, v10
v_fmac_f32 v6, v8, v8
v_sub_f32 v8, v93, v10
v_fmac_f32 v7, v8, v8
v_sub_f32 v8, v94, v10
v_fmac_f32 v6, v8, v8
v_sub_f32 v8, v95, v10
v_fmac_f32 v7, v8, v8
v_sub_f32 v8, v96, v10
v_fmac_f32 v6, v8, v8
v_sub_f32 v8, v97, v10
v_fmac_f32 v7, v8, v8
v_sub_f32 v8, v98, v10
v_fmac_f32 v6, v8, v8
v_sub_f32 v8, v99, v10
v_fmac_f32 v7, v8, v8
v_sub_f32 v8, v100, v10
v_fmac_f32 v6, v8, v8
v_sub_f32 v8, v101, v10
v_fmac_f32 v7, v8, v8
v_sub_f32 v8, v102, v10
v_fmac_f32 v6, v8, v8
v_sub_f32 v8, v103, v10
v_fmac_f32 v7, v8, v8
v_sub_f32 v8, v104, v10
v_fmac_f32 v6, v8, v8
v_sub_f32 v8, v105, v10
v_fmac_f32 v7, v8, v8
v_sub_f32 v8, v106, v10
v_fmac_f32 v6, v8, v8
v_sub_f32 v8, v107, v10
v_fmac_f32 v7, v8, v8
v_sub_f32 v8, v108, v10
v_fmac_f32 v6, v8, v8
v_sub_f32 v8, v109, v10
v_fmac_f32 v7, v8, v8
v_sub_f32 v8, v110, v10
v_fmac_f32 v6, v8, v8
v_sub_f32 v8, v111, v10
v_fmac_f32 v7, v8, v8
v_sub_f32 v8, v112, v10
v_fmac_f32 v6, v8, v8
v_sub_f32 v8, v113, v10
v_fmac_f32 v7, v8, v8
v_sub_f32 v8, v114, v10
v_fmac_f32 v6, v8, v8
v_sub_f32 v8, v115, v10
v_fmac_f32 v7, v8, v8
v_sub_f32 v8, v116, v10
v_fmac_f32 v6, v8, v8
v_sub_f32 v8, v117, v10
v_fmac_f32 v7, v8, v8
v_sub_f32 v8, v118, v10
v_fmac_f32 v6, v8, v8
v_sub_f32 v8, v119, v10
v_fmac_f32 v7, v8, v8
v_sub_f32 v8, v120, v10
v_fmac_f32 v6, v8, v8
v_sub_f32 v8, v121, v10
v_fmac_f32 v7, v8, v8
v_sub_f32 v8, v122, v10
v_fmac_f32 v6, v8, v8
v_sub_f32 v8, v123, v10
v_fmac_f32 v7, v8, v8
v_sub_f32 v8, v124, v10
v_fmac_f32 v6, v8, v8
v_sub_f32 v8, v125, v10
v_fmac_f32 v7, v8, v8
v_sub_f32 v8, v126, v10
v_fmac_f32 v6, v8, v8
v_sub_f32 v8, v127, v10
v_fmac_f32 v7, v8, v8
v_sub_f32 v8, v128, v10
v_fmac_f32 v6, v8, v8
v_sub_f32 v8, v129, v10
v_fmac_f32 v7, v8, v8
v_sub_f32 v8, v130, v10
v_fmac_f32 v6, v8, v8
v_sub_f32 v8, v131, v10
v_fmac_f32 v7, v8, v8
v_sub_f32 v8, v132, v10
v_fmac_f32 v6, v8, v8
v_sub_f32 v8, v133, v10
v_fmac_f32 v7, v8, v8
v_sub_f32 v8, v134, v10
v_fmac_f32 v6, v8, v8
v_sub_f32 v8, v135, v10
v_fmac_f32 v7, v8, v8
v_sub_f32 v8, v136, v10
v_fmac_f32 v6, v8, v8
v_sub_f32 v8, v137, v10
v_fmac_f32 v7, v8, v8
v_sub_f32 v8, v138, v10
v_fmac_f32 v6, v8, v8
v_sub_f32 v8, v139, v10
v_fmac_f32 v7, v8, v8
v_sub_f32 v8, v140, v10
v_fmac_f32 v6, v8, v8
v_sub_f32 v8, v141, v10
v_fmac_f32 v7, v8, v8
v_sub_f32 v8, v142, v10
v_fmac_f32 v6, v8, v8
v_sub_f32 v8, v143, v10
v_fmac_f32 v7, v8, v8
v_add_f32 v6, v6, v7
ds_write_b32 v4, v6 offset:1024
s_waitcnt lgkmcnt(0)
s_barrier
ds_read_b32 v144, v5 offset:1024
ds_read_b32 v145, v5 offset:1152
ds_read_b32 v146, v5 offset:1280
ds_read_b32 v147, v5 offset:1408
ds_read_b32 v148, v5 offset:1536
ds_read_b32 v149, v5 offset:1664
ds_read_b32 v150, v5 offset:1792
ds_read_b32 v151, v5 offset:1920
s_waitcnt lgkmcnt(0)
v_add_f32 v144, v144, v145
v_add_f32 v146, v146, v147
v_add_f32 v148, v148, v149
v_add_f32 v150, v150, v151
v_add_f32 v144, v144, v146
v_add_f32 v148, v148, v150
v_add_f32 v144, v144, v148
v_mul_f32 v11, 0x3acccccd, v144
v_cvt_pk_bf16_f32 v12, v10, v11
v_lshlrev_b32 v10, 16, v12
v_and_b32 v11, 0xffff0000, v12
v_add_f32 v11, 0x3727c5ac, v11
v_cvt_pk_bf16_f32 v12, v11, v11
v_and_b32 v11, 0xffff0000, v12
v_sqrt_f32 v11, v11
s_nop 0
v_cvt_pk_bf16_f32 v12, v11, v11
v_and_b32 v11, 0xffff0000, v12
v_rcp_f32 v13, v11
v_lshlrev_b32 v14, 4, v0
v_sub_f32 v64, v64, v10
v_sub_f32 v65, v65, v10
v_cvt_pk_bf16_f32 v8, v64, v65
v_lshlrev_b32 v64, 16, v8
v_and_b32 v65, 0xffff0000, v8
v_mul_f32 v8, v64, v13
v_mul_f32 v9, v65, v13
v_fma_f32 v64, -v8, v11, v64
v_fma_f32 v65, -v9, v11, v65
v_fma_f32 v8, v64, v13, v8
v_fma_f32 v9, v65, v13, v9
v_cvt_pk_bf16_f32 v16, v8, v9
v_sub_f32 v66, v66, v10
v_sub_f32 v67, v67, v10
v_cvt_pk_bf16_f32 v8, v66, v67
v_lshlrev_b32 v66, 16, v8
v_and_b32 v67, 0xffff0000, v8
v_mul_f32 v8, v66, v13
v_mul_f32 v9, v67, v13
v_fma_f32 v66, -v8, v11, v66
v_fma_f32 v67, -v9, v11, v67
v_fma_f32 v8, v66, v13, v8
v_fma_f32 v9, v67, v13, v9
v_cvt_pk_bf16_f32 v17, v8, v9
v_sub_f32 v68, v68, v10
v_sub_f32 v69, v69, v10
v_cvt_pk_bf16_f32 v8, v68, v69
v_lshlrev_b32 v68, 16, v8
v_and_b32 v69, 0xffff0000, v8
v_mul_f32 v8, v68, v13
v_mul_f32 v9, v69, v13
v_fma_f32 v68, -v8, v11, v68
v_fma_f32 v69, -v9, v11, v69
v_fma_f32 v8, v68, v13, v8
v_fma_f32 v9, v69, v13, v9
v_cvt_pk_bf16_f32 v18, v8, v9
v_sub_f32 v70, v70, v10
v_sub_f32 v71, v71, v10
v_cvt_pk_bf16_f32 v8, v70, v71
v_lshlrev_b32 v70, 16, v8
v_and_b32 v71, 0xffff0000, v8
v_mul_f32 v8, v70, v13
v_mul_f32 v9, v71, v13
v_fma_f32 v70, -v8, v11, v70
v_fma_f32 v71, -v9, v11, v71
v_fma_f32 v8, v70, v13, v8
v_fma_f32 v9, v71, v13, v9
v_cvt_pk_bf16_f32 v19, v8, v9
global_store_dwordx4 v14, v[16:19], s[64:65] sc1
v_add_u32 v14, 4096, v14
v_sub_f32 v72, v72, v10
v_sub_f32 v73, v73, v10
v_cvt_pk_bf16_f32 v8, v72, v73
v_lshlrev_b32 v72, 16, v8
v_and_b32 v73, 0xffff0000, v8
v_mul_f32 v8, v72, v13
v_mul_f32 v9, v73, v13
v_fma_f32 v72, -v8, v11, v72
v_fma_f32 v73, -v9, v11, v73
v_fma_f32 v8, v72, v13, v8
v_fma_f32 v9, v73, v13, v9
v_cvt_pk_bf16_f32 v20, v8, v9
v_sub_f32 v74, v74, v10
v_sub_f32 v75, v75, v10
v_cvt_pk_bf16_f32 v8, v74, v75
v_lshlrev_b32 v74, 16, v8
v_and_b32 v75, 0xffff0000, v8
v_mul_f32 v8, v74, v13
v_mul_f32 v9, v75, v13
v_fma_f32 v74, -v8, v11, v74
v_fma_f32 v75, -v9, v11, v75
v_fma_f32 v8, v74, v13, v8
v_fma_f32 v9, v75, v13, v9
v_cvt_pk_bf16_f32 v21, v8, v9
v_sub_f32 v76, v76, v10
v_sub_f32 v77, v77, v10
v_cvt_pk_bf16_f32 v8, v76, v77
v_lshlrev_b32 v76, 16, v8
v_and_b32 v77, 0xffff0000, v8
v_mul_f32 v8, v76, v13
v_mul_f32 v9, v77, v13
v_fma_f32 v76, -v8, v11, v76
v_fma_f32 v77, -v9, v11, v77
v_fma_f32 v8, v76, v13, v8
v_fma_f32 v9, v77, v13, v9
v_cvt_pk_bf16_f32 v22, v8, v9
v_sub_f32 v78, v78, v10
v_sub_f32 v79, v79, v10
v_cvt_pk_bf16_f32 v8, v78, v79
v_lshlrev_b32 v78, 16, v8
v_and_b32 v79, 0xffff0000, v8
v_mul_f32 v8, v78, v13
v_mul_f32 v9, v79, v13
v_fma_f32 v78, -v8, v11, v78
v_fma_f32 v79, -v9, v11, v79
v_fma_f32 v8, v78, v13, v8
v_fma_f32 v9, v79, v13, v9
v_cvt_pk_bf16_f32 v23, v8, v9
global_store_dwordx4 v14, v[20:23], s[64:65] sc1
v_add_u32 v14, 4096, v14
v_sub_f32 v80, v80, v10
v_sub_f32 v81, v81, v10
v_cvt_pk_bf16_f32 v8, v80, v81
v_lshlrev_b32 v80, 16, v8
v_and_b32 v81, 0xffff0000, v8
v_mul_f32 v8, v80, v13
v_mul_f32 v9, v81, v13
v_fma_f32 v80, -v8, v11, v80
v_fma_f32 v81, -v9, v11, v81
v_fma_f32 v8, v80, v13, v8
v_fma_f32 v9, v81, v13, v9
v_cvt_pk_bf16_f32 v24, v8, v9
v_sub_f32 v82, v82, v10
v_sub_f32 v83, v83, v10
v_cvt_pk_bf16_f32 v8, v82, v83
v_lshlrev_b32 v82, 16, v8
v_and_b32 v83, 0xffff0000, v8
v_mul_f32 v8, v82, v13
v_mul_f32 v9, v83, v13
v_fma_f32 v82, -v8, v11, v82
v_fma_f32 v83, -v9, v11, v83
v_fma_f32 v8, v82, v13, v8
v_fma_f32 v9, v83, v13, v9
v_cvt_pk_bf16_f32 v25, v8, v9
v_sub_f32 v84, v84, v10
v_sub_f32 v85, v85, v10
v_cvt_pk_bf16_f32 v8, v84, v85
v_lshlrev_b32 v84, 16, v8
v_and_b32 v85, 0xffff0000, v8
v_mul_f32 v8, v84, v13
v_mul_f32 v9, v85, v13
v_fma_f32 v84, -v8, v11, v84
v_fma_f32 v85, -v9, v11, v85
v_fma_f32 v8, v84, v13, v8
v_fma_f32 v9, v85, v13, v9
v_cvt_pk_bf16_f32 v26, v8, v9
v_sub_f32 v86, v86, v10
v_sub_f32 v87, v87, v10
v_cvt_pk_bf16_f32 v8, v86, v87
v_lshlrev_b32 v86, 16, v8
v_and_b32 v87, 0xffff0000, v8
v_mul_f32 v8, v86, v13
v_mul_f32 v9, v87, v13
v_fma_f32 v86, -v8, v11, v86
v_fma_f32 v87, -v9, v11, v87
v_fma_f32 v8, v86, v13, v8
v_fma_f32 v9, v87, v13, v9
v_cvt_pk_bf16_f32 v27, v8, v9
global_store_dwordx4 v14, v[24:27], s[64:65] sc1
v_add_u32 v14, 4096, v14
v_sub_f32 v88, v88, v10
v_sub_f32 v89, v89, v10
v_cvt_pk_bf16_f32 v8, v88, v89
v_lshlrev_b32 v88, 16, v8
v_and_b32 v89, 0xffff0000, v8
v_mul_f32 v8, v88, v13
v_mul_f32 v9, v89, v13
v_fma_f32 v88, -v8, v11, v88
v_fma_f32 v89, -v9, v11, v89
v_fma_f32 v8, v88, v13, v8
v_fma_f32 v9, v89, v13, v9
v_cvt_pk_bf16_f32 v28, v8, v9
v_sub_f32 v90, v90, v10
v_sub_f32 v91, v91, v10
v_cvt_pk_bf16_f32 v8, v90, v91
v_lshlrev_b32 v90, 16, v8
v_and_b32 v91, 0xffff0000, v8
v_mul_f32 v8, v90, v13
v_mul_f32 v9, v91, v13
v_fma_f32 v90, -v8, v11, v90
v_fma_f32 v91, -v9, v11, v91
v_fma_f32 v8, v90, v13, v8
v_fma_f32 v9, v91, v13, v9
v_cvt_pk_bf16_f32 v29, v8, v9
v_sub_f32 v92, v92, v10
v_sub_f32 v93, v93, v10
v_cvt_pk_bf16_f32 v8, v92, v93
v_lshlrev_b32 v92, 16, v8
v_and_b32 v93, 0xffff0000, v8
v_mul_f32 v8, v92, v13
v_mul_f32 v9, v93, v13
v_fma_f32 v92, -v8, v11, v92
v_fma_f32 v93, -v9, v11, v93
v_fma_f32 v8, v92, v13, v8
v_fma_f32 v9, v93, v13, v9
v_cvt_pk_bf16_f32 v30, v8, v9
v_sub_f32 v94, v94, v10
v_sub_f32 v95, v95, v10
v_cvt_pk_bf16_f32 v8, v94, v95
v_lshlrev_b32 v94, 16, v8
v_and_b32 v95, 0xffff0000, v8
v_mul_f32 v8, v94, v13
v_mul_f32 v9, v95, v13
v_fma_f32 v94, -v8, v11, v94
v_fma_f32 v95, -v9, v11, v95
v_fma_f32 v8, v94, v13, v8
v_fma_f32 v9, v95, v13, v9
v_cvt_pk_bf16_f32 v31, v8, v9
global_store_dwordx4 v14, v[28:31], s[64:65] sc1
v_add_u32 v14, 4096, v14
v_sub_f32 v96, v96, v10
v_sub_f32 v97, v97, v10
v_cvt_pk_bf16_f32 v8, v96, v97
v_lshlrev_b32 v96, 16, v8
v_and_b32 v97, 0xffff0000, v8
v_mul_f32 v8, v96, v13
v_mul_f32 v9, v97, v13
v_fma_f32 v96, -v8, v11, v96
v_fma_f32 v97, -v9, v11, v97
v_fma_f32 v8, v96, v13, v8
v_fma_f32 v9, v97, v13, v9
v_cvt_pk_bf16_f32 v32, v8, v9
v_sub_f32 v98, v98, v10
v_sub_f32 v99, v99, v10
v_cvt_pk_bf16_f32 v8, v98, v99
v_lshlrev_b32 v98, 16, v8
v_and_b32 v99, 0xffff0000, v8
v_mul_f32 v8, v98, v13
v_mul_f32 v9, v99, v13
v_fma_f32 v98, -v8, v11, v98
v_fma_f32 v99, -v9, v11, v99
v_fma_f32 v8, v98, v13, v8
v_fma_f32 v9, v99, v13, v9
v_cvt_pk_bf16_f32 v33, v8, v9
v_sub_f32 v100, v100, v10
v_sub_f32 v101, v101, v10
v_cvt_pk_bf16_f32 v8, v100, v101
v_lshlrev_b32 v100, 16, v8
v_and_b32 v101, 0xffff0000, v8
v_mul_f32 v8, v100, v13
v_mul_f32 v9, v101, v13
v_fma_f32 v100, -v8, v11, v100
v_fma_f32 v101, -v9, v11, v101
v_fma_f32 v8, v100, v13, v8
v_fma_f32 v9, v101, v13, v9
v_cvt_pk_bf16_f32 v34, v8, v9
v_sub_f32 v102, v102, v10
v_sub_f32 v103, v103, v10
v_cvt_pk_bf16_f32 v8, v102, v103
v_lshlrev_b32 v102, 16, v8
v_and_b32 v103, 0xffff0000, v8
v_mul_f32 v8, v102, v13
v_mul_f32 v9, v103, v13
v_fma_f32 v102, -v8, v11, v102
v_fma_f32 v103, -v9, v11, v103
v_fma_f32 v8, v102, v13, v8
v_fma_f32 v9, v103, v13, v9
v_cvt_pk_bf16_f32 v35, v8, v9
global_store_dwordx4 v14, v[32:35], s[64:65] sc1
v_add_u32 v14, 4096, v14
v_sub_f32 v104, v104, v10
v_sub_f32 v105, v105, v10
v_cvt_pk_bf16_f32 v8, v104, v105
v_lshlrev_b32 v104, 16, v8
v_and_b32 v105, 0xffff0000, v8
v_mul_f32 v8, v104, v13
v_mul_f32 v9, v105, v13
v_fma_f32 v104, -v8, v11, v104
v_fma_f32 v105, -v9, v11, v105
v_fma_f32 v8, v104, v13, v8
v_fma_f32 v9, v105, v13, v9
v_cvt_pk_bf16_f32 v36, v8, v9
v_sub_f32 v106, v106, v10
v_sub_f32 v107, v107, v10
v_cvt_pk_bf16_f32 v8, v106, v107
v_lshlrev_b32 v106, 16, v8
v_and_b32 v107, 0xffff0000, v8
v_mul_f32 v8, v106, v13
v_mul_f32 v9, v107, v13
v_fma_f32 v106, -v8, v11, v106
v_fma_f32 v107, -v9, v11, v107
v_fma_f32 v8, v106, v13, v8
v_fma_f32 v9, v107, v13, v9
v_cvt_pk_bf16_f32 v37, v8, v9
v_sub_f32 v108, v108, v10
v_sub_f32 v109, v109, v10
v_cvt_pk_bf16_f32 v8, v108, v109
v_lshlrev_b32 v108, 16, v8
v_and_b32 v109, 0xffff0000, v8
v_mul_f32 v8, v108, v13
v_mul_f32 v9, v109, v13
v_fma_f32 v108, -v8, v11, v108
v_fma_f32 v109, -v9, v11, v109
v_fma_f32 v8, v108, v13, v8
v_fma_f32 v9, v109, v13, v9
v_cvt_pk_bf16_f32 v38, v8, v9
v_sub_f32 v110, v110, v10
v_sub_f32 v111, v111, v10
v_cvt_pk_bf16_f32 v8, v110, v111
v_lshlrev_b32 v110, 16, v8
v_and_b32 v111, 0xffff0000, v8
v_mul_f32 v8, v110, v13
v_mul_f32 v9, v111, v13
v_fma_f32 v110, -v8, v11, v110
v_fma_f32 v111, -v9, v11, v111
v_fma_f32 v8, v110, v13, v8
v_fma_f32 v9, v111, v13, v9
v_cvt_pk_bf16_f32 v39, v8, v9
global_store_dwordx4 v14, v[36:39], s[64:65] sc1
v_add_u32 v14, 4096, v14
v_sub_f32 v112, v112, v10
v_sub_f32 v113, v113, v10
v_cvt_pk_bf16_f32 v8, v112, v113
v_lshlrev_b32 v112, 16, v8
v_and_b32 v113, 0xffff0000, v8
v_mul_f32 v8, v112, v13
v_mul_f32 v9, v113, v13
v_fma_f32 v112, -v8, v11, v112
v_fma_f32 v113, -v9, v11, v113
v_fma_f32 v8, v112, v13, v8
v_fma_f32 v9, v113, v13, v9
v_cvt_pk_bf16_f32 v40, v8, v9
v_sub_f32 v114, v114, v10
v_sub_f32 v115, v115, v10
v_cvt_pk_bf16_f32 v8, v114, v115
v_lshlrev_b32 v114, 16, v8
v_and_b32 v115, 0xffff0000, v8
v_mul_f32 v8, v114, v13
v_mul_f32 v9, v115, v13
v_fma_f32 v114, -v8, v11, v114
v_fma_f32 v115, -v9, v11, v115
v_fma_f32 v8, v114, v13, v8
v_fma_f32 v9, v115, v13, v9
v_cvt_pk_bf16_f32 v41, v8, v9
v_sub_f32 v116, v116, v10
v_sub_f32 v117, v117, v10
v_cvt_pk_bf16_f32 v8, v116, v117
v_lshlrev_b32 v116, 16, v8
v_and_b32 v117, 0xffff0000, v8
v_mul_f32 v8, v116, v13
v_mul_f32 v9, v117, v13
v_fma_f32 v116, -v8, v11, v116
v_fma_f32 v117, -v9, v11, v117
v_fma_f32 v8, v116, v13, v8
v_fma_f32 v9, v117, v13, v9
v_cvt_pk_bf16_f32 v42, v8, v9
v_sub_f32 v118, v118, v10
v_sub_f32 v119, v119, v10
v_cvt_pk_bf16_f32 v8, v118, v119
v_lshlrev_b32 v118, 16, v8
v_and_b32 v119, 0xffff0000, v8
v_mul_f32 v8, v118, v13
v_mul_f32 v9, v119, v13
v_fma_f32 v118, -v8, v11, v118
v_fma_f32 v119, -v9, v11, v119
v_fma_f32 v8, v118, v13, v8
v_fma_f32 v9, v119, v13, v9
v_cvt_pk_bf16_f32 v43, v8, v9
global_store_dwordx4 v14, v[40:43], s[64:65] sc1
v_add_u32 v14, 4096, v14
v_sub_f32 v120, v120, v10
v_sub_f32 v121, v121, v10
v_cvt_pk_bf16_f32 v8, v120, v121
v_lshlrev_b32 v120, 16, v8
v_and_b32 v121, 0xffff0000, v8
v_mul_f32 v8, v120, v13
v_mul_f32 v9, v121, v13
v_fma_f32 v120, -v8, v11, v120
v_fma_f32 v121, -v9, v11, v121
v_fma_f32 v8, v120, v13, v8
v_fma_f32 v9, v121, v13, v9
v_cvt_pk_bf16_f32 v44, v8, v9
v_sub_f32 v122, v122, v10
v_sub_f32 v123, v123, v10
v_cvt_pk_bf16_f32 v8, v122, v123
v_lshlrev_b32 v122, 16, v8
v_and_b32 v123, 0xffff0000, v8
v_mul_f32 v8, v122, v13
v_mul_f32 v9, v123, v13
v_fma_f32 v122, -v8, v11, v122
v_fma_f32 v123, -v9, v11, v123
v_fma_f32 v8, v122, v13, v8
v_fma_f32 v9, v123, v13, v9
v_cvt_pk_bf16_f32 v45, v8, v9
v_sub_f32 v124, v124, v10
v_sub_f32 v125, v125, v10
v_cvt_pk_bf16_f32 v8, v124, v125
v_lshlrev_b32 v124, 16, v8
v_and_b32 v125, 0xffff0000, v8
v_mul_f32 v8, v124, v13
v_mul_f32 v9, v125, v13
v_fma_f32 v124, -v8, v11, v124
v_fma_f32 v125, -v9, v11, v125
v_fma_f32 v8, v124, v13, v8
v_fma_f32 v9, v125, v13, v9
v_cvt_pk_bf16_f32 v46, v8, v9
v_sub_f32 v126, v126, v10
v_sub_f32 v127, v127, v10
v_cvt_pk_bf16_f32 v8, v126, v127
v_lshlrev_b32 v126, 16, v8
v_and_b32 v127, 0xffff0000, v8
v_mul_f32 v8, v126, v13
v_mul_f32 v9, v127, v13
v_fma_f32 v126, -v8, v11, v126
v_fma_f32 v127, -v9, v11, v127
v_fma_f32 v8, v126, v13, v8
v_fma_f32 v9, v127, v13, v9
v_cvt_pk_bf16_f32 v47, v8, v9
global_store_dwordx4 v14, v[44:47], s[64:65] sc1
v_add_u32 v14, 4096, v14
v_sub_f32 v128, v128, v10
v_sub_f32 v129, v129, v10
v_cvt_pk_bf16_f32 v8, v128, v129
v_lshlrev_b32 v128, 16, v8
v_and_b32 v129, 0xffff0000, v8
v_mul_f32 v8, v128, v13
v_mul_f32 v9, v129, v13
v_fma_f32 v128, -v8, v11, v128
v_fma_f32 v129, -v9, v11, v129
v_fma_f32 v8, v128, v13, v8
v_fma_f32 v9, v129, v13, v9
v_cvt_pk_bf16_f32 v48, v8, v9
v_sub_f32 v130, v130, v10
v_sub_f32 v131, v131, v10
v_cvt_pk_bf16_f32 v8, v130, v131
v_lshlrev_b32 v130, 16, v8
v_and_b32 v131, 0xffff0000, v8
v_mul_f32 v8, v130, v13
v_mul_f32 v9, v131, v13
v_fma_f32 v130, -v8, v11, v130
v_fma_f32 v131, -v9, v11, v131
v_fma_f32 v8, v130, v13, v8
v_fma_f32 v9, v131, v13, v9
v_cvt_pk_bf16_f32 v49, v8, v9
v_sub_f32 v132, v132, v10
v_sub_f32 v133, v133, v10
v_cvt_pk_bf16_f32 v8, v132, v133
v_lshlrev_b32 v132, 16, v8
v_and_b32 v133, 0xffff0000, v8
v_mul_f32 v8, v132, v13
v_mul_f32 v9, v133, v13
v_fma_f32 v132, -v8, v11, v132
v_fma_f32 v133, -v9, v11, v133
v_fma_f32 v8, v132, v13, v8
v_fma_f32 v9, v133, v13, v9
v_cvt_pk_bf16_f32 v50, v8, v9
v_sub_f32 v134, v134, v10
v_sub_f32 v135, v135, v10
v_cvt_pk_bf16_f32 v8, v134, v135
v_lshlrev_b32 v134, 16, v8
v_and_b32 v135, 0xffff0000, v8
v_mul_f32 v8, v134, v13
v_mul_f32 v9, v135, v13
v_fma_f32 v134, -v8, v11, v134
v_fma_f32 v135, -v9, v11, v135
v_fma_f32 v8, v134, v13, v8
v_fma_f32 v9, v135, v13, v9
v_cvt_pk_bf16_f32 v51, v8, v9
global_store_dwordx4 v14, v[48:51], s[64:65] sc1
v_add_u32 v14, 4096, v14
v_sub_f32 v136, v136, v10
v_sub_f32 v137, v137, v10
v_cvt_pk_bf16_f32 v8, v136, v137
v_lshlrev_b32 v136, 16, v8
v_and_b32 v137, 0xffff0000, v8
v_mul_f32 v8, v136, v13
v_mul_f32 v9, v137, v13
v_fma_f32 v136, -v8, v11, v136
v_fma_f32 v137, -v9, v11, v137
v_fma_f32 v8, v136, v13, v8
v_fma_f32 v9, v137, v13, v9
v_cvt_pk_bf16_f32 v52, v8, v9
v_sub_f32 v138, v138, v10
v_sub_f32 v139, v139, v10
v_cvt_pk_bf16_f32 v8, v138, v139
v_lshlrev_b32 v138, 16, v8
v_and_b32 v139, 0xffff0000, v8
v_mul_f32 v8, v138, v13
v_mul_f32 v9, v139, v13
v_fma_f32 v138, -v8, v11, v138
v_fma_f32 v139, -v9, v11, v139
v_fma_f32 v8, v138, v13, v8
v_fma_f32 v9, v139, v13, v9
v_cvt_pk_bf16_f32 v53, v8, v9
v_sub_f32 v140, v140, v10
v_sub_f32 v141, v141, v10
v_cvt_pk_bf16_f32 v8, v140, v141
v_lshlrev_b32 v140, 16, v8
v_and_b32 v141, 0xffff0000, v8
v_mul_f32 v8, v140, v13
v_mul_f32 v9, v141, v13
v_fma_f32 v140, -v8, v11, v140
v_fma_f32 v141, -v9, v11, v141
v_fma_f32 v8, v140, v13, v8
v_fma_f32 v9, v141, v13, v9
v_cvt_pk_bf16_f32 v54, v8, v9
v_sub_f32 v142, v142, v10
v_sub_f32 v143, v143, v10
v_cvt_pk_bf16_f32 v8, v142, v143
v_lshlrev_b32 v142, 16, v8
v_and_b32 v143, 0xffff0000, v8
v_mul_f32 v8, v142, v13
v_mul_f32 v9, v143, v13
v_fma_f32 v142, -v8, v11, v142
v_fma_f32 v143, -v9, v11, v143
v_fma_f32 v8, v142, v13, v8
v_fma_f32 v9, v143, v13, v9
v_cvt_pk_bf16_f32 v55, v8, v9
global_store_dwordx4 v14, v[52:55], s[64:65] sc1
v_add_u32 v14, 4096, v14
s_waitcnt vmcnt(0)
s_barrier
s_cmp_eq_u32 s32, 0
s_cbranch_scc0 L_wi_LN_ok
s_mov_b32 s66, 0
v_and_b32 v4, 63, v0
v_and_b32 v2, 3, v4
v_bfe_u32 v3, v4, 2, 1
v_lshl_add_u32 v2, v3, 5, v2
v_lshlrev_b32 v2, 2, v2
v_cmp_eq_u32 vcc, 8, v4
v_mov_b32 v3, 40
s_nop 0
v_cndmask_b32 v2, v2, v3, vcc
v_cmp_lt_u32 vcc, 8, v4
v_mov_b32 v3, 44
s_nop 0
v_cndmask_b32 v2, v2, v3, vcc
L_wi_LN:
global_load_dword v3, v2, s[28:29] sc1
s_waitcnt vmcnt(0)
v_readlane_b32 s67, v3, 0
v_readlane_b32 s68, v3, 1
s_nop 2
s_add_u32 s67, s67, s68
v_readlane_b32 s68, v3, 2
s_nop 2
s_add_u32 s67, s67, s68
v_readlane_b32 s68, v3, 3
s_nop 2
s_add_u32 s67, s67, s68
v_readlane_b32 s68, v3, 4
s_nop 2
s_add_u32 s67, s67, s68
v_readlane_b32 s68, v3, 5
s_nop 2
s_add_u32 s67, s67, s68
v_readlane_b32 s68, v3, 6
s_nop 2
s_add_u32 s67, s67, s68
v_readlane_b32 s68, v3, 7
s_nop 2
s_add_u32 s67, s67, s68
v_readlane_b32 s68, v3, 8
s_nop 2
s_add_u32 s67, s67, s68
s_cmp_ge_u32 s67, 256
s_cbranch_scc1 L_wi_LN_ok
s_sleep 8
s_add_u32 s66, s66, 1
s_cmp_lt_u32 s66, 0x20000
s_cbranch_scc1 L_wi_LN
s_endpgm
L_wi_LN_ok:
s_barrier
s_cmp_eq_u32 s32, 0
s_cbranch_scc0 L_LN_nf
s_mov_b64 exec, 1
s_lshl_b32 s60, s59, 6
s_add_u32 s60, s60, 32768
v_mov_b32 v2, s60
v_mov_b32 v3, 1
global_store_dword v2, v3, s[30:31] sc1
s_waitcnt vmcnt(0)
s_mov_b64 exec, -1
L_LN_nf:
s_cmp_lt_u32 s59, 60
s_cbranch_scc1 L_F_main
s_endpgm
L_K:
v_and_b32 v1, 63, v0
s_lshl_b32 s35, s34, 8
s_add_u32 s36, s14, s35
s_addc_u32 s37, s15, 0
s_mul_i32 s35, s32, 1310720
s_add_u32 s36, s36, s35
s_addc_u32 s37, s37, 0
v_lshrrev_b32 v4, 4, v1
v_and_b32 v5, 15, v1
v_lshrrev_b32 v6, 1, v5
v_lshlrev_b32 v7, 1, v4
v_xor_b32 v6, v6, v7
v_and_b32 v5, 1, v5
v_lshl_add_u32 v6, v6, 1, v5
s_mov_b32 s35, 8192
v_mul_lo_u32 v2, v4, s35
v_lshl_add_u32 v2, v6, 4, v2
s_mul_i32 s40, s32, 40960
s_mov_b32 m0, s40
s_nop 0
global_load_lds_dwordx4 v2, s[36:37]
s_add_u32 s40, s40, 1024
s_add_u32 s36, s36, 32768
s_addc_u32 s37, s37, 0
s_mov_b32 m0, s40
s_nop 0
global_load_lds_dwordx4 v2, s[36:37]
s_add_u32 s40, s40, 1024
s_add_u32 s36, s36, 32768
s_addc_u32 s37, s37, 0
s_mov_b32 m0, s40
s_nop 0
global_load_lds_dwordx4 v2, s[36:37]
s_add_u32 s40, s40, 1024
s_add_u32 s36, s36, 32768
s_addc_u32 s37, s37, 0
s_mov_b32 m0, s40
s_nop 0
global_load_lds_dwordx4 v2, s[36:37]
s_add_u32 s40, s40, 1024
s_add_u32 s36, s36, 32768
s_addc_u32 s37, s37, 0
s_mov_b32 m0, s40
s_nop 0
global_load_lds_dwordx4 v2, s[36:37]
s_add_u32 s40, s40, 1024
s_add_u32 s36, s36, 32768
s_addc_u32 s37, s37, 0
s_mov_b32 m0, s40
s_nop 0
global_load_lds_dwordx4 v2, s[36:37]
s_add_u32 s40, s40, 1024
s_add_u32 s36, s36, 32768
s_addc_u32 s37, s37, 0
s_mov_b32 m0, s40
s_nop 0
global_load_lds_dwordx4 v2, s[36:37]
s_add_u32 s40, s40, 1024
s_add_u32 s36, s36, 32768
s_addc_u32 s37, s37, 0
s_mov_b32 m0, s40
s_nop 0
global_load_lds_dwordx4 v2, s[36:37]
s_add_u32 s40, s40, 1024
s_add_u32 s36, s36, 32768
s_addc_u32 s37, s37, 0
s_mov_b32 m0, s40
s_nop 0
global_load_lds_dwordx4 v2, s[36:37]
s_add_u32 s40, s40, 1024
s_add_u32 s36, s36, 32768
s_addc_u32 s37, s37, 0
s_mov_b32 m0, s40
s_nop 0
global_load_lds_dwordx4 v2, s[36:37]
s_add_u32 s40, s40, 1024
s_add_u32 s36, s36, 32768
s_addc_u32 s37, s37, 0
s_mov_b32 m0, s40
s_nop 0
global_load_lds_dwordx4 v2, s[36:37]
s_add_u32 s40, s40, 1024
s_add_u32 s36, s36, 32768
s_addc_u32 s37, s37, 0
s_mov_b32 m0, s40
s_nop 0
global_load_lds_dwordx4 v2, s[36:37]
s_add_u32 s40, s40, 1024
s_add_u32 s36, s36, 32768
s_addc_u32 s37, s37, 0
s_mov_b32 m0, s40
s_nop 0
global_load_lds_dwordx4 v2, s[36:37]
s_add_u32 s40, s40, 1024
s_add_u32 s36, s36, 32768
s_addc_u32 s37, s37, 0
s_mov_b32 m0, s40
s_nop 0
global_load_lds_dwordx4 v2, s[36:37]
s_add_u32 s40, s40, 1024
s_add_u32 s36, s36, 32768
s_addc_u32 s37, s37, 0
s_mov_b32 m0, s40
s_nop 0
global_load_lds_dwordx4 v2, s[36:37]
s_add_u32 s40, s40, 1024
s_add_u32 s36, s36, 32768
s_addc_u32 s37, s37, 0
s_mov_b32 m0, s40
s_nop 0
global_load_lds_dwordx4 v2, s[36:37]
s_add_u32 s40, s40, 1024
s_add_u32 s36, s36, 32768
s_addc_u32 s37, s37, 0
s_mov_b32 m0, s40
s_nop 0
global_load_lds_dwordx4 v2, s[36:37]
s_add_u32 s40, s40, 1024
s_add_u32 s36, s36, 32768
s_addc_u32 s37, s37, 0
s_mov_b32 m0, s40
s_nop 0
global_load_lds_dwordx4 v2, s[36:37]
s_add_u32 s40, s40, 1024
s_add_u32 s36, s36, 32768
s_addc_u32 s37, s37, 0
s_mov_b32 m0, s40
s_nop 0
global_load_lds_dwordx4 v2, s[36:37]
s_add_u32 s40, s40, 1024
s_add_u32 s36, s36, 32768
s_addc_u32 s37, s37, 0
s_mov_b32 m0, s40
s_nop 0
global_load_lds_dwordx4 v2, s[36:37]
s_add_u32 s40, s40, 1024
s_add_u32 s36, s36, 32768
s_addc_u32 s37, s37, 0
s_mov_b32 m0, s40
s_nop 0
global_load_lds_dwordx4 v2, s[36:37]
s_add_u32 s40, s40, 1024
s_add_u32 s36, s36, 32768
s_addc_u32 s37, s37, 0
s_mov_b32 m0, s40
s_nop 0
global_load_lds_dwordx4 v2, s[36:37]
s_add_u32 s40, s40, 1024
s_add_u32 s36, s36, 32768
s_addc_u32 s37, s37, 0
s_mov_b32 m0, s40
s_nop 0
global_load_lds_dwordx4 v2, s[36:37]
s_add_u32 s40, s40, 1024
s_add_u32 s36, s36, 32768
s_addc_u32 s37, s37, 0
s_mov_b32 m0, s40
s_nop 0
global_load_lds_dwordx4 v2, s[36:37]
s_add_u32 s40, s40, 1024
s_add_u32 s36, s36, 32768
s_addc_u32 s37, s37, 0
s_mov_b32 m0, s40
s_nop 0
global_load_lds_dwordx4 v2, s[36:37]
s_add_u32 s40, s40, 1024
s_add_u32 s36, s36, 32768
s_addc_u32 s37, s37, 0
s_mov_b32 m0, s40
s_nop 0
global_load_lds_dwordx4 v2, s[36:37]
s_add_u32 s40, s40, 1024
s_add_u32 s36, s36, 32768
s_addc_u32 s37, s37, 0
s_mov_b32 m0, s40
s_nop 0
global_load_lds_dwordx4 v2, s[36:37]
s_add_u32 s40, s40, 1024
s_add_u32 s36, s36, 32768
s_addc_u32 s37, s37, 0
s_mov_b32 m0, s40
s_nop 0
global_load_lds_dwordx4 v2, s[36:37]
s_add_u32 s40, s40, 1024
s_add_u32 s36, s36, 32768
s_addc_u32 s37, s37, 0
s_mov_b32 m0, s40
s_nop 0
global_load_lds_dwordx4 v2, s[36:37]
s_add_u32 s40, s40, 1024
s_add_u32 s36, s36, 32768
s_addc_u32 s37, s37, 0
s_mov_b32 m0, s40
s_nop 0
global_load_lds_dwordx4 v2, s[36:37]
s_add_u32 s40, s40, 1024
s_add_u32 s36, s36, 32768
s_addc_u32 s37, s37, 0
s_mov_b32 m0, s40
s_nop 0
global_load_lds_dwordx4 v2, s[36:37]
s_add_u32 s40, s40, 1024
s_add_u32 s36, s36, 32768
s_addc_u32 s37, s37, 0
s_mov_b32 m0, s40
s_nop 0
global_load_lds_dwordx4 v2, s[36:37]
s_add_u32 s40, s40, 1024
s_add_u32 s36, s36, 32768
s_addc_u32 s37, s37, 0
s_mov_b32 m0, s40
s_nop 0
global_load_lds_dwordx4 v2, s[36:37]
s_add_u32 s40, s40, 1024
s_add_u32 s36, s36, 32768
s_addc_u32 s37, s37, 0
s_mov_b32 m0, s40
s_nop 0
global_load_lds_dwordx4 v2, s[36:37]
s_add_u32 s40, s40, 1024
s_add_u32 s36, s36, 32768
s_addc_u32 s37, s37, 0
s_mov_b32 m0, s40
s_nop 0
global_load_lds_dwordx4 v2, s[36:37]
s_add_u32 s40, s40, 1024
s_add_u32 s36, s36, 32768
s_addc_u32 s37, s37, 0
s_mov_b32 m0, s40
s_nop 0
global_load_lds_dwordx4 v2, s[36:37]
s_add_u32 s40, s40, 1024
s_add_u32 s36, s36, 32768
s_addc_u32 s37, s37, 0
s_mov_b32 m0, s40
s_nop 0
global_load_lds_dwordx4 v2, s[36:37]
s_add_u32 s40, s40, 1024
s_add_u32 s36, s36, 32768
s_addc_u32 s37, s37, 0
s_mov_b32 m0, s40
s_nop 0
global_load_lds_dwordx4 v2, s[36:37]
s_add_u32 s40, s40, 1024
s_add_u32 s36, s36, 32768
s_addc_u32 s37, s37, 0
s_mov_b32 m0, s40
s_nop 0
global_load_lds_dwordx4 v2, s[36:37]
s_add_u32 s40, s40, 1024
s_add_u32 s36, s36, 32768
s_addc_u32 s37, s37, 0
s_mov_b32 m0, s40
s_nop 0
global_load_lds_dwordx4 v2, s[36:37]
s_add_u32 s40, s40, 1024
s_add_u32 s36, s36, 32768
s_addc_u32 s37, s37, 0
v_lshrrev_b32 v10, 5, v1
v_bfe_u32 v11, v1, 2, 2
v_lshl_add_u32 v12, v10, 3, v11
v_lshlrev_b32 v12, 8, v12
v_bfe_u32 v13, v1, 4, 1
s_lshl_b32 s35, s32, 1
v_add_u32 v13, s35, v13
v_lshlrev_b32 v14, 1, v11
v_xor_b32 v13, v13, v14
v_lshl_add_u32 v12, v13, 5, v12
v_and_b32 v13, 3, v1
v_lshl_add_u32 v15, v13, 3, v12
v_add_u32 v16, 0x10000, v15
v_add_u32 v17, 0x20000, v15
s_waitcnt vmcnt(0)
s_barrier
ds_read_b64_tr_b16 a[0:1], v15 offset:0
ds_read_b64_tr_b16 a[2:3], v15 offset:1024
ds_read_b64_tr_b16 a[4:5], v15 offset:4096
ds_read_b64_tr_b16 a[6:7], v15 offset:5120
ds_read_b64_tr_b16 a[8:9], v15 offset:8192
ds_read_b64_tr_b16 a[10:11], v15 offset:9216
ds_read_b64_tr_b16 a[12:13], v15 offset:12288
ds_read_b64_tr_b16 a[14:15], v15 offset:13312
ds_read_b64_tr_b16 a[16:17], v15 offset:16384
ds_read_b64_tr_b16 a[18:19], v15 offset:17408
ds_read_b64_tr_b16 a[20:21], v15 offset:20480
ds_read_b64_tr_b16 a[22:23], v15 offset:21504
ds_read_b64_tr_b16 a[24:25], v15 offset:24576
ds_read_b64_tr_b16 a[26:27], v15 offset:25600
ds_read_b64_tr_b16 a[28:29], v15 offset:28672
s_waitcnt lgkmcnt(14)
ds_read_b64_tr_b16 a[30:31], v15 offset:29696
s_waitcnt lgkmcnt(14)
ds_read_b64_tr_b16 a[32:33], v15 offset:32768
s_waitcnt lgkmcnt(14)
ds_read_b64_tr_b16 a[34:35], v15 offset:33792
s_waitcnt lgkmcnt(14)
ds_read_b64_tr_b16 a[36:37], v15 offset:36864
s_waitcnt lgkmcnt(14)
ds_read_b64_tr_b16 a[38:39], v15 offset:37888
s_waitcnt lgkmcnt(14)
ds_read_b64_tr_b16 a[40:41], v15 offset:40960
s_waitcnt lgkmcnt(14)
ds_read_b64_tr_b16 a[42:43], v15 offset:41984
s_waitcnt lgkmcnt(14)
ds_read_b64_tr_b16 a[44:45], v15 offset:45056
s_waitcnt lgkmcnt(14)
ds_read_b64_tr_b16 a[46:47], v15 offset:46080
s_waitcnt lgkmcnt(14)
ds_read_b64_tr_b16 a[48:49], v15 offset:49152
s_waitcnt lgkmcnt(14)
ds_read_b64_tr_b16 a[50:51], v15 offset:50176
s_waitcnt lgkmcnt(14)
ds_read_b64_tr_b16 a[52:53], v15 offset:53248
s_waitcnt lgkmcnt(14)
ds_read_b64_tr_b16 a[54:55], v15 offset:54272
s_waitcnt lgkmcnt(14)
ds_read_b64_tr_b16 a[56:57], v15 offset:57344
s_waitcnt lgkmcnt(14)
ds_read_b64_tr_b16 a[58:59], v15 offset:58368
s_waitcnt lgkmcnt(14)
ds_read_b64_tr_b16 a[60:61], v15 offset:61440
s_waitcnt lgkmcnt(14)
ds_read_b64_tr_b16 a[62:63], v15 offset:62464
s_waitcnt lgkmcnt(14)
ds_read_b64_tr_b16 a[64:65], v16 offset:0
s_waitcnt lgkmcnt(14)
ds_read_b64_tr_b16 a[66:67], v16 offset:1024
s_waitcnt lgkmcnt(14)
ds_read_b64_tr_b16 a[68:69], v16 offset:4096
s_waitcnt lgkmcnt(14)
ds_read_b64_tr_b16 a[70:71], v16 offset:5120
s_waitcnt lgkmcnt(14)
ds_read_b64_tr_b16 a[72:73], v16 offset:8192
s_waitcnt lgkmcnt(14)
ds_read_b64_tr_b16 a[74:75], v16 offset:9216
s_waitcnt lgkmcnt(14)
ds_read_b64_tr_b16 a[76:77], v16 offset:12288
s_waitcnt lgkmcnt(14)
ds_read_b64_tr_b16 a[78:79], v16 offset:13312
s_waitcnt lgkmcnt(14)
ds_read_b64_tr_b16 a[80:81], v16 offset:16384
s_waitcnt lgkmcnt(14)
ds_read_b64_tr_b16 a[82:83], v16 offset:17408
s_waitcnt lgkmcnt(14)
ds_read_b64_tr_b16 a[84:85], v16 offset:20480
s_waitcnt lgkmcnt(14)
ds_read_b64_tr_b16 a[86:87], v16 offset:21504
s_waitcnt lgkmcnt(14)
ds_read_b64_tr_b16 a[88:89], v16 offset:24576
s_waitcnt lgkmcnt(14)
ds_read_b64_tr_b16 a[90:91], v16 offset:25600
s_waitcnt lgkmcnt(14)
ds_read_b64_tr_b16 a[92:93], v16 offset:28672
s_waitcnt lgkmcnt(14)
ds_read_b64_tr_b16 a[94:95], v16 offset:29696
s_waitcnt lgkmcnt(14)
ds_read_b64_tr_b16 a[96:97], v16 offset:32768
s_waitcnt lgkmcnt(14)
ds_read_b64_tr_b16 a[98:99], v16 offset:33792
s_waitcnt lgkmcnt(14)
ds_read_b64_tr_b16 a[100:101], v16 offset:36864
s_waitcnt lgkmcnt(14)
ds_read_b64_tr_b16 a[102:103], v16 offset:37888
s_waitcnt lgkmcnt(14)
ds_read_b64_tr_b16 a[104:105], v16 offset:40960
s_waitcnt lgkmcnt(14)
ds_read_b64_tr_b16 a[106:107], v16 offset:41984
s_waitcnt lgkmcnt(14)
ds_read_b64_tr_b16 a[108:109], v16 offset:45056
s_waitcnt lgkmcnt(14)
ds_read_b64_tr_b16 a[110:111], v16 offset:46080
s_waitcnt lgkmcnt(14)
ds_read_b64_tr_b16 a[112:113], v16 offset:49152
s_waitcnt lgkmcnt(14)
ds_read_b64_tr_b16 a[114:115], v16 offset:50176
s_waitcnt lgkmcnt(14)
ds_read_b64_tr_b16 a[116:117], v16 offset:53248
s_waitcnt lgkmcnt(14)
ds_read_b64_tr_b16 a[118:119], v16 offset:54272
s_waitcnt lgkmcnt(14)
ds_read_b64_tr_b16 a[120:121], v16 offset:57344
s_waitcnt lgkmcnt(14)
ds_read_b64_tr_b16 a[122:123], v16 offset:58368
s_waitcnt lgkmcnt(14)
ds_read_b64_tr_b16 a[124:125], v16 offset:61440
s_waitcnt lgkmcnt(14)
ds_read_b64_tr_b16 a[126:127], v16 offset:62464
s_waitcnt lgkmcnt(14)
ds_read_b64_tr_b16 a[128:129], v17 offset:0
s_waitcnt lgkmcnt(14)
ds_read_b64_tr_b16 a[130:131], v17 offset:1024
s_waitcnt lgkmcnt(14)
ds_read_b64_tr_b16 a[132:133], v17 offset:4096
s_waitcnt lgkmcnt(14)
ds_read_b64_tr_b16 a[134:135], v17 offset:5120
s_waitcnt lgkmcnt(14)
ds_read_b64_tr_b16 a[136:137], v17 offset:8192
s_waitcnt lgkmcnt(14)
ds_read_b64_tr_b16 a[138:139], v17 offset:9216
s_waitcnt lgkmcnt(14)
ds_read_b64_tr_b16 a[140:141], v17 offset:12288
s_waitcnt lgkmcnt(14)
ds_read_b64_tr_b16 a[142:143], v17 offset:13312
s_waitcnt lgkmcnt(14)
ds_read_b64_tr_b16 a[144:145], v17 offset:16384
s_waitcnt lgkmcnt(14)
ds_read_b64_tr_b16 a[146:147], v17 offset:17408
s_waitcnt lgkmcnt(14)
ds_read_b64_tr_b16 a[148:149], v17 offset:20480
s_waitcnt lgkmcnt(14)
ds_read_b64_tr_b16 a[150:151], v17 offset:21504
s_waitcnt lgkmcnt(14)
ds_read_b64_tr_b16 a[152:153], v17 offset:24576
s_waitcnt lgkmcnt(14)
ds_read_b64_tr_b16 a[154:155], v17 offset:25600
s_waitcnt lgkmcnt(14)
ds_read_b64_tr_b16 a[156:157], v17 offset:28672
s_waitcnt lgkmcnt(14)
ds_read_b64_tr_b16 a[158:159], v17 offset:29696
s_waitcnt lgkmcnt(0)
s_barrier
s_cmp_eq_u32 s32, 0
s_cbranch_scc0 L_wi_K_ok
s_mov_b32 s57, 0
v_and_b32 v4, 63, v0
v_and_b32 v2, 3, v4
v_bfe_u32 v3, v4, 2, 1
v_lshl_add_u32 v2, v3, 5, v2
v_lshlrev_b32 v2, 2, v2
v_cmp_eq_u32 vcc, 8, v4
v_mov_b32 v3, 40
s_nop 0
v_cndmask_b32 v2, v2, v3, vcc
v_cmp_lt_u32 vcc, 8, v4
v_mov_b32 v3, 44
s_nop 0
v_cndmask_b32 v2, v2, v3, vcc
L_wi_K:
global_load_dword v3, v2, s[28:29] sc1
s_waitcnt vmcnt(0)
v_readlane_b32 s58, v3, 0
v_readlane_b32 s59, v3, 1
s_nop 2
s_add_u32 s58, s58, s59
v_readlane_b32 s59, v3, 2
s_nop 2
s_add_u32 s58, s58, s59
v_readlane_b32 s59, v3, 3
s_nop 2
s_add_u32 s58, s58, s59
v_readlane_b32 s59, v3, 4
s_nop 2
s_add_u32 s58, s58, s59
v_readlane_b32 s59, v3, 5
s_nop 2
s_add_u32 s58, s58, s59
v_readlane_b32 s59, v3, 6
s_nop 2
s_add_u32 s58, s58, s59
v_readlane_b32 s59, v3, 7
s_nop 2
s_add_u32 s58, s58, s59
v_readlane_b32 s59, v3, 8
s_nop 2
s_add_u32 s58, s58, s59
s_cmp_ge_u32 s58, 256
s_cbranch_scc1 L_wi_K_ok
s_sleep 8
s_add_u32 s57, s57, 1
s_cmp_lt_u32 s57, 0x20000
s_cbranch_scc1 L_wi_K
s_endpgm
L_wi_K_ok:
s_barrier
v_lshlrev_b32 v9, 6, v1
v_add_u32 v9, 32768, v9
s_mov_b32 s62, 0
s_mov_b32 s63, 0
s_cmp_eq_u32 s62, 1
s_cbranch_scc1 L_K_wx0_sk
s_mov_b32 s57, 0
L_K_wx0:
global_load_dword v10, v9, s[30:31] sc1
s_waitcnt vmcnt(0)
v_cmp_ne_u32 vcc, 0, v10
s_nop 2
s_cmp_eq_u64 vcc, exec
s_cselect_b32 s62, 1, 0
s_bitcmp1_b64 vcc, s63
s_cbranch_scc0 L_K_wx0_s_22
L_K_wx0_sk:
s_mul_i32 s35, s32, 10240
v_lshlrev_b32 v5, 4, v1
v_add_u32 v2, s35, v5
v_add_u32 v3, 4096, v2
v_add_u32 v4, 8192, v2
s_add_u32 s36, s30, 1048576
s_addc_u32 s37, s31, 0
s_mov_b32 s40, s35
s_lshl_b32 s35, s34, 13
s_add_u32 s38, s30, 16777216
s_addc_u32 s39, s31, 0
s_add_u32 s38, s38, s35
s_addc_u32 s39, s39, 0
v_bfe_u32 v10, v1, 4, 1
v_lshlrev_b32 v10, 10, v10
v_lshrrev_b32 v11, 5, v1
v_lshl_add_u32 v10, v11, 8, v10
v_and_b32 v11, 15, v1
v_lshl_add_u32 v10, v11, 4, v10
s_lshl_b32 s35, s32, 11
v_add_u32 v6, s35, v10
s_lshl_b32 s35, s34, 6
s_lshl_b32 s41, s32, 2
s_add_u32 s35, s35, s41
s_add_u32 s35, s35, 0
v_mov_b32 v7, s35
s_mov_b32 m0, s40
s_nop 0
global_load_lds_dwordx4 v2, s[36:37] offset:0 sc1
global_load_lds_dwordx4 v2, s[36:37] offset:1024 sc1
global_load_lds_dwordx4 v2, s[36:37] offset:2048 sc1
global_load_lds_dwordx4 v2, s[36:37] offset:3072 sc1
s_add_u32 m0, s40, 4096
s_nop 0
global_load_lds_dwordx4 v3, s[36:37] offset:0 sc1
global_load_lds_dwordx4 v3, s[36:37] offset:1024 sc1
global_load_lds_dwordx4 v3, s[36:37] offset:2048 sc1
global_load_lds_dwordx4 v3, s[36:37] offset:3072 sc1
s_add_u32 m0, s40, 8192
s_nop 0
global_load_lds_dwordx4 v4, s[36:37] offset:0 sc1
global_load_lds_dwordx4 v4, s[36:37] offset:1024 sc1
s_mov_b32 s42, 0
s_waitcnt vmcnt(0)
L_K_loop:
s_waitcnt vmcnt(3)
s_barrier
s_add_u32 s63, s42, 1
s_min_u32 s63, s63, 63
s_cmp_eq_u32 s62, 1
s_cbranch_scc1 L_K_wxn_sk
s_mov_b32 s57, 0
L_K_wxn:
global_load_dword v10, v9, s[30:31] sc1
s_waitcnt vmcnt(0)
v_cmp_ne_u32 vcc, 0, v10
s_nop 2
s_cmp_eq_u64 vcc, exec
s_cselect_b32 s62, 1, 0
s_bitcmp1_b64 vcc, s63
s_cbranch_scc0 L_K_wxn_s_23
L_K_wxn_sk:
s_cmp_lt_u32 s42, 63
s_cselect_b32 s35, 40960, 0
s_add_u32 s36, s36, s35
s_addc_u32 s37, s37, 0
s_xor_b32 s43, s42, 1
s_and_b32 s43, s43, 1
s_mul_i32 s43, s43, 40960
s_mul_i32 s40, s32, 10240
s_add_u32 s40, s40, s43
s_mov_b32 m0, s40
s_nop 0
global_load_lds_dwordx4 v2, s[36:37] offset:0 sc1
global_load_lds_dwordx4 v2, s[36:37] offset:1024 sc1
global_load_lds_dwordx4 v2, s[36:37] offset:2048 sc1
global_load_lds_dwordx4 v2, s[36:37] offset:3072 sc1
s_add_u32 m0, s40, 4096
s_nop 0
global_load_lds_dwordx4 v3, s[36:37] offset:0 sc1
global_load_lds_dwordx4 v3, s[36:37] offset:1024 sc1
global_load_lds_dwordx4 v3, s[36:37] offset:2048 sc1
global_load_lds_dwordx4 v3, s[36:37] offset:3072 sc1
s_add_u32 m0, s40, 8192
s_nop 0
global_load_lds_dwordx4 v4, s[36:37] offset:0 sc1
global_load_lds_dwordx4 v4, s[36:37] offset:1024 sc1
ds_read_b128 v[32:35], v5 offset:0
ds_read_b128 v[36:39], v5 offset:1024
ds_read_b128 v[40:43], v5 offset:2048
ds_read_b128 v[44:47], v5 offset:3072
ds_read_b128 v[48:51], v5 offset:4096
ds_read_b128 v[52:55], v5 offset:5120
ds_read_b128 v[56:59], v5 offset:6144
ds_read_b128 v[60:63], v5 offset:7168
s_waitcnt lgkmcnt(7)
v_mfma_f32_32x32x16_bf16 v[16:31], a[0:3], v[32:35], 0
ds_read_b128 v[32:35], v5 offset:8192
s_waitcnt lgkmcnt(7)
v_mfma_f32_32x32x16_bf16 v[16:31], a[4:7], v[36:39], v[16:31]
ds_read_b128 v[36:39], v5 offset:9216
s_waitcnt lgkmcnt(7)
v_mfma_f32_32x32x16_bf16 v[16:31], a[8:11], v[40:43], v[16:31]
ds_read_b128 v[40:43], v5 offset:10240
s_waitcnt lgkmcnt(7)
v_mfma_f32_32x32x16_bf16 v[16:31], a[12:15], v[44:47], v[16:31]
ds_read_b128 v[44:47], v5 offset:11264
s_waitcnt lgkmcnt(7)
v_mfma_f32_32x32x16_bf16 v[16:31], a[16:19], v[48:51], v[16:31]
ds_read_b128 v[48:51], v5 offset:12288
s_waitcnt lgkmcnt(7)
v_mfma_f32_32x32x16_bf16 v[16:31], a[20:23], v[52:55], v[16:31]
ds_read_b128 v[52:55], v5 offset:13312
s_waitcnt lgkmcnt(7)
v_mfma_f32_32x32x16_bf16 v[16:31], a[24:27], v[56:59], v[16:31]
ds_read_b128 v[56:59], v5 offset:14336
s_waitcnt lgkmcnt(7)
v_mfma_f32_32x32x16_bf16 v[16:31], a[28:31], v[60:63], v[16:31]
ds_read_b128 v[60:63], v5 offset:15360
s_waitcnt lgkmcnt(7)
v_mfma_f32_32x32x16_bf16 v[16:31], a[32:35], v[32:35], v[16:31]
ds_read_b128 v[32:35], v5 offset:16384
s_waitcnt lgkmcnt(7)
v_mfma_f32_32x32x16_bf16 v[16:31], a[36:39], v[36:39], v[16:31]
ds_read_b128 v[36:39], v5 offset:17408
s_waitcnt lgkmcnt(7)
v_mfma_f32_32x32x16_bf16 v[16:31], a[40:43], v[40:43], v[16:31]
ds_read_b128 v[40:43], v5 offset:18432
s_waitcnt lgkmcnt(7)
v_mfma_f32_32x32x16_bf16 v[16:31], a[44:47], v[44:47], v[16:31]
ds_read_b128 v[44:47], v5 offset:19456
s_waitcnt lgkmcnt(7)
v_mfma_f32_32x32x16_bf16 v[16:31], a[48:51], v[48:51], v[16:31]
ds_read_b128 v[48:51], v5 offset:20480
s_waitcnt lgkmcnt(7)
v_mfma_f32_32x32x16_bf16 v[16:31], a[52:55], v[52:55], v[16:31]
ds_read_b128 v[52:55], v5 offset:21504
s_waitcnt lgkmcnt(7)
v_mfma_f32_32x32x16_bf16 v[16:31], a[56:59], v[56:59], v[16:31]
ds_read_b128 v[56:59], v5 offset:22528
s_waitcnt lgkmcnt(7)
v_mfma_f32_32x32x16_bf16 v[16:31], a[60:63], v[60:63], v[16:31]
ds_read_b128 v[60:63], v5 offset:23552
s_waitcnt lgkmcnt(7)
v_mfma_f32_32x32x16_bf16 v[16:31], a[64:67], v[32:35], v[16:31]
ds_read_b128 v[32:35], v5 offset:24576
s_waitcnt lgkmcnt(7)
v_mfma_f32_32x32x16_bf16 v[16:31], a[68:71], v[36:39], v[16:31]
ds_read_b128 v[36:39], v5 offset:25600
s_waitcnt lgkmcnt(7)
v_mfma_f32_32x32x16_bf16 v[16:31], a[72:75], v[40:43], v[16:31]
ds_read_b128 v[40:43], v5 offset:26624
s_waitcnt lgkmcnt(7)
v_mfma_f32_32x32x16_bf16 v[16:31], a[76:79], v[44:47], v[16:31]
ds_read_b128 v[44:47], v5 offset:27648
s_waitcnt lgkmcnt(7)
v_mfma_f32_32x32x16_bf16 v[16:31], a[80:83], v[48:51], v[16:31]
ds_read_b128 v[48:51], v5 offset:28672
s_waitcnt lgkmcnt(7)
v_mfma_f32_32x32x16_bf16 v[16:31], a[84:87], v[52:55], v[16:31]
ds_read_b128 v[52:55], v5 offset:29696
s_waitcnt lgkmcnt(7)
v_mfma_f32_32x32x16_bf16 v[16:31], a[88:91], v[56:59], v[16:31]
ds_read_b128 v[56:59], v5 offset:30720
s_waitcnt lgkmcnt(7)
v_mfma_f32_32x32x16_bf16 v[16:31], a[92:95], v[60:63], v[16:31]
ds_read_b128 v[60:63], v5 offset:31744
s_waitcnt lgkmcnt(7)
v_mfma_f32_32x32x16_bf16 v[16:31], a[96:99], v[32:35], v[16:31]
ds_read_b128 v[32:35], v5 offset:32768
s_waitcnt lgkmcnt(7)
v_mfma_f32_32x32x16_bf16 v[16:31], a[100:103], v[36:39], v[16:31]
ds_read_b128 v[36:39], v5 offset:33792
s_waitcnt lgkmcnt(7)
v_mfma_f32_32x32x16_bf16 v[16:31], a[104:107], v[40:43], v[16:31]
ds_read_b128 v[40:43], v5 offset:34816
s_waitcnt lgkmcnt(7)
v_mfma_f32_32x32x16_bf16 v[16:31], a[108:111], v[44:47], v[16:31]
ds_read_b128 v[44:47], v5 offset:35840
s_waitcnt lgkmcnt(7)
v_mfma_f32_32x32x16_bf16 v[16:31], a[112:115], v[48:51], v[16:31]
ds_read_b128 v[48:51], v5 offset:36864
s_waitcnt lgkmcnt(7)
v_mfma_f32_32x32x16_bf16 v[16:31], a[116:119], v[52:55], v[16:31]
ds_read_b128 v[52:55], v5 offset:37888
s_waitcnt lgkmcnt(7)
v_mfma_f32_32x32x16_bf16 v[16:31], a[120:123], v[56:59], v[16:31]
ds_read_b128 v[56:59], v5 offset:38912
s_waitcnt lgkmcnt(7)
v_mfma_f32_32x32x16_bf16 v[16:31], a[124:127], v[60:63], v[16:31]
ds_read_b128 v[60:63], v5 offset:39936
s_waitcnt lgkmcnt(7)
v_mfma_f32_32x32x16_bf16 v[16:31], a[128:131], v[32:35], v[16:31]
s_waitcnt lgkmcnt(6)
v_mfma_f32_32x32x16_bf16 v[16:31], a[132:135], v[36:39], v[16:31]
s_waitcnt lgkmcnt(5)
v_mfma_f32_32x32x16_bf16 v[16:31], a[136:139], v[40:43], v[16:31]
s_waitcnt lgkmcnt(4)
v_mfma_f32_32x32x16_bf16 v[16:31], a[140:143], v[44:47], v[16:31]
s_waitcnt lgkmcnt(3)
v_mfma_f32_32x32x16_bf16 v[16:31], a[144:147], v[48:51], v[16:31]
s_waitcnt lgkmcnt(2)
v_mfma_f32_32x32x16_bf16 v[16:31], a[148:151], v[52:55], v[16:31]
s_waitcnt lgkmcnt(1)
v_mfma_f32_32x32x16_bf16 v[16:31], a[152:155], v[56:59], v[16:31]
s_waitcnt lgkmcnt(0)
v_mfma_f32_32x32x16_bf16 v[16:31], a[156:159], v[60:63], v[16:31]
v_xor_b32 v5, 0xa000, v5
s_waitcnt vmcnt(10)
s_mov_b64 exec, 1
v_mov_b32 v8, s42
global_store_dword v7, v8, s[30:31] sc1
s_mov_b64 exec, -1
s_nop 5
v_cvt_pk_bf16_f32 v64, v16, v17
v_cvt_pk_bf16_f32 v65, v18, v19
v_cvt_pk_bf16_f32 v66, v24, v25
v_cvt_pk_bf16_f32 v67, v26, v27
v_cvt_pk_bf16_f32 v68, v20, v21
v_cvt_pk_bf16_f32 v69, v22, v23
v_cvt_pk_bf16_f32 v70, v28, v29
v_cvt_pk_bf16_f32 v71, v30, v31
global_store_dwordx4 v6, v[64:67], s[38:39] sc1
global_store_dwordx4 v6, v[68:71], s[38:39] offset:512 sc1
s_cmp_eq_u32 s42, 0
s_cbranch_scc0 L_K_nf0
s_waitcnt vmcnt(0)
s_mov_b64 exec, 1
v_mov_b32 v8, 1
global_store_dword v7, v8, s[30:31] sc1
s_mov_b64 exec, -1
s_waitcnt vmcnt(0)
L_K_nf0:
s_add_u32 s38, s38, 262144
s_addc_u32 s39, s39, 0
s_add_u32 s42, s42, 1
s_cmp_lt_u32 s42, 64
s_cbranch_scc1 L_K_loop
s_waitcnt vmcnt(0)
s_mov_b64 exec, 1
v_mov_b32 v8, 64
global_store_dword v7, v8, s[30:31] sc1
s_mov_b64 exec, -1
s_waitcnt vmcnt(0)
s_endpgm
L_K_wx0_s_22:
s_sleep 2
s_add_u32 s57, s57, 1
s_cmp_lt_u32 s57, 262144
s_cbranch_scc1 L_K_wx0
s_endpgm
L_K_wxn_s_23:
s_sleep 2
s_add_u32 s57, s57, 1
s_cmp_lt_u32 s57, 262144
s_cbranch_scc1 L_K_wxn
s_endpgm
L_V:
v_and_b32 v1, 63, v0
s_lshl_b32 s35, s34, 8
s_add_u32 s36, s16, s35
s_addc_u32 s37, s17, 0
s_mul_i32 s35, s32, 1310720
s_add_u32 s36, s36, s35
s_addc_u32 s37, s37, 0
v_lshrrev_b32 v4, 4, v1
v_and_b32 v5, 15, v1
v_lshrrev_b32 v6, 1, v5
v_lshlrev_b32 v7, 1, v4
v_xor_b32 v6, v6, v7
v_and_b32 v5, 1, v5
v_lshl_add_u32 v6, v6, 1, v5
s_mov_b32 s35, 8192
v_mul_lo_u32 v2, v4, s35
v_lshl_add_u32 v2, v6, 4, v2
s_mul_i32 s40, s32, 40960
s_mov_b32 m0, s40
s_nop 0
global_load_lds_dwordx4 v2, s[36:37]
s_add_u32 s40, s40, 1024
s_add_u32 s36, s36, 32768
s_addc_u32 s37, s37, 0
s_mov_b32 m0, s40
s_nop 0
global_load_lds_dwordx4 v2, s[36:37]
s_add_u32 s40, s40, 1024
s_add_u32 s36, s36, 32768
s_addc_u32 s37, s37, 0
s_mov_b32 m0, s40
s_nop 0
global_load_lds_dwordx4 v2, s[36:37]
s_add_u32 s40, s40, 1024
s_add_u32 s36, s36, 32768
s_addc_u32 s37, s37, 0
s_mov_b32 m0, s40
s_nop 0
global_load_lds_dwordx4 v2, s[36:37]
s_add_u32 s40, s40, 1024
s_add_u32 s36, s36, 32768
s_addc_u32 s37, s37, 0
s_mov_b32 m0, s40
s_nop 0
global_load_lds_dwordx4 v2, s[36:37]
s_add_u32 s40, s40, 1024
s_add_u32 s36, s36, 32768
s_addc_u32 s37, s37, 0
s_mov_b32 m0, s40
s_nop 0
global_load_lds_dwordx4 v2, s[36:37]
s_add_u32 s40, s40, 1024
s_add_u32 s36, s36, 32768
s_addc_u32 s37, s37, 0
s_mov_b32 m0, s40
s_nop 0
global_load_lds_dwordx4 v2, s[36:37]
s_add_u32 s40, s40, 1024
s_add_u32 s36, s36, 32768
s_addc_u32 s37, s37, 0
s_mov_b32 m0, s40
s_nop 0
global_load_lds_dwordx4 v2, s[36:37]
s_add_u32 s40, s40, 1024
s_add_u32 s36, s36, 32768
s_addc_u32 s37, s37, 0
s_mov_b32 m0, s40
s_nop 0
global_load_lds_dwordx4 v2, s[36:37]
s_add_u32 s40, s40, 1024
s_add_u32 s36, s36, 32768
s_addc_u32 s37, s37, 0
s_mov_b32 m0, s40
s_nop 0
global_load_lds_dwordx4 v2, s[36:37]
s_add_u32 s40, s40, 1024
s_add_u32 s36, s36, 32768
s_addc_u32 s37, s37, 0
s_mov_b32 m0, s40
s_nop 0
global_load_lds_dwordx4 v2, s[36:37]
s_add_u32 s40, s40, 1024
s_add_u32 s36, s36, 32768
s_addc_u32 s37, s37, 0
s_mov_b32 m0, s40
s_nop 0
global_load_lds_dwordx4 v2, s[36:37]
s_add_u32 s40, s40, 1024
s_add_u32 s36, s36, 32768
s_addc_u32 s37, s37, 0
s_mov_b32 m0, s40
s_nop 0
global_load_lds_dwordx4 v2, s[36:37]
s_add_u32 s40, s40, 1024
s_add_u32 s36, s36, 32768
s_addc_u32 s37, s37, 0
s_mov_b32 m0, s40
s_nop 0
global_load_lds_dwordx4 v2, s[36:37]
s_add_u32 s40, s40, 1024
s_add_u32 s36, s36, 32768
s_addc_u32 s37, s37, 0
s_mov_b32 m0, s40
s_nop 0
global_load_lds_dwordx4 v2, s[36:37]
s_add_u32 s40, s40, 1024
s_add_u32 s36, s36, 32768
s_addc_u32 s37, s37, 0
s_mov_b32 m0, s40
s_nop 0
global_load_lds_dwordx4 v2, s[36:37]
s_add_u32 s40, s40, 1024
s_add_u32 s36, s36, 32768
s_addc_u32 s37, s37, 0
s_mov_b32 m0, s40
s_nop 0
global_load_lds_dwordx4 v2, s[36:37]
s_add_u32 s40, s40, 1024
s_add_u32 s36, s36, 32768
s_addc_u32 s37, s37, 0
s_mov_b32 m0, s40
s_nop 0
global_load_lds_dwordx4 v2, s[36:37]
s_add_u32 s40, s40, 1024
s_add_u32 s36, s36, 32768
s_addc_u32 s37, s37, 0
s_mov_b32 m0, s40
s_nop 0
global_load_lds_dwordx4 v2, s[36:37]
s_add_u32 s40, s40, 1024
s_add_u32 s36, s36, 32768
s_addc_u32 s37, s37, 0
s_mov_b32 m0, s40
s_nop 0
global_load_lds_dwordx4 v2, s[36:37]
s_add_u32 s40, s40, 1024
s_add_u32 s36, s36, 32768
s_addc_u32 s37, s37, 0
s_mov_b32 m0, s40
s_nop 0
global_load_lds_dwordx4 v2, s[36:37]
s_add_u32 s40, s40, 1024
s_add_u32 s36, s36, 32768
s_addc_u32 s37, s37, 0
s_mov_b32 m0, s40
s_nop 0
global_load_lds_dwordx4 v2, s[36:37]
s_add_u32 s40, s40, 1024
s_add_u32 s36, s36, 32768
s_addc_u32 s37, s37, 0
s_mov_b32 m0, s40
s_nop 0
global_load_lds_dwordx4 v2, s[36:37]
s_add_u32 s40, s40, 1024
s_add_u32 s36, s36, 32768
s_addc_u32 s37, s37, 0
s_mov_b32 m0, s40
s_nop 0
global_load_lds_dwordx4 v2, s[36:37]
s_add_u32 s40, s40, 1024
s_add_u32 s36, s36, 32768
s_addc_u32 s37, s37, 0
s_mov_b32 m0, s40
s_nop 0
global_load_lds_dwordx4 v2, s[36:37]
s_add_u32 s40, s40, 1024
s_add_u32 s36, s36, 32768
s_addc_u32 s37, s37, 0
s_mov_b32 m0, s40
s_nop 0
global_load_lds_dwordx4 v2, s[36:37]
s_add_u32 s40, s40, 1024
s_add_u32 s36, s36, 32768
s_addc_u32 s37, s37, 0
s_mov_b32 m0, s40
s_nop 0
global_load_lds_dwordx4 v2, s[36:37]
s_add_u32 s40, s40, 1024
s_add_u32 s36, s36, 32768
s_addc_u32 s37, s37, 0
s_mov_b32 m0, s40
s_nop 0
global_load_lds_dwordx4 v2, s[36:37]
s_add_u32 s40, s40, 1024
s_add_u32 s36, s36, 32768
s_addc_u32 s37, s37, 0
s_mov_b32 m0, s40
s_nop 0
global_load_lds_dwordx4 v2, s[36:37]
s_add_u32 s40, s40, 1024
s_add_u32 s36, s36, 32768
s_addc_u32 s37, s37, 0
s_mov_b32 m0, s40
s_nop 0
global_load_lds_dwordx4 v2, s[36:37]
s_add_u32 s40, s40, 1024
s_add_u32 s36, s36, 32768
s_addc_u32 s37, s37, 0
s_mov_b32 m0, s40
s_nop 0
global_load_lds_dwordx4 v2, s[36:37]
s_add_u32 s40, s40, 1024
s_add_u32 s36, s36, 32768
s_addc_u32 s37, s37, 0
s_mov_b32 m0, s40
s_nop 0
global_load_lds_dwordx4 v2, s[36:37]
s_add_u32 s40, s40, 1024
s_add_u32 s36, s36, 32768
s_addc_u32 s37, s37, 0
s_mov_b32 m0, s40
s_nop 0
global_load_lds_dwordx4 v2, s[36:37]
s_add_u32 s40, s40, 1024
s_add_u32 s36, s36, 32768
s_addc_u32 s37, s37, 0
s_mov_b32 m0, s40
s_nop 0
global_load_lds_dwordx4 v2, s[36:37]
s_add_u32 s40, s40, 1024
s_add_u32 s36, s36, 32768
s_addc_u32 s37, s37, 0
s_mov_b32 m0, s40
s_nop 0
global_load_lds_dwordx4 v2, s[36:37]
s_add_u32 s40, s40, 1024
s_add_u32 s36, s36, 32768
s_addc_u32 s37, s37, 0
s_mov_b32 m0, s40
s_nop 0
global_load_lds_dwordx4 v2, s[36:37]
s_add_u32 s40, s40, 1024
s_add_u32 s36, s36, 32768
s_addc_u32 s37, s37, 0
s_mov_b32 m0, s40
s_nop 0
global_load_lds_dwordx4 v2, s[36:37]
s_add_u32 s40, s40, 1024
s_add_u32 s36, s36, 32768
s_addc_u32 s37, s37, 0
s_mov_b32 m0, s40
s_nop 0
global_load_lds_dwordx4 v2, s[36:37]
s_add_u32 s40, s40, 1024
s_add_u32 s36, s36, 32768
s_addc_u32 s37, s37, 0
s_mov_b32 m0, s40
s_nop 0
global_load_lds_dwordx4 v2, s[36:37]
s_add_u32 s40, s40, 1024
s_add_u32 s36, s36, 32768
s_addc_u32 s37, s37, 0
s_mov_b32 m0, s40
s_nop 0
global_load_lds_dwordx4 v2, s[36:37]
s_add_u32 s40, s40, 1024
s_add_u32 s36, s36, 32768
s_addc_u32 s37, s37, 0
v_lshrrev_b32 v10, 5, v1
v_bfe_u32 v11, v1, 2, 2
v_lshl_add_u32 v12, v10, 3, v11
v_lshlrev_b32 v12, 8, v12
v_bfe_u32 v13, v1, 4, 1
s_lshl_b32 s35, s32, 1
v_add_u32 v13, s35, v13
v_lshlrev_b32 v14, 1, v11
v_xor_b32 v13, v13, v14
v_lshl_add_u32 v12, v13, 5, v12
v_and_b32 v13, 3, v1
v_lshl_add_u32 v15, v13, 3, v12
v_add_u32 v16, 0x10000, v15
v_add_u32 v17, 0x20000, v15
s_waitcnt vmcnt(0)
s_barrier
ds_read_b64_tr_b16 a[0:1], v15 offset:0
ds_read_b64_tr_b16 a[2:3], v15 offset:1024
ds_read_b64_tr_b16 a[4:5], v15 offset:4096
ds_read_b64_tr_b16 a[6:7], v15 offset:5120
ds_read_b64_tr_b16 a[8:9], v15 offset:8192
ds_read_b64_tr_b16 a[10:11], v15 offset:9216
ds_read_b64_tr_b16 a[12:13], v15 offset:12288
ds_read_b64_tr_b16 a[14:15], v15 offset:13312
ds_read_b64_tr_b16 a[16:17], v15 offset:16384
ds_read_b64_tr_b16 a[18:19], v15 offset:17408
ds_read_b64_tr_b16 a[20:21], v15 offset:20480
ds_read_b64_tr_b16 a[22:23], v15 offset:21504
ds_read_b64_tr_b16 a[24:25], v15 offset:24576
ds_read_b64_tr_b16 a[26:27], v15 offset:25600
ds_read_b64_tr_b16 a[28:29], v15 offset:28672
s_waitcnt lgkmcnt(14)
ds_read_b64_tr_b16 a[30:31], v15 offset:29696
s_waitcnt lgkmcnt(14)
ds_read_b64_tr_b16 a[32:33], v15 offset:32768
s_waitcnt lgkmcnt(14)
ds_read_b64_tr_b16 a[34:35], v15 offset:33792
s_waitcnt lgkmcnt(14)
ds_read_b64_tr_b16 a[36:37], v15 offset:36864
s_waitcnt lgkmcnt(14)
ds_read_b64_tr_b16 a[38:39], v15 offset:37888
s_waitcnt lgkmcnt(14)
ds_read_b64_tr_b16 a[40:41], v15 offset:40960
s_waitcnt lgkmcnt(14)
ds_read_b64_tr_b16 a[42:43], v15 offset:41984
s_waitcnt lgkmcnt(14)
ds_read_b64_tr_b16 a[44:45], v15 offset:45056
s_waitcnt lgkmcnt(14)
ds_read_b64_tr_b16 a[46:47], v15 offset:46080
s_waitcnt lgkmcnt(14)
ds_read_b64_tr_b16 a[48:49], v15 offset:49152
s_waitcnt lgkmcnt(14)
ds_read_b64_tr_b16 a[50:51], v15 offset:50176
s_waitcnt lgkmcnt(14)
ds_read_b64_tr_b16 a[52:53], v15 offset:53248
s_waitcnt lgkmcnt(14)
ds_read_b64_tr_b16 a[54:55], v15 offset:54272
s_waitcnt lgkmcnt(14)
ds_read_b64_tr_b16 a[56:57], v15 offset:57344
s_waitcnt lgkmcnt(14)
ds_read_b64_tr_b16 a[58:59], v15 offset:58368
s_waitcnt lgkmcnt(14)
ds_read_b64_tr_b16 a[60:61], v15 offset:61440
s_waitcnt lgkmcnt(14)
ds_read_b64_tr_b16 a[62:63], v15 offset:62464
s_waitcnt lgkmcnt(14)
ds_read_b64_tr_b16 a[64:65], v16 offset:0
s_waitcnt lgkmcnt(14)
ds_read_b64_tr_b16 a[66:67], v16 offset:1024
s_waitcnt lgkmcnt(14)
ds_read_b64_tr_b16 a[68:69], v16 offset:4096
s_waitcnt lgkmcnt(14)
ds_read_b64_tr_b16 a[70:71], v16 offset:5120
s_waitcnt lgkmcnt(14)
ds_read_b64_tr_b16 a[72:73], v16 offset:8192
s_waitcnt lgkmcnt(14)
ds_read_b64_tr_b16 a[74:75], v16 offset:9216
s_waitcnt lgkmcnt(14)
ds_read_b64_tr_b16 a[76:77], v16 offset:12288
s_waitcnt lgkmcnt(14)
ds_read_b64_tr_b16 a[78:79], v16 offset:13312
s_waitcnt lgkmcnt(14)
ds_read_b64_tr_b16 a[80:81], v16 offset:16384
s_waitcnt lgkmcnt(14)
ds_read_b64_tr_b16 a[82:83], v16 offset:17408
s_waitcnt lgkmcnt(14)
ds_read_b64_tr_b16 a[84:85], v16 offset:20480
s_waitcnt lgkmcnt(14)
ds_read_b64_tr_b16 a[86:87], v16 offset:21504
s_waitcnt lgkmcnt(14)
ds_read_b64_tr_b16 a[88:89], v16 offset:24576
s_waitcnt lgkmcnt(14)
ds_read_b64_tr_b16 a[90:91], v16 offset:25600
s_waitcnt lgkmcnt(14)
ds_read_b64_tr_b16 a[92:93], v16 offset:28672
s_waitcnt lgkmcnt(14)
ds_read_b64_tr_b16 a[94:95], v16 offset:29696
s_waitcnt lgkmcnt(14)
ds_read_b64_tr_b16 a[96:97], v16 offset:32768
s_waitcnt lgkmcnt(14)
ds_read_b64_tr_b16 a[98:99], v16 offset:33792
s_waitcnt lgkmcnt(14)
ds_read_b64_tr_b16 a[100:101], v16 offset:36864
s_waitcnt lgkmcnt(14)
ds_read_b64_tr_b16 a[102:103], v16 offset:37888
s_waitcnt lgkmcnt(14)
ds_read_b64_tr_b16 a[104:105], v16 offset:40960
s_waitcnt lgkmcnt(14)
ds_read_b64_tr_b16 a[106:107], v16 offset:41984
s_waitcnt lgkmcnt(14)
ds_read_b64_tr_b16 a[108:109], v16 offset:45056
s_waitcnt lgkmcnt(14)
ds_read_b64_tr_b16 a[110:111], v16 offset:46080
s_waitcnt lgkmcnt(14)
ds_read_b64_tr_b16 a[112:113], v16 offset:49152
s_waitcnt lgkmcnt(14)
ds_read_b64_tr_b16 a[114:115], v16 offset:50176
s_waitcnt lgkmcnt(14)
ds_read_b64_tr_b16 a[116:117], v16 offset:53248
s_waitcnt lgkmcnt(14)
ds_read_b64_tr_b16 a[118:119], v16 offset:54272
s_waitcnt lgkmcnt(14)
ds_read_b64_tr_b16 a[120:121], v16 offset:57344
s_waitcnt lgkmcnt(14)
ds_read_b64_tr_b16 a[122:123], v16 offset:58368
s_waitcnt lgkmcnt(14)
ds_read_b64_tr_b16 a[124:125], v16 offset:61440
s_waitcnt lgkmcnt(14)
ds_read_b64_tr_b16 a[126:127], v16 offset:62464
s_waitcnt lgkmcnt(14)
ds_read_b64_tr_b16 a[128:129], v17 offset:0
s_waitcnt lgkmcnt(14)
ds_read_b64_tr_b16 a[130:131], v17 offset:1024
s_waitcnt lgkmcnt(14)
ds_read_b64_tr_b16 a[132:133], v17 offset:4096
s_waitcnt lgkmcnt(14)
ds_read_b64_tr_b16 a[134:135], v17 offset:5120
s_waitcnt lgkmcnt(14)
ds_read_b64_tr_b16 a[136:137], v17 offset:8192
s_waitcnt lgkmcnt(14)
ds_read_b64_tr_b16 a[138:139], v17 offset:9216
s_waitcnt lgkmcnt(14)
ds_read_b64_tr_b16 a[140:141], v17 offset:12288
s_waitcnt lgkmcnt(14)
ds_read_b64_tr_b16 a[142:143], v17 offset:13312
s_waitcnt lgkmcnt(14)
ds_read_b64_tr_b16 a[144:145], v17 offset:16384
s_waitcnt lgkmcnt(14)
ds_read_b64_tr_b16 a[146:147], v17 offset:17408
s_waitcnt lgkmcnt(14)
ds_read_b64_tr_b16 a[148:149], v17 offset:20480
s_waitcnt lgkmcnt(14)
ds_read_b64_tr_b16 a[150:151], v17 offset:21504
s_waitcnt lgkmcnt(14)
ds_read_b64_tr_b16 a[152:153], v17 offset:24576
s_waitcnt lgkmcnt(14)
ds_read_b64_tr_b16 a[154:155], v17 offset:25600
s_waitcnt lgkmcnt(14)
ds_read_b64_tr_b16 a[156:157], v17 offset:28672
s_waitcnt lgkmcnt(14)
ds_read_b64_tr_b16 a[158:159], v17 offset:29696
s_waitcnt lgkmcnt(0)
s_barrier
s_cmp_eq_u32 s32, 0
s_cbranch_scc0 L_wi_V_ok
s_mov_b32 s57, 0
v_and_b32 v4, 63, v0
v_and_b32 v2, 3, v4
v_bfe_u32 v3, v4, 2, 1
v_lshl_add_u32 v2, v3, 5, v2
v_lshlrev_b32 v2, 2, v2
v_cmp_eq_u32 vcc, 8, v4
v_mov_b32 v3, 40
s_nop 0
v_cndmask_b32 v2, v2, v3, vcc
v_cmp_lt_u32 vcc, 8, v4
v_mov_b32 v3, 44
s_nop 0
v_cndmask_b32 v2, v2, v3, vcc
L_wi_V:
global_load_dword v3, v2, s[28:29] sc1
s_waitcnt vmcnt(0)
v_readlane_b32 s58, v3, 0
v_readlane_b32 s59, v3, 1
s_nop 2
s_add_u32 s58, s58, s59
v_readlane_b32 s59, v3, 2
s_nop 2
s_add_u32 s58, s58, s59
v_readlane_b32 s59, v3, 3
s_nop 2
s_add_u32 s58, s58, s59
v_readlane_b32 s59, v3, 4
s_nop 2
s_add_u32 s58, s58, s59
v_readlane_b32 s59, v3, 5
s_nop 2
s_add_u32 s58, s58, s59
v_readlane_b32 s59, v3, 6
s_nop 2
s_add_u32 s58, s58, s59
v_readlane_b32 s59, v3, 7
s_nop 2
s_add_u32 s58, s58, s59
v_readlane_b32 s59, v3, 8
s_nop 2
s_add_u32 s58, s58, s59
s_cmp_ge_u32 s58, 256
s_cbranch_scc1 L_wi_V_ok
s_sleep 8
s_add_u32 s57, s57, 1
s_cmp_lt_u32 s57, 0x20000
s_cbranch_scc1 L_wi_V
s_endpgm
L_wi_V_ok:
s_barrier
v_lshlrev_b32 v9, 6, v1
v_add_u32 v9, 32768, v9
s_mov_b32 s62, 0
s_mov_b32 s63, 0
s_cmp_eq_u32 s62, 1
s_cbranch_scc1 L_V_wx0_sk
s_mov_b32 s57, 0
L_V_wx0:
global_load_dword v10, v9, s[30:31] sc1
s_waitcnt vmcnt(0)
v_cmp_ne_u32 vcc, 0, v10
s_nop 2
s_cmp_eq_u64 vcc, exec
s_cselect_b32 s62, 1, 0
s_bitcmp1_b64 vcc, s63
s_cbranch_scc0 L_V_wx0_s_24
L_V_wx0_sk:
s_mul_i32 s35, s32, 10240
v_lshlrev_b32 v5, 4, v1
v_add_u32 v2, s35, v5
v_add_u32 v3, 4096, v2
v_add_u32 v4, 8192, v2
s_add_u32 s36, s30, 1048576
s_addc_u32 s37, s31, 0
s_mov_b32 s40, s35
s_lshl_b32 s35, s34, 13
s_add_u32 s38, s30, 33554432
s_addc_u32 s39, s31, 0
s_add_u32 s38, s38, s35
s_addc_u32 s39, s39, 0
v_bfe_u32 v10, v1, 4, 1
v_lshlrev_b32 v10, 10, v10
v_lshrrev_b32 v11, 5, v1
v_lshl_add_u32 v10, v11, 8, v10
v_and_b32 v11, 15, v1
v_lshl_add_u32 v10, v11, 4, v10
s_lshl_b32 s35, s32, 11
v_add_u32 v6, s35, v10
s_lshl_b32 s35, s34, 6
s_lshl_b32 s41, s32, 2
s_add_u32 s35, s35, s41
s_add_u32 s35, s35, 4096
v_mov_b32 v7, s35
s_mov_b32 m0, s40
s_nop 0
global_load_lds_dwordx4 v2, s[36:37] offset:0 sc1
global_load_lds_dwordx4 v2, s[36:37] offset:1024 sc1
global_load_lds_dwordx4 v2, s[36:37] offset:2048 sc1
global_load_lds_dwordx4 v2, s[36:37] offset:3072 sc1
s_add_u32 m0, s40, 4096
s_nop 0
global_load_lds_dwordx4 v3, s[36:37] offset:0 sc1
global_load_lds_dwordx4 v3, s[36:37] offset:1024 sc1
global_load_lds_dwordx4 v3, s[36:37] offset:2048 sc1
global_load_lds_dwordx4 v3, s[36:37] offset:3072 sc1
s_add_u32 m0, s40, 8192
s_nop 0
global_load_lds_dwordx4 v4, s[36:37] offset:0 sc1
global_load_lds_dwordx4 v4, s[36:37] offset:1024 sc1
s_mov_b32 s42, 0
s_waitcnt vmcnt(0)
L_V_loop:
s_waitcnt vmcnt(3)
s_barrier
s_add_u32 s63, s42, 1
s_min_u32 s63, s63, 63
s_cmp_eq_u32 s62, 1
s_cbranch_scc1 L_V_wxn_sk
s_mov_b32 s57, 0
L_V_wxn:
global_load_dword v10, v9, s[30:31] sc1
s_waitcnt vmcnt(0)
v_cmp_ne_u32 vcc, 0, v10
s_nop 2
s_cmp_eq_u64 vcc, exec
s_cselect_b32 s62, 1, 0
s_bitcmp1_b64 vcc, s63
s_cbranch_scc0 L_V_wxn_s_25
L_V_wxn_sk:
s_cmp_lt_u32 s42, 63
s_cselect_b32 s35, 40960, 0
s_add_u32 s36, s36, s35
s_addc_u32 s37, s37, 0
s_xor_b32 s43, s42, 1
s_and_b32 s43, s43, 1
s_mul_i32 s43, s43, 40960
s_mul_i32 s40, s32, 10240
s_add_u32 s40, s40, s43
s_mov_b32 m0, s40
s_nop 0
global_load_lds_dwordx4 v2, s[36:37] offset:0 sc1
global_load_lds_dwordx4 v2, s[36:37] offset:1024 sc1
global_load_lds_dwordx4 v2, s[36:37] offset:2048 sc1
global_load_lds_dwordx4 v2, s[36:37] offset:3072 sc1
s_add_u32 m0, s40, 4096
s_nop 0
global_load_lds_dwordx4 v3, s[36:37] offset:0 sc1
global_load_lds_dwordx4 v3, s[36:37] offset:1024 sc1
global_load_lds_dwordx4 v3, s[36:37] offset:2048 sc1
global_load_lds_dwordx4 v3, s[36:37] offset:3072 sc1
s_add_u32 m0, s40, 8192
s_nop 0
global_load_lds_dwordx4 v4, s[36:37] offset:0 sc1
global_load_lds_dwordx4 v4, s[36:37] offset:1024 sc1
ds_read_b128 v[32:35], v5 offset:0
ds_read_b128 v[36:39], v5 offset:1024
ds_read_b128 v[40:43], v5 offset:2048
ds_read_b128 v[44:47], v5 offset:3072
ds_read_b128 v[48:51], v5 offset:4096
ds_read_b128 v[52:55], v5 offset:5120
ds_read_b128 v[56:59], v5 offset:6144
ds_read_b128 v[60:63], v5 offset:7168
s_waitcnt lgkmcnt(7)
v_mfma_f32_32x32x16_bf16 v[16:31], v[32:35], a[0:3], 0
ds_read_b128 v[32:35], v5 offset:8192
s_waitcnt lgkmcnt(7)
v_mfma_f32_32x32x16_bf16 v[16:31], v[36:39], a[4:7], v[16:31]
ds_read_b128 v[36:39], v5 offset:9216
s_waitcnt lgkmcnt(7)
v_mfma_f32_32x32x16_bf16 v[16:31], v[40:43], a[8:11], v[16:31]
ds_read_b128 v[40:43], v5 offset:10240
s_waitcnt lgkmcnt(7)
v_mfma_f32_32x32x16_bf16 v[16:31], v[44:47], a[12:15], v[16:31]
ds_read_b128 v[44:47], v5 offset:11264
s_waitcnt lgkmcnt(7)
v_mfma_f32_32x32x16_bf16 v[16:31], v[48:51], a[16:19], v[16:31]
ds_read_b128 v[48:51], v5 offset:12288
s_waitcnt lgkmcnt(7)
v_mfma_f32_32x32x16_bf16 v[16:31], v[52:55], a[20:23], v[16:31]
ds_read_b128 v[52:55], v5 offset:13312
s_waitcnt lgkmcnt(7)
v_mfma_f32_32x32x16_bf16 v[16:31], v[56:59], a[24:27], v[16:31]
ds_read_b128 v[56:59], v5 offset:14336
s_waitcnt lgkmcnt(7)
v_mfma_f32_32x32x16_bf16 v[16:31], v[60:63], a[28:31], v[16:31]
ds_read_b128 v[60:63], v5 offset:15360
s_waitcnt lgkmcnt(7)
v_mfma_f32_32x32x16_bf16 v[16:31], v[32:35], a[32:35], v[16:31]
ds_read_b128 v[32:35], v5 offset:16384
s_waitcnt lgkmcnt(7)
v_mfma_f32_32x32x16_bf16 v[16:31], v[36:39], a[36:39], v[16:31]
ds_read_b128 v[36:39], v5 offset:17408
s_waitcnt lgkmcnt(7)
v_mfma_f32_32x32x16_bf16 v[16:31], v[40:43], a[40:43], v[16:31]
ds_read_b128 v[40:43], v5 offset:18432
s_waitcnt lgkmcnt(7)
v_mfma_f32_32x32x16_bf16 v[16:31], v[44:47], a[44:47], v[16:31]
ds_read_b128 v[44:47], v5 offset:19456
s_waitcnt lgkmcnt(7)
v_mfma_f32_32x32x16_bf16 v[16:31], v[48:51], a[48:51], v[16:31]
ds_read_b128 v[48:51], v5 offset:20480
s_waitcnt lgkmcnt(7)
v_mfma_f32_32x32x16_bf16 v[16:31], v[52:55], a[52:55], v[16:31]
ds_read_b128 v[52:55], v5 offset:21504
s_waitcnt lgkmcnt(7)
v_mfma_f32_32x32x16_bf16 v[16:31], v[56:59], a[56:59], v[16:31]
ds_read_b128 v[56:59], v5 offset:22528
s_waitcnt lgkmcnt(7)
v_mfma_f32_32x32x16_bf16 v[16:31], v[60:63], a[60:63], v[16:31]
ds_read_b128 v[60:63], v5 offset:23552
s_waitcnt lgkmcnt(7)
v_mfma_f32_32x32x16_bf16 v[16:31], v[32:35], a[64:67], v[16:31]
ds_read_b128 v[32:35], v5 offset:24576
s_waitcnt lgkmcnt(7)
v_mfma_f32_32x32x16_bf16 v[16:31], v[36:39], a[68:71], v[16:31]
ds_read_b128 v[36:39], v5 offset:25600
s_waitcnt lgkmcnt(7)
v_mfma_f32_32x32x16_bf16 v[16:31], v[40:43], a[72:75], v[16:31]
ds_read_b128 v[40:43], v5 offset:26624
s_waitcnt lgkmcnt(7)
v_mfma_f32_32x32x16_bf16 v[16:31], v[44:47], a[76:79], v[16:31]
ds_read_b128 v[44:47], v5 offset:27648
s_waitcnt lgkmcnt(7)
v_mfma_f32_32x32x16_bf16 v[16:31], v[48:51], a[80:83], v[16:31]
ds_read_b128 v[48:51], v5 offset:28672
s_waitcnt lgkmcnt(7)
v_mfma_f32_32x32x16_bf16 v[16:31], v[52:55], a[84:87], v[16:31]
ds_read_b128 v[52:55], v5 offset:29696
s_waitcnt lgkmcnt(7)
v_mfma_f32_32x32x16_bf16 v[16:31], v[56:59], a[88:91], v[16:31]
ds_read_b128 v[56:59], v5 offset:30720
s_waitcnt lgkmcnt(7)
v_mfma_f32_32x32x16_bf16 v[16:31], v[60:63], a[92:95], v[16:31]
ds_read_b128 v[60:63], v5 offset:31744
s_waitcnt lgkmcnt(7)
v_mfma_f32_32x32x16_bf16 v[16:31], v[32:35], a[96:99], v[16:31]
ds_read_b128 v[32:35], v5 offset:32768
s_waitcnt lgkmcnt(7)
v_mfma_f32_32x32x16_bf16 v[16:31], v[36:39], a[100:103], v[16:31]
ds_read_b128 v[36:39], v5 offset:33792
s_waitcnt lgkmcnt(7)
v_mfma_f32_32x32x16_bf16 v[16:31], v[40:43], a[104:107], v[16:31]
ds_read_b128 v[40:43], v5 offset:34816
s_waitcnt lgkmcnt(7)
v_mfma_f32_32x32x16_bf16 v[16:31], v[44:47], a[108:111], v[16:31]
ds_read_b128 v[44:47], v5 offset:35840
s_waitcnt lgkmcnt(7)
v_mfma_f32_32x32x16_bf16 v[16:31], v[48:51], a[112:115], v[16:31]
ds_read_b128 v[48:51], v5 offset:36864
s_waitcnt lgkmcnt(7)
v_mfma_f32_32x32x16_bf16 v[16:31], v[52:55], a[116:119], v[16:31]
ds_read_b128 v[52:55], v5 offset:37888
s_waitcnt lgkmcnt(7)
v_mfma_f32_32x32x16_bf16 v[16:31], v[56:59], a[120:123], v[16:31]
ds_read_b128 v[56:59], v5 offset:38912
s_waitcnt lgkmcnt(7)
v_mfma_f32_32x32x16_bf16 v[16:31], v[60:63], a[124:127], v[16:31]
ds_read_b128 v[60:63], v5 offset:39936
s_waitcnt lgkmcnt(7)
v_mfma_f32_32x32x16_bf16 v[16:31], v[32:35], a[128:131], v[16:31]
s_waitcnt lgkmcnt(6)
v_mfma_f32_32x32x16_bf16 v[16:31], v[36:39], a[132:135], v[16:31]
s_waitcnt lgkmcnt(5)
v_mfma_f32_32x32x16_bf16 v[16:31], v[40:43], a[136:139], v[16:31]
s_waitcnt lgkmcnt(4)
v_mfma_f32_32x32x16_bf16 v[16:31], v[44:47], a[140:143], v[16:31]
s_waitcnt lgkmcnt(3)
v_mfma_f32_32x32x16_bf16 v[16:31], v[48:51], a[144:147], v[16:31]
s_waitcnt lgkmcnt(2)
v_mfma_f32_32x32x16_bf16 v[16:31], v[52:55], a[148:151], v[16:31]
s_waitcnt lgkmcnt(1)
v_mfma_f32_32x32x16_bf16 v[16:31], v[56:59], a[152:155], v[16:31]
s_waitcnt lgkmcnt(0)
v_mfma_f32_32x32x16_bf16 v[16:31], v[60:63], a[156:159], v[16:31]
v_xor_b32 v5, 0xa000, v5
s_waitcnt vmcnt(10)
s_mov_b64 exec, 1
v_mov_b32 v8, s42
global_store_dword v7, v8, s[30:31] sc1
s_mov_b64 exec, -1
s_nop 5
v_cvt_pk_bf16_f32 v64, v16, v17
v_cvt_pk_bf16_f32 v65, v18, v19
v_cvt_pk_bf16_f32 v66, v24, v25
v_cvt_pk_bf16_f32 v67, v26, v27
v_cvt_pk_bf16_f32 v68, v20, v21
v_cvt_pk_bf16_f32 v69, v22, v23
v_cvt_pk_bf16_f32 v70, v28, v29
v_cvt_pk_bf16_f32 v71, v30, v31
global_store_dwordx4 v6, v[64:67], s[38:39] sc1
global_store_dwordx4 v6, v[68:71], s[38:39] offset:512 sc1
s_cmp_eq_u32 s42, 0
s_cbranch_scc0 L_V_nf0
s_waitcnt vmcnt(0)
s_mov_b64 exec, 1
v_mov_b32 v8, 1
global_store_dword v7, v8, s[30:31] sc1
s_mov_b64 exec, -1
s_waitcnt vmcnt(0)
L_V_nf0:
s_add_u32 s38, s38, 262144
s_addc_u32 s39, s39, 0
s_add_u32 s42, s42, 1
s_cmp_lt_u32 s42, 64
s_cbranch_scc1 L_V_loop
s_waitcnt vmcnt(0)
s_mov_b64 exec, 1
v_mov_b32 v8, 64
global_store_dword v7, v8, s[30:31] sc1
s_mov_b64 exec, -1
s_waitcnt vmcnt(0)
s_endpgm
L_V_wx0_s_24:
s_sleep 2
s_add_u32 s57, s57, 1
s_cmp_lt_u32 s57, 262144
s_cbranch_scc1 L_V_wx0
s_endpgm
L_V_wxn_s_25:
s_sleep 2
s_add_u32 s57, s57, 1
s_cmp_lt_u32 s57, 262144
s_cbranch_scc1 L_V_wxn
s_endpgm
L_Q:
v_and_b32 v1, 63, v0
s_cmp_eq_u32 s34, 0
s_cbranch_scc0 L_Q_noprobe
s_cmp_eq_u32 s32, 0
s_cbranch_scc0 L_Q_probed
s_mov_b64 exec, 1
v_mov_b32 v3, -1
v_mov_b32 v2, 4333056
s_mov_b32 s40, -1
global_store_dword v2, v3, s[30:31] sc1
s_waitcnt vmcnt(0)
s_memtime s[42:43]
s_waitcnt lgkmcnt(0)
global_load_dword v4, v2, s[30:31] sc1
s_waitcnt vmcnt(0)
s_memtime s[44:45]
s_waitcnt lgkmcnt(0)
s_sub_u32 s46, s44, s42
s_min_u32 s40, s40, s46
global_store_dword v2, v3, s[30:31] sc1
s_waitcnt vmcnt(0)
s_memtime s[42:43]
s_waitcnt lgkmcnt(0)
global_load_dword v4, v2, s[30:31] sc1
s_waitcnt vmcnt(0)
s_memtime s[44:45]
s_waitcnt lgkmcnt(0)
s_sub_u32 s46, s44, s42
s_min_u32 s40, s40, s46
global_store_dword v2, v3, s[30:31] sc1
s_waitcnt vmcnt(0)
s_memtime s[42:43]
s_waitcnt lgkmcnt(0)
global_load_dword v4, v2, s[30:31] sc1
s_waitcnt vmcnt(0)
s_memtime s[44:45]
s_waitcnt lgkmcnt(0)
s_sub_u32 s46, s44, s42
s_min_u32 s40, s40, s46
v_mov_b32 v2, 4341248
s_mov_b32 s41, -1
global_store_dword v2, v3, s[30:31] sc1
s_waitcnt vmcnt(0)
s_memtime s[42:43]
s_waitcnt lgkmcnt(0)
global_load_dword v4, v2, s[30:31] sc1
s_waitcnt vmcnt(0)
s_memtime s[44:45]
s_waitcnt lgkmcnt(0)
s_sub_u32 s46, s44, s42
s_min_u32 s41, s41, s46
global_store_dword v2, v3, s[30:31] sc1
s_waitcnt vmcnt(0)
s_memtime s[42:43]
s_waitcnt lgkmcnt(0)
global_load_dword v4, v2, s[30:31] sc1
s_waitcnt vmcnt(0)
s_memtime s[44:45]
s_waitcnt lgkmcnt(0)
s_sub_u32 s46, s44, s42
s_min_u32 s41, s41, s46
global_store_dword v2, v3, s[30:31] sc1
s_waitcnt vmcnt(0)
s_memtime s[42:43]
s_waitcnt lgkmcnt(0)
global_load_dword v4, v2, s[30:31] sc1
s_waitcnt vmcnt(0)
s_memtime s[44:45]
s_waitcnt lgkmcnt(0)
s_sub_u32 s46, s44, s42
s_min_u32 s41, s41, s46
s_cmp_lt_u32 s41, s40
s_cselect_b32 s40, 2, 1
v_mov_b32 v2, 44
v_mov_b32 v3, s40
global_store_dword v2, v3, s[28:29] sc1
s_waitcnt vmcnt(0)
s_mov_b64 exec, -1
L_Q_probed:
s_barrier
L_Q_noprobe:
s_cmp_eq_u32 s32, 0
s_cbranch_scc0 L_wi_Q_ok
s_mov_b32 s57, 0
v_and_b32 v4, 63, v0
v_and_b32 v2, 3, v4
v_bfe_u32 v3, v4, 2, 1
v_lshl_add_u32 v2, v3, 5, v2
v_lshlrev_b32 v2, 2, v2
v_cmp_eq_u32 vcc, 8, v4
v_mov_b32 v3, 40
s_nop 0
v_cndmask_b32 v2, v2, v3, vcc
v_cmp_lt_u32 vcc, 8, v4
v_mov_b32 v3, 44
s_nop 0
v_cndmask_b32 v2, v2, v3, vcc
L_wi_Q:
global_load_dword v3, v2, s[28:29] sc1
s_waitcnt vmcnt(0)
v_readlane_b32 s58, v3, 0
v_readlane_b32 s59, v3, 1
s_nop 2
s_add_u32 s58, s58, s59
v_readlane_b32 s59, v3, 2
s_nop 2
s_add_u32 s58, s58, s59
v_readlane_b32 s59, v3, 3
s_nop 2
s_add_u32 s58, s58, s59
v_readlane_b32 s59, v3, 4
s_nop 2
s_add_u32 s58, s58, s59
v_readlane_b32 s59, v3, 5
s_nop 2
s_add_u32 s58, s58, s59
v_readlane_b32 s59, v3, 6
s_nop 2
s_add_u32 s58, s58, s59
v_readlane_b32 s59, v3, 7
s_nop 2
s_add_u32 s58, s58, s59
v_readlane_b32 s59, v3, 8
s_nop 2
s_add_u32 s58, s58, s59
s_cmp_ge_u32 s58, 256
s_cbranch_scc1 L_wi_Q_ok
s_sleep 32
s_add_u32 s57, s57, 1
s_cmp_lt_u32 s57, 0x20000
s_cbranch_scc1 L_wi_Q
s_endpgm
L_wi_Q_ok:
s_barrier
s_cmp_eq_u32 s32, 0
s_cbranch_scc0 L_wfk_Q_ok
s_mov_b32 s57, 0
v_mov_b32 v2, 0
L_wfk_Q:
global_load_dword v3, v2, s[30:31] sc1
s_waitcnt vmcnt(0)
v_readfirstlane_b32 s58, v3
s_nop 2
s_cmp_ge_u32 s58, 1
s_cbranch_scc1 L_wfk_Q_ok
s_sleep 16
s_add_u32 s57, s57, 1
s_cmp_lt_u32 s57, 0x4000
s_cbranch_scc1 L_wfk_Q
L_wfk_Q_ok:
s_barrier
s_lshl_b32 s35, s34, 8
s_add_u32 s36, s12, s35
s_addc_u32 s37, s13, 0
s_mul_i32 s35, s32, 1310720
s_add_u32 s36, s36, s35
s_addc_u32 s37, s37, 0
v_lshrrev_b32 v4, 4, v1
v_and_b32 v5, 15, v1
v_lshrrev_b32 v6, 1, v5
v_lshlrev_b32 v7, 1, v4
v_xor_b32 v6, v6, v7
v_and_b32 v5, 1, v5
v_lshl_add_u32 v6, v6, 1, v5
s_mov_b32 s35, 8192
v_mul_lo_u32 v2, v4, s35
v_lshl_add_u32 v2, v6, 4, v2
s_mul_i32 s40, s32, 40960
s_mov_b32 m0, s40
s_nop 0
global_load_lds_dwordx4 v2, s[36:37]
s_add_u32 s40, s40, 1024
s_add_u32 s36, s36, 32768
s_addc_u32 s37, s37, 0
s_mov_b32 m0, s40
s_nop 0
global_load_lds_dwordx4 v2, s[36:37]
s_add_u32 s40, s40, 1024
s_add_u32 s36, s36, 32768
s_addc_u32 s37, s37, 0
s_mov_b32 m0, s40
s_nop 0
global_load_lds_dwordx4 v2, s[36:37]
s_add_u32 s40, s40, 1024
s_add_u32 s36, s36, 32768
s_addc_u32 s37, s37, 0
s_mov_b32 m0, s40
s_nop 0
global_load_lds_dwordx4 v2, s[36:37]
s_add_u32 s40, s40, 1024
s_add_u32 s36, s36, 32768
s_addc_u32 s37, s37, 0
s_mov_b32 m0, s40
s_nop 0
global_load_lds_dwordx4 v2, s[36:37]
s_add_u32 s40, s40, 1024
s_add_u32 s36, s36, 32768
s_addc_u32 s37, s37, 0
s_mov_b32 m0, s40
s_nop 0
global_load_lds_dwordx4 v2, s[36:37]
s_add_u32 s40, s40, 1024
s_add_u32 s36, s36, 32768
s_addc_u32 s37, s37, 0
s_mov_b32 m0, s40
s_nop 0
global_load_lds_dwordx4 v2, s[36:37]
s_add_u32 s40, s40, 1024
s_add_u32 s36, s36, 32768
s_addc_u32 s37, s37, 0
s_mov_b32 m0, s40
s_nop 0
global_load_lds_dwordx4 v2, s[36:37]
s_add_u32 s40, s40, 1024
s_add_u32 s36, s36, 32768
s_addc_u32 s37, s37, 0
s_mov_b32 m0, s40
s_nop 0
global_load_lds_dwordx4 v2, s[36:37]
s_add_u32 s40, s40, 1024
s_add_u32 s36, s36, 32768
s_addc_u32 s37, s37, 0
s_mov_b32 m0, s40
s_nop 0
global_load_lds_dwordx4 v2, s[36:37]
s_add_u32 s40, s40, 1024
s_add_u32 s36, s36, 32768
s_addc_u32 s37, s37, 0
s_mov_b32 m0, s40
s_nop 0
global_load_lds_dwordx4 v2, s[36:37]
s_add_u32 s40, s40, 1024
s_add_u32 s36, s36, 32768
s_addc_u32 s37, s37, 0
s_mov_b32 m0, s40
s_nop 0
global_load_lds_dwordx4 v2, s[36:37]
s_add_u32 s40, s40, 1024
s_add_u32 s36, s36, 32768
s_addc_u32 s37, s37, 0
s_mov_b32 m0, s40
s_nop 0
global_load_lds_dwordx4 v2, s[36:37]
s_add_u32 s40, s40, 1024
s_add_u32 s36, s36, 32768
s_addc_u32 s37, s37, 0
s_mov_b32 m0, s40
s_nop 0
global_load_lds_dwordx4 v2, s[36:37]
s_add_u32 s40, s40, 1024
s_add_u32 s36, s36, 32768
s_addc_u32 s37, s37, 0
s_mov_b32 m0, s40
s_nop 0
global_load_lds_dwordx4 v2, s[36:37]
s_add_u32 s40, s40, 1024
s_add_u32 s36, s36, 32768
s_addc_u32 s37, s37, 0
s_mov_b32 m0, s40
s_nop 0
global_load_lds_dwordx4 v2, s[36:37]
s_add_u32 s40, s40, 1024
s_add_u32 s36, s36, 32768
s_addc_u32 s37, s37, 0
s_mov_b32 m0, s40
s_nop 0
global_load_lds_dwordx4 v2, s[36:37]
s_add_u32 s40, s40, 1024
s_add_u32 s36, s36, 32768
s_addc_u32 s37, s37, 0
s_mov_b32 m0, s40
s_nop 0
global_load_lds_dwordx4 v2, s[36:37]
s_add_u32 s40, s40, 1024
s_add_u32 s36, s36, 32768
s_addc_u32 s37, s37, 0
s_mov_b32 m0, s40
s_nop 0
global_load_lds_dwordx4 v2, s[36:37]
s_add_u32 s40, s40, 1024
s_add_u32 s36, s36, 32768
s_addc_u32 s37, s37, 0
s_mov_b32 m0, s40
s_nop 0
global_load_lds_dwordx4 v2, s[36:37]
s_add_u32 s40, s40, 1024
s_add_u32 s36, s36, 32768
s_addc_u32 s37, s37, 0
s_mov_b32 m0, s40
s_nop 0
global_load_lds_dwordx4 v2, s[36:37]
s_add_u32 s40, s40, 1024
s_add_u32 s36, s36, 32768
s_addc_u32 s37, s37, 0
s_mov_b32 m0, s40
s_nop 0
global_load_lds_dwordx4 v2, s[36:37]
s_add_u32 s40, s40, 1024
s_add_u32 s36, s36, 32768
s_addc_u32 s37, s37, 0
s_mov_b32 m0, s40
s_nop 0
global_load_lds_dwordx4 v2, s[36:37]
s_add_u32 s40, s40, 1024
s_add_u32 s36, s36, 32768
s_addc_u32 s37, s37, 0
s_mov_b32 m0, s40
s_nop 0
global_load_lds_dwordx4 v2, s[36:37]
s_add_u32 s40, s40, 1024
s_add_u32 s36, s36, 32768
s_addc_u32 s37, s37, 0
s_mov_b32 m0, s40
s_nop 0
global_load_lds_dwordx4 v2, s[36:37]
s_add_u32 s40, s40, 1024
s_add_u32 s36, s36, 32768
s_addc_u32 s37, s37, 0
s_mov_b32 m0, s40
s_nop 0
global_load_lds_dwordx4 v2, s[36:37]
s_add_u32 s40, s40, 1024
s_add_u32 s36, s36, 32768
s_addc_u32 s37, s37, 0
s_mov_b32 m0, s40
s_nop 0
global_load_lds_dwordx4 v2, s[36:37]
s_add_u32 s40, s40, 1024
s_add_u32 s36, s36, 32768
s_addc_u32 s37, s37, 0
s_mov_b32 m0, s40
s_nop 0
global_load_lds_dwordx4 v2, s[36:37]
s_add_u32 s40, s40, 1024
s_add_u32 s36, s36, 32768
s_addc_u32 s37, s37, 0
s_mov_b32 m0, s40
s_nop 0
global_load_lds_dwordx4 v2, s[36:37]
s_add_u32 s40, s40, 1024
s_add_u32 s36, s36, 32768
s_addc_u32 s37, s37, 0
s_mov_b32 m0, s40
s_nop 0
global_load_lds_dwordx4 v2, s[36:37]
s_add_u32 s40, s40, 1024
s_add_u32 s36, s36, 32768
s_addc_u32 s37, s37, 0
s_mov_b32 m0, s40
s_nop 0
global_load_lds_dwordx4 v2, s[36:37]
s_add_u32 s40, s40, 1024
s_add_u32 s36, s36, 32768
s_addc_u32 s37, s37, 0
s_mov_b32 m0, s40
s_nop 0
global_load_lds_dwordx4 v2, s[36:37]
s_add_u32 s40, s40, 1024
s_add_u32 s36, s36, 32768
s_addc_u32 s37, s37, 0
s_mov_b32 m0, s40
s_nop 0
global_load_lds_dwordx4 v2, s[36:37]
s_add_u32 s40, s40, 1024
s_add_u32 s36, s36, 32768
s_addc_u32 s37, s37, 0
s_mov_b32 m0, s40
s_nop 0
global_load_lds_dwordx4 v2, s[36:37]
s_add_u32 s40, s40, 1024
s_add_u32 s36, s36, 32768
s_addc_u32 s37, s37, 0
s_mov_b32 m0, s40
s_nop 0
global_load_lds_dwordx4 v2, s[36:37]
s_add_u32 s40, s40, 1024
s_add_u32 s36, s36, 32768
s_addc_u32 s37, s37, 0
s_mov_b32 m0, s40
s_nop 0
global_load_lds_dwordx4 v2, s[36:37]
s_add_u32 s40, s40, 1024
s_add_u32 s36, s36, 32768
s_addc_u32 s37, s37, 0
s_mov_b32 m0, s40
s_nop 0
global_load_lds_dwordx4 v2, s[36:37]
s_add_u32 s40, s40, 1024
s_add_u32 s36, s36, 32768
s_addc_u32 s37, s37, 0
s_mov_b32 m0, s40
s_nop 0
global_load_lds_dwordx4 v2, s[36:37]
s_add_u32 s40, s40, 1024
s_add_u32 s36, s36, 32768
s_addc_u32 s37, s37, 0
s_mov_b32 m0, s40
s_nop 0
global_load_lds_dwordx4 v2, s[36:37]
s_add_u32 s40, s40, 1024
s_add_u32 s36, s36, 32768
s_addc_u32 s37, s37, 0
s_mov_b32 m0, s40
s_nop 0
global_load_lds_dwordx4 v2, s[36:37]
s_add_u32 s40, s40, 1024
s_add_u32 s36, s36, 32768
s_addc_u32 s37, s37, 0
v_lshrrev_b32 v10, 5, v1
v_bfe_u32 v11, v1, 2, 2
v_lshl_add_u32 v12, v10, 3, v11
v_lshlrev_b32 v12, 8, v12
v_bfe_u32 v13, v1, 4, 1
s_lshl_b32 s35, s32, 1
v_add_u32 v13, s35, v13
v_lshlrev_b32 v14, 1, v11
v_xor_b32 v13, v13, v14
v_lshl_add_u32 v12, v13, 5, v12
v_and_b32 v13, 3, v1
v_lshl_add_u32 v15, v13, 3, v12
v_add_u32 v16, 0x10000, v15
v_add_u32 v17, 0x20000, v15
s_waitcnt vmcnt(0)
s_barrier
ds_read_b64_tr_b16 a[0:1], v15 offset:0
ds_read_b64_tr_b16 a[2:3], v15 offset:1024
ds_read_b64_tr_b16 a[4:5], v15 offset:4096
ds_read_b64_tr_b16 a[6:7], v15 offset:5120
ds_read_b64_tr_b16 a[8:9], v15 offset:8192
ds_read_b64_tr_b16 a[10:11], v15 offset:9216
ds_read_b64_tr_b16 a[12:13], v15 offset:12288
ds_read_b64_tr_b16 a[14:15], v15 offset:13312
ds_read_b64_tr_b16 a[16:17], v15 offset:16384
ds_read_b64_tr_b16 a[18:19], v15 offset:17408
ds_read_b64_tr_b16 a[20:21], v15 offset:20480
ds_read_b64_tr_b16 a[22:23], v15 offset:21504
ds_read_b64_tr_b16 a[24:25], v15 offset:24576
ds_read_b64_tr_b16 a[26:27], v15 offset:25600
ds_read_b64_tr_b16 a[28:29], v15 offset:28672
s_waitcnt lgkmcnt(14)
ds_read_b64_tr_b16 a[30:31], v15 offset:29696
s_waitcnt lgkmcnt(14)
ds_read_b64_tr_b16 a[32:33], v15 offset:32768
s_waitcnt lgkmcnt(14)
ds_read_b64_tr_b16 a[34:35], v15 offset:33792
s_waitcnt lgkmcnt(14)
ds_read_b64_tr_b16 a[36:37], v15 offset:36864
s_waitcnt lgkmcnt(14)
ds_read_b64_tr_b16 a[38:39], v15 offset:37888
s_waitcnt lgkmcnt(14)
ds_read_b64_tr_b16 a[40:41], v15 offset:40960
s_waitcnt lgkmcnt(14)
ds_read_b64_tr_b16 a[42:43], v15 offset:41984
s_waitcnt lgkmcnt(14)
ds_read_b64_tr_b16 a[44:45], v15 offset:45056
s_waitcnt lgkmcnt(14)
ds_read_b64_tr_b16 a[46:47], v15 offset:46080
s_waitcnt lgkmcnt(14)
ds_read_b64_tr_b16 a[48:49], v15 offset:49152
s_waitcnt lgkmcnt(14)
ds_read_b64_tr_b16 a[50:51], v15 offset:50176
s_waitcnt lgkmcnt(14)
ds_read_b64_tr_b16 a[52:53], v15 offset:53248
s_waitcnt lgkmcnt(14)
ds_read_b64_tr_b16 a[54:55], v15 offset:54272
s_waitcnt lgkmcnt(14)
ds_read_b64_tr_b16 a[56:57], v15 offset:57344
s_waitcnt lgkmcnt(14)
ds_read_b64_tr_b16 a[58:59], v15 offset:58368
s_waitcnt lgkmcnt(14)
ds_read_b64_tr_b16 a[60:61], v15 offset:61440
s_waitcnt lgkmcnt(14)
ds_read_b64_tr_b16 a[62:63], v15 offset:62464
s_waitcnt lgkmcnt(14)
ds_read_b64_tr_b16 a[64:65], v16 offset:0
s_waitcnt lgkmcnt(14)
ds_read_b64_tr_b16 a[66:67], v16 offset:1024
s_waitcnt lgkmcnt(14)
ds_read_b64_tr_b16 a[68:69], v16 offset:4096
s_waitcnt lgkmcnt(14)
ds_read_b64_tr_b16 a[70:71], v16 offset:5120
s_waitcnt lgkmcnt(14)
ds_read_b64_tr_b16 a[72:73], v16 offset:8192
s_waitcnt lgkmcnt(14)
ds_read_b64_tr_b16 a[74:75], v16 offset:9216
s_waitcnt lgkmcnt(14)
ds_read_b64_tr_b16 a[76:77], v16 offset:12288
s_waitcnt lgkmcnt(14)
ds_read_b64_tr_b16 a[78:79], v16 offset:13312
s_waitcnt lgkmcnt(14)
ds_read_b64_tr_b16 a[80:81], v16 offset:16384
s_waitcnt lgkmcnt(14)
ds_read_b64_tr_b16 a[82:83], v16 offset:17408
s_waitcnt lgkmcnt(14)
ds_read_b64_tr_b16 a[84:85], v16 offset:20480
s_waitcnt lgkmcnt(14)
ds_read_b64_tr_b16 a[86:87], v16 offset:21504
s_waitcnt lgkmcnt(14)
ds_read_b64_tr_b16 a[88:89], v16 offset:24576
s_waitcnt lgkmcnt(14)
ds_read_b64_tr_b16 a[90:91], v16 offset:25600
s_waitcnt lgkmcnt(14)
ds_read_b64_tr_b16 a[92:93], v16 offset:28672
s_waitcnt lgkmcnt(14)
ds_read_b64_tr_b16 a[94:95], v16 offset:29696
s_waitcnt lgkmcnt(14)
ds_read_b64_tr_b16 a[96:97], v16 offset:32768
s_waitcnt lgkmcnt(14)
ds_read_b64_tr_b16 a[98:99], v16 offset:33792
s_waitcnt lgkmcnt(14)
ds_read_b64_tr_b16 a[100:101], v16 offset:36864
s_waitcnt lgkmcnt(14)
ds_read_b64_tr_b16 a[102:103], v16 offset:37888
s_waitcnt lgkmcnt(14)
ds_read_b64_tr_b16 a[104:105], v16 offset:40960
s_waitcnt lgkmcnt(14)
ds_read_b64_tr_b16 a[106:107], v16 offset:41984
s_waitcnt lgkmcnt(14)
ds_read_b64_tr_b16 a[108:109], v16 offset:45056
s_waitcnt lgkmcnt(14)
ds_read_b64_tr_b16 a[110:111], v16 offset:46080
s_waitcnt lgkmcnt(14)
ds_read_b64_tr_b16 a[112:113], v16 offset:49152
s_waitcnt lgkmcnt(14)
ds_read_b64_tr_b16 a[114:115], v16 offset:50176
s_waitcnt lgkmcnt(14)
ds_read_b64_tr_b16 a[116:117], v16 offset:53248
s_waitcnt lgkmcnt(14)
ds_read_b64_tr_b16 a[118:119], v16 offset:54272
s_waitcnt lgkmcnt(14)
ds_read_b64_tr_b16 a[120:121], v16 offset:57344
s_waitcnt lgkmcnt(14)
ds_read_b64_tr_b16 a[122:123], v16 offset:58368
s_waitcnt lgkmcnt(14)
ds_read_b64_tr_b16 a[124:125], v16 offset:61440
s_waitcnt lgkmcnt(14)
ds_read_b64_tr_b16 a[126:127], v16 offset:62464
s_waitcnt lgkmcnt(14)
ds_read_b64_tr_b16 a[128:129], v17 offset:0
s_waitcnt lgkmcnt(14)
ds_read_b64_tr_b16 a[130:131], v17 offset:1024
s_waitcnt lgkmcnt(14)
ds_read_b64_tr_b16 a[132:133], v17 offset:4096
s_waitcnt lgkmcnt(14)
ds_read_b64_tr_b16 a[134:135], v17 offset:5120
s_waitcnt lgkmcnt(14)
ds_read_b64_tr_b16 a[136:137], v17 offset:8192
s_waitcnt lgkmcnt(14)
ds_read_b64_tr_b16 a[138:139], v17 offset:9216
s_waitcnt lgkmcnt(14)
ds_read_b64_tr_b16 a[140:141], v17 offset:12288
s_waitcnt lgkmcnt(14)
ds_read_b64_tr_b16 a[142:143], v17 offset:13312
s_waitcnt lgkmcnt(14)
ds_read_b64_tr_b16 a[144:145], v17 offset:16384
s_waitcnt lgkmcnt(14)
ds_read_b64_tr_b16 a[146:147], v17 offset:17408
s_waitcnt lgkmcnt(14)
ds_read_b64_tr_b16 a[148:149], v17 offset:20480
s_waitcnt lgkmcnt(14)
ds_read_b64_tr_b16 a[150:151], v17 offset:21504
s_waitcnt lgkmcnt(14)
ds_read_b64_tr_b16 a[152:153], v17 offset:24576
s_waitcnt lgkmcnt(14)
ds_read_b64_tr_b16 a[154:155], v17 offset:25600
s_waitcnt lgkmcnt(14)
ds_read_b64_tr_b16 a[156:157], v17 offset:28672
s_waitcnt lgkmcnt(14)
ds_read_b64_tr_b16 a[158:159], v17 offset:29696
s_waitcnt lgkmcnt(0)
s_barrier
v_lshlrev_b32 v9, 6, v1
v_add_u32 v9, 32768, v9
s_mov_b32 s62, 0
s_mov_b32 s63, 0
s_cmp_eq_u32 s62, 1
s_cbranch_scc1 L_Q_wx0_sk
s_mov_b32 s57, 0
L_Q_wx0:
global_load_dword v10, v9, s[30:31] sc1
s_waitcnt vmcnt(0)
v_cmp_ne_u32 vcc, 0, v10
s_nop 2
s_cmp_eq_u64 vcc, exec
s_cselect_b32 s62, 1, 0
s_bitcmp1_b64 vcc, s63
s_cbranch_scc0 L_Q_wx0_s_26
L_Q_wx0_sk:
s_mul_i32 s35, s32, 10240
v_lshlrev_b32 v5, 4, v1
v_add_u32 v2, s35, v5
v_add_u32 v3, 4096, v2
v_add_u32 v4, 8192, v2
s_add_u32 s36, s30, 1048576
s_addc_u32 s37, s31, 0
s_mov_b32 s40, s35
s_lshl_b32 s35, s34, 13
s_add_u32 s38, s30, 50331648
s_addc_u32 s39, s31, 0
s_add_u32 s38, s38, s35
s_addc_u32 s39, s39, 0
v_bfe_u32 v10, v1, 4, 1
v_lshlrev_b32 v10, 10, v10
v_lshrrev_b32 v11, 5, v1
v_lshl_add_u32 v10, v11, 8, v10
v_and_b32 v11, 15, v1
v_lshl_add_u32 v10, v11, 4, v10
s_lshl_b32 s35, s32, 11
v_add_u32 v6, s35, v10
s_lshl_b32 s35, s34, 6
s_lshl_b32 s41, s32, 2
s_add_u32 s35, s35, s41
s_add_u32 s35, s35, 8192
v_mov_b32 v7, s35
s_mov_b32 m0, s40
s_nop 0
global_load_lds_dwordx4 v2, s[36:37] offset:0 sc1
global_load_lds_dwordx4 v2, s[36:37] offset:1024 sc1
global_load_lds_dwordx4 v2, s[36:37] offset:2048 sc1
global_load_lds_dwordx4 v2, s[36:37] offset:3072 sc1
s_add_u32 m0, s40, 4096
s_nop 0
global_load_lds_dwordx4 v3, s[36:37] offset:0 sc1
global_load_lds_dwordx4 v3, s[36:37] offset:1024 sc1
global_load_lds_dwordx4 v3, s[36:37] offset:2048 sc1
global_load_lds_dwordx4 v3, s[36:37] offset:3072 sc1
s_add_u32 m0, s40, 8192
s_nop 0
global_load_lds_dwordx4 v4, s[36:37] offset:0 sc1
global_load_lds_dwordx4 v4, s[36:37] offset:1024 sc1
s_mov_b32 s42, 0
s_waitcnt vmcnt(0)
L_Q_loop:
s_waitcnt vmcnt(3)
s_barrier
s_add_u32 s63, s42, 1
s_min_u32 s63, s63, 63
s_cmp_eq_u32 s62, 1
s_cbranch_scc1 L_Q_wxn_sk
s_mov_b32 s57, 0
L_Q_wxn:
global_load_dword v10, v9, s[30:31] sc1
s_waitcnt vmcnt(0)
v_cmp_ne_u32 vcc, 0, v10
s_nop 2
s_cmp_eq_u64 vcc, exec
s_cselect_b32 s62, 1, 0
s_bitcmp1_b64 vcc, s63
s_cbranch_scc0 L_Q_wxn_s_27
L_Q_wxn_sk:
s_cmp_lt_u32 s42, 63
s_cselect_b32 s35, 40960, 0
s_add_u32 s36, s36, s35
s_addc_u32 s37, s37, 0
s_xor_b32 s43, s42, 1
s_and_b32 s43, s43, 1
s_mul_i32 s43, s43, 40960
s_mul_i32 s40, s32, 10240
s_add_u32 s40, s40, s43
s_mov_b32 m0, s40
s_nop 0
global_load_lds_dwordx4 v2, s[36:37] offset:0 sc1
global_load_lds_dwordx4 v2, s[36:37] offset:1024 sc1
global_load_lds_dwordx4 v2, s[36:37] offset:2048 sc1
global_load_lds_dwordx4 v2, s[36:37] offset:3072 sc1
s_add_u32 m0, s40, 4096
s_nop 0
global_load_lds_dwordx4 v3, s[36:37] offset:0 sc1
global_load_lds_dwordx4 v3, s[36:37] offset:1024 sc1
global_load_lds_dwordx4 v3, s[36:37] offset:2048 sc1
global_load_lds_dwordx4 v3, s[36:37] offset:3072 sc1
s_add_u32 m0, s40, 8192
s_nop 0
global_load_lds_dwordx4 v4, s[36:37] offset:0 sc1
global_load_lds_dwordx4 v4, s[36:37] offset:1024 sc1
ds_read_b128 v[32:35], v5 offset:0
ds_read_b128 v[36:39], v5 offset:1024
ds_read_b128 v[40:43], v5 offset:2048
ds_read_b128 v[44:47], v5 offset:3072
ds_read_b128 v[48:51], v5 offset:4096
ds_read_b128 v[52:55], v5 offset:5120
ds_read_b128 v[56:59], v5 offset:6144
ds_read_b128 v[60:63], v5 offset:7168
s_waitcnt lgkmcnt(7)
v_mfma_f32_32x32x16_bf16 v[16:31], a[0:3], v[32:35], 0
ds_read_b128 v[32:35], v5 offset:8192
s_waitcnt lgkmcnt(7)
v_mfma_f32_32x32x16_bf16 v[16:31], a[4:7], v[36:39], v[16:31]
ds_read_b128 v[36:39], v5 offset:9216
s_waitcnt lgkmcnt(7)
v_mfma_f32_32x32x16_bf16 v[16:31], a[8:11], v[40:43], v[16:31]
ds_read_b128 v[40:43], v5 offset:10240
s_waitcnt lgkmcnt(7)
v_mfma_f32_32x32x16_bf16 v[16:31], a[12:15], v[44:47], v[16:31]
ds_read_b128 v[44:47], v5 offset:11264
s_waitcnt lgkmcnt(7)
v_mfma_f32_32x32x16_bf16 v[16:31], a[16:19], v[48:51], v[16:31]
ds_read_b128 v[48:51], v5 offset:12288
s_waitcnt lgkmcnt(7)
v_mfma_f32_32x32x16_bf16 v[16:31], a[20:23], v[52:55], v[16:31]
ds_read_b128 v[52:55], v5 offset:13312
s_waitcnt lgkmcnt(7)
v_mfma_f32_32x32x16_bf16 v[16:31], a[24:27], v[56:59], v[16:31]
ds_read_b128 v[56:59], v5 offset:14336
s_waitcnt lgkmcnt(7)
v_mfma_f32_32x32x16_bf16 v[16:31], a[28:31], v[60:63], v[16:31]
ds_read_b128 v[60:63], v5 offset:15360
s_waitcnt lgkmcnt(7)
v_mfma_f32_32x32x16_bf16 v[16:31], a[32:35], v[32:35], v[16:31]
ds_read_b128 v[32:35], v5 offset:16384
s_waitcnt lgkmcnt(7)
v_mfma_f32_32x32x16_bf16 v[16:31], a[36:39], v[36:39], v[16:31]
ds_read_b128 v[36:39], v5 offset:17408
s_waitcnt lgkmcnt(7)
v_mfma_f32_32x32x16_bf16 v[16:31], a[40:43], v[40:43], v[16:31]
ds_read_b128 v[40:43], v5 offset:18432
s_waitcnt lgkmcnt(7)
v_mfma_f32_32x32x16_bf16 v[16:31], a[44:47], v[44:47], v[16:31]
ds_read_b128 v[44:47], v5 offset:19456
s_waitcnt lgkmcnt(7)
v_mfma_f32_32x32x16_bf16 v[16:31], a[48:51], v[48:51], v[16:31]
ds_read_b128 v[48:51], v5 offset:20480
s_waitcnt lgkmcnt(7)
v_mfma_f32_32x32x16_bf16 v[16:31], a[52:55], v[52:55], v[16:31]
ds_read_b128 v[52:55], v5 offset:21504
s_waitcnt lgkmcnt(7)
v_mfma_f32_32x32x16_bf16 v[16:31], a[56:59], v[56:59], v[16:31]
ds_read_b128 v[56:59], v5 offset:22528
s_waitcnt lgkmcnt(7)
v_mfma_f32_32x32x16_bf16 v[16:31], a[60:63], v[60:63], v[16:31]
ds_read_b128 v[60:63], v5 offset:23552
s_waitcnt lgkmcnt(7)
v_mfma_f32_32x32x16_bf16 v[16:31], a[64:67], v[32:35], v[16:31]
ds_read_b128 v[32:35], v5 offset:24576
s_waitcnt lgkmcnt(7)
v_mfma_f32_32x32x16_bf16 v[16:31], a[68:71], v[36:39], v[16:31]
ds_read_b128 v[36:39], v5 offset:25600
s_waitcnt lgkmcnt(7)
v_mfma_f32_32x32x16_bf16 v[16:31], a[72:75], v[40:43], v[16:31]
ds_read_b128 v[40:43], v5 offset:26624
s_waitcnt lgkmcnt(7)
v_mfma_f32_32x32x16_bf16 v[16:31], a[76:79], v[44:47], v[16:31]
ds_read_b128 v[44:47], v5 offset:27648
s_waitcnt lgkmcnt(7)
v_mfma_f32_32x32x16_bf16 v[16:31], a[80:83], v[48:51], v[16:31]
ds_read_b128 v[48:51], v5 offset:28672
s_waitcnt lgkmcnt(7)
v_mfma_f32_32x32x16_bf16 v[16:31], a[84:87], v[52:55], v[16:31]
ds_read_b128 v[52:55], v5 offset:29696
s_waitcnt lgkmcnt(7)
v_mfma_f32_32x32x16_bf16 v[16:31], a[88:91], v[56:59], v[16:31]
ds_read_b128 v[56:59], v5 offset:30720
s_waitcnt lgkmcnt(7)
v_mfma_f32_32x32x16_bf16 v[16:31], a[92:95], v[60:63], v[16:31]
ds_read_b128 v[60:63], v5 offset:31744
s_waitcnt lgkmcnt(7)
v_mfma_f32_32x32x16_bf16 v[16:31], a[96:99], v[32:35], v[16:31]
ds_read_b128 v[32:35], v5 offset:32768
s_waitcnt lgkmcnt(7)
v_mfma_f32_32x32x16_bf16 v[16:31], a[100:103], v[36:39], v[16:31]
ds_read_b128 v[36:39], v5 offset:33792
s_waitcnt lgkmcnt(7)
v_mfma_f32_32x32x16_bf16 v[16:31], a[104:107], v[40:43], v[16:31]
ds_read_b128 v[40:43], v5 offset:34816
s_waitcnt lgkmcnt(7)
v_mfma_f32_32x32x16_bf16 v[16:31], a[108:111], v[44:47], v[16:31]
ds_read_b128 v[44:47], v5 offset:35840
s_waitcnt lgkmcnt(7)
v_mfma_f32_32x32x16_bf16 v[16:31], a[112:115], v[48:51], v[16:31]
ds_read_b128 v[48:51], v5 offset:36864
s_waitcnt lgkmcnt(7)
v_mfma_f32_32x32x16_bf16 v[16:31], a[116:119], v[52:55], v[16:31]
ds_read_b128 v[52:55], v5 offset:37888
s_waitcnt lgkmcnt(7)
v_mfma_f32_32x32x16_bf16 v[16:31], a[120:123], v[56:59], v[16:31]
ds_read_b128 v[56:59], v5 offset:38912
s_waitcnt lgkmcnt(7)
v_mfma_f32_32x32x16_bf16 v[16:31], a[124:127], v[60:63], v[16:31]
ds_read_b128 v[60:63], v5 offset:39936
s_waitcnt lgkmcnt(7)
v_mfma_f32_32x32x16_bf16 v[16:31], a[128:131], v[32:35], v[16:31]
s_waitcnt lgkmcnt(6)
v_mfma_f32_32x32x16_bf16 v[16:31], a[132:135], v[36:39], v[16:31]
s_waitcnt lgkmcnt(5)
v_mfma_f32_32x32x16_bf16 v[16:31], a[136:139], v[40:43], v[16:31]
s_waitcnt lgkmcnt(4)
v_mfma_f32_32x32x16_bf16 v[16:31], a[140:143], v[44:47], v[16:31]
s_waitcnt lgkmcnt(3)
v_mfma_f32_32x32x16_bf16 v[16:31], a[144:147], v[48:51], v[16:31]
s_waitcnt lgkmcnt(2)
v_mfma_f32_32x32x16_bf16 v[16:31], a[148:151], v[52:55], v[16:31]
s_waitcnt lgkmcnt(1)
v_mfma_f32_32x32x16_bf16 v[16:31], a[152:155], v[56:59], v[16:31]
s_waitcnt lgkmcnt(0)
v_mfma_f32_32x32x16_bf16 v[16:31], a[156:159], v[60:63], v[16:31]
v_xor_b32 v5, 0xa000, v5
s_waitcnt vmcnt(10)
s_mov_b64 exec, 1
v_mov_b32 v8, s42
global_store_dword v7, v8, s[30:31] sc1
s_mov_b64 exec, -1
s_nop 5
v_cvt_pk_bf16_f32 v64, v16, v17
v_cvt_pk_bf16_f32 v65, v18, v19
v_cvt_pk_bf16_f32 v66, v24, v25
v_cvt_pk_bf16_f32 v67, v26, v27
v_cvt_pk_bf16_f32 v68, v20, v21
v_cvt_pk_bf16_f32 v69, v22, v23
v_cvt_pk_bf16_f32 v70, v28, v29
v_cvt_pk_bf16_f32 v71, v30, v31
global_store_dwordx4 v6, v[64:67], s[38:39] sc1
global_store_dwordx4 v6, v[68:71], s[38:39] offset:512 sc1
s_cmp_eq_u32 s42, 0
s_cbranch_scc0 L_Q_nf0
s_waitcnt vmcnt(0)
s_mov_b64 exec, 1
v_mov_b32 v8, 1
global_store_dword v7, v8, s[30:31] sc1
s_mov_b64 exec, -1
s_waitcnt vmcnt(0)
L_Q_nf0:
s_add_u32 s38, s38, 262144
s_addc_u32 s39, s39, 0
s_add_u32 s42, s42, 1
s_cmp_lt_u32 s42, 64
s_cbranch_scc1 L_Q_loop
s_waitcnt vmcnt(0)
s_mov_b64 exec, 1
v_mov_b32 v8, 64
global_store_dword v7, v8, s[30:31] sc1
s_mov_b64 exec, -1
s_waitcnt vmcnt(0)
s_endpgm
L_Q_wx0_s_26:
s_sleep 2
s_add_u32 s57, s57, 1
s_cmp_lt_u32 s57, 262144
s_cbranch_scc1 L_Q_wx0
s_endpgm
L_Q_wxn_s_27:
s_sleep 2
s_add_u32 s57, s57, 1
s_cmp_lt_u32 s57, 262144
s_cbranch_scc1 L_Q_wxn
s_endpgm
L_H:
v_and_b32 v1, 63, v0
s_cmp_eq_u32 s32, 0
s_cbranch_scc0 L_wi_H_ok
s_mov_b32 s57, 0
v_and_b32 v4, 63, v0
v_and_b32 v2, 3, v4
v_bfe_u32 v3, v4, 2, 1
v_lshl_add_u32 v2, v3, 5, v2
v_lshlrev_b32 v2, 2, v2
v_cmp_eq_u32 vcc, 8, v4
v_mov_b32 v3, 40
s_nop 0
v_cndmask_b32 v2, v2, v3, vcc
v_cmp_lt_u32 vcc, 8, v4
v_mov_b32 v3, 44
s_nop 0
v_cndmask_b32 v2, v2, v3, vcc
L_wi_H:
global_load_dword v3, v2, s[28:29] sc1
s_waitcnt vmcnt(0)
v_readlane_b32 s58, v3, 0
v_readlane_b32 s59, v3, 1
s_nop 2
s_add_u32 s58, s58, s59
v_readlane_b32 s59, v3, 2
s_nop 2
s_add_u32 s58, s58, s59
v_readlane_b32 s59, v3, 3
s_nop 2
s_add_u32 s58, s58, s59
v_readlane_b32 s59, v3, 4
s_nop 2
s_add_u32 s58, s58, s59
v_readlane_b32 s59, v3, 5
s_nop 2
s_add_u32 s58, s58, s59
v_readlane_b32 s59, v3, 6
s_nop 2
s_add_u32 s58, s58, s59
v_readlane_b32 s59, v3, 7
s_nop 2
s_add_u32 s58, s58, s59
v_readlane_b32 s59, v3, 8
s_nop 2
s_add_u32 s58, s58, s59
s_cmp_ge_u32 s58, 256
s_cbranch_scc1 L_wi_H_ok
s_sleep 32
s_add_u32 s57, s57, 1
s_cmp_lt_u32 s57, 0x20000
s_cbranch_scc1 L_wi_H
s_endpgm
L_wi_H_ok:
s_barrier
s_cmp_eq_u32 s32, 0
s_cbranch_scc0 L_wfk_H_ok
s_mov_b32 s57, 0
v_mov_b32 v2, 0
L_wfk_H:
global_load_dword v3, v2, s[30:31] sc1
s_waitcnt vmcnt(0)
v_readfirstlane_b32 s58, v3
s_nop 2
s_cmp_ge_u32 s58, 1
s_cbranch_scc1 L_wfk_H_ok
s_sleep 16
s_add_u32 s57, s57, 1
s_cmp_lt_u32 s57, 0x4000
s_cbranch_scc1 L_wfk_H
L_wfk_H_ok:
s_barrier
s_lshl_b32 s35, s34, 8
s_add_u32 s36, s20, s35
s_addc_u32 s37, s21, 0
s_mul_i32 s35, s32, 552960
s_add_u32 s36, s36, s35
s_addc_u32 s37, s37, 0
v_lshrrev_b32 v4, 4, v1
v_and_b32 v5, 15, v1
v_lshrrev_b32 v6, 1, v5
v_lshlrev_b32 v7, 1, v4
v_xor_b32 v6, v6, v7
v_and_b32 v5, 1, v5
v_lshl_add_u32 v6, v6, 1, v5
s_cmp_eq_u32 s34, 13
s_cselect_b32 s35, 7, 15
v_and_b32 v6, s35, v6
s_mov_b32 s35, 3456
v_mul_lo_u32 v2, v4, s35
v_lshl_add_u32 v2, v6, 4, v2
s_mul_i32 s40, s32, 40960
s_mov_b32 m0, s40
s_nop 0
global_load_lds_dwordx4 v2, s[36:37]
s_add_u32 s40, s40, 1024
s_add_u32 s36, s36, 13824
s_addc_u32 s37, s37, 0
s_mov_b32 m0, s40
s_nop 0
global_load_lds_dwordx4 v2, s[36:37]
s_add_u32 s40, s40, 1024
s_add_u32 s36, s36, 13824
s_addc_u32 s37, s37, 0
s_mov_b32 m0, s40
s_nop 0
global_load_lds_dwordx4 v2, s[36:37]
s_add_u32 s40, s40, 1024
s_add_u32 s36, s36, 13824
s_addc_u32 s37, s37, 0
s_mov_b32 m0, s40
s_nop 0
global_load_lds_dwordx4 v2, s[36:37]
s_add_u32 s40, s40, 1024
s_add_u32 s36, s36, 13824
s_addc_u32 s37, s37, 0
s_mov_b32 m0, s40
s_nop 0
global_load_lds_dwordx4 v2, s[36:37]
s_add_u32 s40, s40, 1024
s_add_u32 s36, s36, 13824
s_addc_u32 s37, s37, 0
s_mov_b32 m0, s40
s_nop 0
global_load_lds_dwordx4 v2, s[36:37]
s_add_u32 s40, s40, 1024
s_add_u32 s36, s36, 13824
s_addc_u32 s37, s37, 0
s_mov_b32 m0, s40
s_nop 0
global_load_lds_dwordx4 v2, s[36:37]
s_add_u32 s40, s40, 1024
s_add_u32 s36, s36, 13824
s_addc_u32 s37, s37, 0
s_mov_b32 m0, s40
s_nop 0
global_load_lds_dwordx4 v2, s[36:37]
s_add_u32 s40, s40, 1024
s_add_u32 s36, s36, 13824
s_addc_u32 s37, s37, 0
s_mov_b32 m0, s40
s_nop 0
global_load_lds_dwordx4 v2, s[36:37]
s_add_u32 s40, s40, 1024
s_add_u32 s36, s36, 13824
s_addc_u32 s37, s37, 0
s_mov_b32 m0, s40
s_nop 0
global_load_lds_dwordx4 v2, s[36:37]
s_add_u32 s40, s40, 1024
s_add_u32 s36, s36, 13824
s_addc_u32 s37, s37, 0
s_mov_b32 m0, s40
s_nop 0
global_load_lds_dwordx4 v2, s[36:37]
s_add_u32 s40, s40, 1024
s_add_u32 s36, s36, 13824
s_addc_u32 s37, s37, 0
s_mov_b32 m0, s40
s_nop 0
global_load_lds_dwordx4 v2, s[36:37]
s_add_u32 s40, s40, 1024
s_add_u32 s36, s36, 13824
s_addc_u32 s37, s37, 0
s_mov_b32 m0, s40
s_nop 0
global_load_lds_dwordx4 v2, s[36:37]
s_add_u32 s40, s40, 1024
s_add_u32 s36, s36, 13824
s_addc_u32 s37, s37, 0
s_mov_b32 m0, s40
s_nop 0
global_load_lds_dwordx4 v2, s[36:37]
s_add_u32 s40, s40, 1024
s_add_u32 s36, s36, 13824
s_addc_u32 s37, s37, 0
s_mov_b32 m0, s40
s_nop 0
global_load_lds_dwordx4 v2, s[36:37]
s_add_u32 s40, s40, 1024
s_add_u32 s36, s36, 13824
s_addc_u32 s37, s37, 0
s_mov_b32 m0, s40
s_nop 0
global_load_lds_dwordx4 v2, s[36:37]
s_add_u32 s40, s40, 1024
s_add_u32 s36, s36, 13824
s_addc_u32 s37, s37, 0
s_mov_b32 m0, s40
s_nop 0
global_load_lds_dwordx4 v2, s[36:37]
s_add_u32 s40, s40, 1024
s_add_u32 s36, s36, 13824
s_addc_u32 s37, s37, 0
s_mov_b32 m0, s40
s_nop 0
global_load_lds_dwordx4 v2, s[36:37]
s_add_u32 s40, s40, 1024
s_add_u32 s36, s36, 13824
s_addc_u32 s37, s37, 0
s_mov_b32 m0, s40
s_nop 0
global_load_lds_dwordx4 v2, s[36:37]
s_add_u32 s40, s40, 1024
s_add_u32 s36, s36, 13824
s_addc_u32 s37, s37, 0
s_mov_b32 m0, s40
s_nop 0
global_load_lds_dwordx4 v2, s[36:37]
s_add_u32 s40, s40, 1024
s_add_u32 s36, s36, 13824
s_addc_u32 s37, s37, 0
s_mov_b32 m0, s40
s_nop 0
global_load_lds_dwordx4 v2, s[36:37]
s_add_u32 s40, s40, 1024
s_add_u32 s36, s36, 13824
s_addc_u32 s37, s37, 0
s_mov_b32 m0, s40
s_nop 0
global_load_lds_dwordx4 v2, s[36:37]
s_add_u32 s40, s40, 1024
s_add_u32 s36, s36, 13824
s_addc_u32 s37, s37, 0
s_mov_b32 m0, s40
s_nop 0
global_load_lds_dwordx4 v2, s[36:37]
s_add_u32 s40, s40, 1024
s_add_u32 s36, s36, 13824
s_addc_u32 s37, s37, 0
s_mov_b32 m0, s40
s_nop 0
global_load_lds_dwordx4 v2, s[36:37]
s_add_u32 s40, s40, 1024
s_add_u32 s36, s36, 13824
s_addc_u32 s37, s37, 0
s_mov_b32 m0, s40
s_nop 0
global_load_lds_dwordx4 v2, s[36:37]
s_add_u32 s40, s40, 1024
s_add_u32 s36, s36, 13824
s_addc_u32 s37, s37, 0
s_mov_b32 m0, s40
s_nop 0
global_load_lds_dwordx4 v2, s[36:37]
s_add_u32 s40, s40, 1024
s_add_u32 s36, s36, 13824
s_addc_u32 s37, s37, 0
s_mov_b32 m0, s40
s_nop 0
global_load_lds_dwordx4 v2, s[36:37]
s_add_u32 s40, s40, 1024
s_add_u32 s36, s36, 13824
s_addc_u32 s37, s37, 0
s_mov_b32 m0, s40
s_nop 0
global_load_lds_dwordx4 v2, s[36:37]
s_add_u32 s40, s40, 1024
s_add_u32 s36, s36, 13824
s_addc_u32 s37, s37, 0
s_mov_b32 m0, s40
s_nop 0
global_load_lds_dwordx4 v2, s[36:37]
s_add_u32 s40, s40, 1024
s_add_u32 s36, s36, 13824
s_addc_u32 s37, s37, 0
s_mov_b32 m0, s40
s_nop 0
global_load_lds_dwordx4 v2, s[36:37]
s_add_u32 s40, s40, 1024
s_add_u32 s36, s36, 13824
s_addc_u32 s37, s37, 0
s_mov_b32 m0, s40
s_nop 0
global_load_lds_dwordx4 v2, s[36:37]
s_add_u32 s40, s40, 1024
s_add_u32 s36, s36, 13824
s_addc_u32 s37, s37, 0
s_mov_b32 m0, s40
s_nop 0
global_load_lds_dwordx4 v2, s[36:37]
s_add_u32 s40, s40, 1024
s_add_u32 s36, s36, 13824
s_addc_u32 s37, s37, 0
s_mov_b32 m0, s40
s_nop 0
global_load_lds_dwordx4 v2, s[36:37]
s_add_u32 s40, s40, 1024
s_add_u32 s36, s36, 13824
s_addc_u32 s37, s37, 0
s_mov_b32 m0, s40
s_nop 0
global_load_lds_dwordx4 v2, s[36:37]
s_add_u32 s40, s40, 1024
s_add_u32 s36, s36, 13824
s_addc_u32 s37, s37, 0
s_mov_b32 m0, s40
s_nop 0
global_load_lds_dwordx4 v2, s[36:37]
s_add_u32 s40, s40, 1024
s_add_u32 s36, s36, 13824
s_addc_u32 s37, s37, 0
s_mov_b32 m0, s40
s_nop 0
global_load_lds_dwordx4 v2, s[36:37]
s_add_u32 s40, s40, 1024
s_add_u32 s36, s36, 13824
s_addc_u32 s37, s37, 0
s_mov_b32 m0, s40
s_nop 0
global_load_lds_dwordx4 v2, s[36:37]
s_add_u32 s40, s40, 1024
s_add_u32 s36, s36, 13824
s_addc_u32 s37, s37, 0
s_mov_b32 m0, s40
s_nop 0
global_load_lds_dwordx4 v2, s[36:37]
s_add_u32 s40, s40, 1024
s_add_u32 s36, s36, 13824
s_addc_u32 s37, s37, 0
s_mov_b32 m0, s40
s_nop 0
global_load_lds_dwordx4 v2, s[36:37]
s_add_u32 s40, s40, 1024
s_add_u32 s36, s36, 13824
s_addc_u32 s37, s37, 0
s_mov_b32 m0, s40
s_nop 0
global_load_lds_dwordx4 v2, s[36:37]
s_add_u32 s40, s40, 1024
s_add_u32 s36, s36, 13824
s_addc_u32 s37, s37, 0
v_lshrrev_b32 v10, 5, v1
v_bfe_u32 v11, v1, 2, 2
v_lshl_add_u32 v12, v10, 3, v11
v_lshlrev_b32 v12, 8, v12
v_bfe_u32 v13, v1, 4, 1
s_lshl_b32 s35, s32, 1
v_add_u32 v13, s35, v13
v_lshlrev_b32 v14, 1, v11
v_xor_b32 v13, v13, v14
v_lshl_add_u32 v12, v13, 5, v12
v_and_b32 v13, 3, v1
v_lshl_add_u32 v15, v13, 3, v12
v_add_u32 v16, 0x10000, v15
v_add_u32 v17, 0x20000, v15
s_waitcnt vmcnt(0)
s_barrier
ds_read_b64_tr_b16 a[0:1], v15 offset:0
ds_read_b64_tr_b16 a[2:3], v15 offset:1024
ds_read_b64_tr_b16 a[4:5], v15 offset:4096
ds_read_b64_tr_b16 a[6:7], v15 offset:5120
ds_read_b64_tr_b16 a[8:9], v15 offset:8192
ds_read_b64_tr_b16 a[10:11], v15 offset:9216
ds_read_b64_tr_b16 a[12:13], v15 offset:12288
ds_read_b64_tr_b16 a[14:15], v15 offset:13312
ds_read_b64_tr_b16 a[16:17], v15 offset:16384
ds_read_b64_tr_b16 a[18:19], v15 offset:17408
ds_read_b64_tr_b16 a[20:21], v15 offset:20480
ds_read_b64_tr_b16 a[22:23], v15 offset:21504
ds_read_b64_tr_b16 a[24:25], v15 offset:24576
ds_read_b64_tr_b16 a[26:27], v15 offset:25600
ds_read_b64_tr_b16 a[28:29], v15 offset:28672
s_waitcnt lgkmcnt(14)
ds_read_b64_tr_b16 a[30:31], v15 offset:29696
s_waitcnt lgkmcnt(14)
ds_read_b64_tr_b16 a[32:33], v15 offset:32768
s_waitcnt lgkmcnt(14)
ds_read_b64_tr_b16 a[34:35], v15 offset:33792
s_waitcnt lgkmcnt(14)
ds_read_b64_tr_b16 a[36:37], v15 offset:36864
s_waitcnt lgkmcnt(14)
ds_read_b64_tr_b16 a[38:39], v15 offset:37888
s_waitcnt lgkmcnt(14)
ds_read_b64_tr_b16 a[40:41], v15 offset:40960
s_waitcnt lgkmcnt(14)
ds_read_b64_tr_b16 a[42:43], v15 offset:41984
s_waitcnt lgkmcnt(14)
ds_read_b64_tr_b16 a[44:45], v15 offset:45056
s_waitcnt lgkmcnt(14)
ds_read_b64_tr_b16 a[46:47], v15 offset:46080
s_waitcnt lgkmcnt(14)
ds_read_b64_tr_b16 a[48:49], v15 offset:49152
s_waitcnt lgkmcnt(14)
ds_read_b64_tr_b16 a[50:51], v15 offset:50176
s_waitcnt lgkmcnt(14)
ds_read_b64_tr_b16 a[52:53], v15 offset:53248
s_waitcnt lgkmcnt(14)
ds_read_b64_tr_b16 a[54:55], v15 offset:54272
s_waitcnt lgkmcnt(14)
ds_read_b64_tr_b16 a[56:57], v15 offset:57344
s_waitcnt lgkmcnt(14)
ds_read_b64_tr_b16 a[58:59], v15 offset:58368
s_waitcnt lgkmcnt(14)
ds_read_b64_tr_b16 a[60:61], v15 offset:61440
s_waitcnt lgkmcnt(14)
ds_read_b64_tr_b16 a[62:63], v15 offset:62464
s_waitcnt lgkmcnt(14)
ds_read_b64_tr_b16 a[64:65], v16 offset:0
s_waitcnt lgkmcnt(14)
ds_read_b64_tr_b16 a[66:67], v16 offset:1024
s_waitcnt lgkmcnt(14)
ds_read_b64_tr_b16 a[68:69], v16 offset:4096
s_waitcnt lgkmcnt(14)
ds_read_b64_tr_b16 a[70:71], v16 offset:5120
s_waitcnt lgkmcnt(14)
ds_read_b64_tr_b16 a[72:73], v16 offset:8192
s_waitcnt lgkmcnt(14)
ds_read_b64_tr_b16 a[74:75], v16 offset:9216
s_waitcnt lgkmcnt(14)
ds_read_b64_tr_b16 a[76:77], v16 offset:12288
s_waitcnt lgkmcnt(14)
ds_read_b64_tr_b16 a[78:79], v16 offset:13312
s_waitcnt lgkmcnt(14)
ds_read_b64_tr_b16 a[80:81], v16 offset:16384
s_waitcnt lgkmcnt(14)
ds_read_b64_tr_b16 a[82:83], v16 offset:17408
s_waitcnt lgkmcnt(14)
ds_read_b64_tr_b16 a[84:85], v16 offset:20480
s_waitcnt lgkmcnt(14)
ds_read_b64_tr_b16 a[86:87], v16 offset:21504
s_waitcnt lgkmcnt(14)
ds_read_b64_tr_b16 a[88:89], v16 offset:24576
s_waitcnt lgkmcnt(14)
ds_read_b64_tr_b16 a[90:91], v16 offset:25600
s_waitcnt lgkmcnt(14)
ds_read_b64_tr_b16 a[92:93], v16 offset:28672
s_waitcnt lgkmcnt(14)
ds_read_b64_tr_b16 a[94:95], v16 offset:29696
s_waitcnt lgkmcnt(14)
ds_read_b64_tr_b16 a[96:97], v16 offset:32768
s_waitcnt lgkmcnt(14)
ds_read_b64_tr_b16 a[98:99], v16 offset:33792
s_waitcnt lgkmcnt(14)
ds_read_b64_tr_b16 a[100:101], v16 offset:36864
s_waitcnt lgkmcnt(14)
ds_read_b64_tr_b16 a[102:103], v16 offset:37888
s_waitcnt lgkmcnt(14)
ds_read_b64_tr_b16 a[104:105], v16 offset:40960
s_waitcnt lgkmcnt(14)
ds_read_b64_tr_b16 a[106:107], v16 offset:41984
s_waitcnt lgkmcnt(14)
ds_read_b64_tr_b16 a[108:109], v16 offset:45056
s_waitcnt lgkmcnt(14)
ds_read_b64_tr_b16 a[110:111], v16 offset:46080
s_waitcnt lgkmcnt(14)
ds_read_b64_tr_b16 a[112:113], v16 offset:49152
s_waitcnt lgkmcnt(14)
ds_read_b64_tr_b16 a[114:115], v16 offset:50176
s_waitcnt lgkmcnt(14)
ds_read_b64_tr_b16 a[116:117], v16 offset:53248
s_waitcnt lgkmcnt(14)
ds_read_b64_tr_b16 a[118:119], v16 offset:54272
s_waitcnt lgkmcnt(14)
ds_read_b64_tr_b16 a[120:121], v16 offset:57344
s_waitcnt lgkmcnt(14)
ds_read_b64_tr_b16 a[122:123], v16 offset:58368
s_waitcnt lgkmcnt(14)
ds_read_b64_tr_b16 a[124:125], v16 offset:61440
s_waitcnt lgkmcnt(14)
ds_read_b64_tr_b16 a[126:127], v16 offset:62464
s_waitcnt lgkmcnt(14)
ds_read_b64_tr_b16 a[128:129], v17 offset:0
s_waitcnt lgkmcnt(14)
ds_read_b64_tr_b16 a[130:131], v17 offset:1024
s_waitcnt lgkmcnt(14)
ds_read_b64_tr_b16 a[132:133], v17 offset:4096
s_waitcnt lgkmcnt(14)
ds_read_b64_tr_b16 a[134:135], v17 offset:5120
s_waitcnt lgkmcnt(14)
ds_read_b64_tr_b16 a[136:137], v17 offset:8192
s_waitcnt lgkmcnt(14)
ds_read_b64_tr_b16 a[138:139], v17 offset:9216
s_waitcnt lgkmcnt(14)
ds_read_b64_tr_b16 a[140:141], v17 offset:12288
s_waitcnt lgkmcnt(14)
ds_read_b64_tr_b16 a[142:143], v17 offset:13312
s_waitcnt lgkmcnt(14)
ds_read_b64_tr_b16 a[144:145], v17 offset:16384
s_waitcnt lgkmcnt(14)
ds_read_b64_tr_b16 a[146:147], v17 offset:17408
s_waitcnt lgkmcnt(14)
ds_read_b64_tr_b16 a[148:149], v17 offset:20480
s_waitcnt lgkmcnt(14)
ds_read_b64_tr_b16 a[150:151], v17 offset:21504
s_waitcnt lgkmcnt(14)
ds_read_b64_tr_b16 a[152:153], v17 offset:24576
s_waitcnt lgkmcnt(14)
ds_read_b64_tr_b16 a[154:155], v17 offset:25600
s_waitcnt lgkmcnt(14)
ds_read_b64_tr_b16 a[156:157], v17 offset:28672
s_waitcnt lgkmcnt(14)
ds_read_b64_tr_b16 a[158:159], v17 offset:29696
s_waitcnt lgkmcnt(0)
s_barrier
s_lshl_b32 s35, s34, 7
s_lshl_b32 s38, s32, 5
s_add_u32 s35, s35, s38
v_lshrrev_b32 v10, 5, v1
v_lshlrev_b32 v10, 2, v10
v_add_u32 v10, s35, v10
v_min_u32 v10, 1700, v10
v_lshlrev_b32 v10, 1, v10
global_load_dwordx2 v[64:65], v10, s[22:23] offset:0
global_load_dwordx2 v[66:67], v10, s[22:23] offset:16
global_load_dwordx2 v[68:69], v10, s[22:23] offset:32
global_load_dwordx2 v[70:71], v10, s[22:23] offset:48
s_waitcnt vmcnt(0)
v_lshlrev_b32 v80, 16, v64
v_and_b32 v81, 0xffff0000, v64
v_lshlrev_b32 v82, 16, v65
v_and_b32 v83, 0xffff0000, v65
v_lshlrev_b32 v84, 16, v66
v_and_b32 v85, 0xffff0000, v66
v_lshlrev_b32 v86, 16, v67
v_and_b32 v87, 0xffff0000, v67
v_lshlrev_b32 v88, 16, v68
v_and_b32 v89, 0xffff0000, v68
v_lshlrev_b32 v90, 16, v69
v_and_b32 v91, 0xffff0000, v69
v_lshlrev_b32 v92, 16, v70
v_and_b32 v93, 0xffff0000, v70
v_lshlrev_b32 v94, 16, v71
v_and_b32 v95, 0xffff0000, v71
s_mov_b32 s60, 0xbfb8aa3b
v_lshlrev_b32 v9, 6, v1
v_add_u32 v9, 32768, v9
s_mov_b32 s62, 0
s_mov_b32 s63, 0
s_cmp_eq_u32 s62, 1
s_cbranch_scc1 L_H_wx0_sk
s_mov_b32 s57, 0
L_H_wx0:
global_load_dword v10, v9, s[30:31] sc1
s_waitcnt vmcnt(0)
v_cmp_ne_u32 vcc, 0, v10
s_nop 2
s_cmp_eq_u64 vcc, exec
s_cselect_b32 s62, 1, 0
s_bitcmp1_b64 vcc, s63
s_cbranch_scc0 L_H_wx0_s_28
L_H_wx0_sk:
s_mul_i32 s35, s32, 10240
v_lshlrev_b32 v5, 4, v1
v_add_u32 v2, s35, v5
v_add_u32 v3, 4096, v2
v_add_u32 v4, 8192, v2
s_add_u32 s36, s30, 1048576
s_addc_u32 s37, s31, 0
s_mov_b32 s40, s35
s_lshl_b32 s35, s34, 13
s_lshl_b32 s41, s32, 11
s_add_u32 s35, s35, s41
s_add_u32 s38, s30, 104857600
s_addc_u32 s39, s31, 0
s_add_u32 s38, s38, s35
s_addc_u32 s39, s39, 0
v_lshlrev_b32 v6, 4, v1
s_lshl_b32 s35, s34, 6
s_lshl_b32 s41, s32, 2
s_add_u32 s35, s35, s41
s_add_u32 s35, s35, 12288
v_mov_b32 v7, s35
s_cmp_eq_u32 s34, 13
s_cselect_b32 s61, 1, 0
s_lshr_b32 s41, s32, 1
s_and_b32 s61, s61, s41
s_xor_b32 s61, s61, 1
s_mov_b32 m0, s40
s_nop 0
global_load_lds_dwordx4 v2, s[36:37] offset:0 sc1
global_load_lds_dwordx4 v2, s[36:37] offset:1024 sc1
global_load_lds_dwordx4 v2, s[36:37] offset:2048 sc1
global_load_lds_dwordx4 v2, s[36:37] offset:3072 sc1
s_add_u32 m0, s40, 4096
s_nop 0
global_load_lds_dwordx4 v3, s[36:37] offset:0 sc1
global_load_lds_dwordx4 v3, s[36:37] offset:1024 sc1
global_load_lds_dwordx4 v3, s[36:37] offset:2048 sc1
global_load_lds_dwordx4 v3, s[36:37] offset:3072 sc1
s_add_u32 m0, s40, 8192
s_nop 0
global_load_lds_dwordx4 v4, s[36:37] offset:0 sc1
global_load_lds_dwordx4 v4, s[36:37] offset:1024 sc1
s_mov_b32 s42, 0
s_waitcnt vmcnt(0)
L_H_loop:
s_waitcnt vmcnt(3)
s_barrier
s_add_u32 s63, s42, 1
s_min_u32 s63, s63, 63
s_cmp_eq_u32 s62, 1
s_cbranch_scc1 L_H_wxn_sk
s_mov_b32 s57, 0
L_H_wxn:
global_load_dword v10, v9, s[30:31] sc1
s_waitcnt vmcnt(0)
v_cmp_ne_u32 vcc, 0, v10
s_nop 2
s_cmp_eq_u64 vcc, exec
s_cselect_b32 s62, 1, 0
s_bitcmp1_b64 vcc, s63
s_cbranch_scc0 L_H_wxn_s_29
L_H_wxn_sk:
s_cmp_lt_u32 s42, 63
s_cselect_b32 s35, 40960, 0
s_add_u32 s36, s36, s35
s_addc_u32 s37, s37, 0
s_xor_b32 s43, s42, 1
s_and_b32 s43, s43, 1
s_mul_i32 s43, s43, 40960
s_mul_i32 s40, s32, 10240
s_add_u32 s40, s40, s43
s_mov_b32 m0, s40
s_nop 0
global_load_lds_dwordx4 v2, s[36:37] offset:0 sc1
global_load_lds_dwordx4 v2, s[36:37] offset:1024 sc1
global_load_lds_dwordx4 v2, s[36:37] offset:2048 sc1
global_load_lds_dwordx4 v2, s[36:37] offset:3072 sc1
s_add_u32 m0, s40, 4096
s_nop 0
global_load_lds_dwordx4 v3, s[36:37] offset:0 sc1
global_load_lds_dwordx4 v3, s[36:37] offset:1024 sc1
global_load_lds_dwordx4 v3, s[36:37] offset:2048 sc1
global_load_lds_dwordx4 v3, s[36:37] offset:3072 sc1
s_add_u32 m0, s40, 8192
s_nop 0
global_load_lds_dwordx4 v4, s[36:37] offset:0 sc1
global_load_lds_dwordx4 v4, s[36:37] offset:1024 sc1
ds_read_b128 v[32:35], v5 offset:0
ds_read_b128 v[36:39], v5 offset:1024
ds_read_b128 v[40:43], v5 offset:2048
ds_read_b128 v[44:47], v5 offset:3072
ds_read_b128 v[48:51], v5 offset:4096
ds_read_b128 v[52:55], v5 offset:5120
ds_read_b128 v[56:59], v5 offset:6144
ds_read_b128 v[60:63], v5 offset:7168
s_waitcnt lgkmcnt(7)
v_mfma_f32_32x32x16_bf16 v[16:31], a[0:3], v[32:35], 0
ds_read_b128 v[32:35], v5 offset:8192
s_waitcnt lgkmcnt(7)
v_mfma_f32_32x32x16_bf16 v[16:31], a[4:7], v[36:39], v[16:31]
ds_read_b128 v[36:39], v5 offset:9216
s_waitcnt lgkmcnt(7)
v_mfma_f32_32x32x16_bf16 v[16:31], a[8:11], v[40:43], v[16:31]
ds_read_b128 v[40:43], v5 offset:10240
s_waitcnt lgkmcnt(7)
v_mfma_f32_32x32x16_bf16 v[16:31], a[12:15], v[44:47], v[16:31]
ds_read_b128 v[44:47], v5 offset:11264
s_waitcnt lgkmcnt(7)
v_mfma_f32_32x32x16_bf16 v[16:31], a[16:19], v[48:51], v[16:31]
ds_read_b128 v[48:51], v5 offset:12288
s_waitcnt lgkmcnt(7)
v_mfma_f32_32x32x16_bf16 v[16:31], a[20:23], v[52:55], v[16:31]
ds_read_b128 v[52:55], v5 offset:13312
s_waitcnt lgkmcnt(7)
v_mfma_f32_32x32x16_bf16 v[16:31], a[24:27], v[56:59], v[16:31]
ds_read_b128 v[56:59], v5 offset:14336
s_waitcnt lgkmcnt(7)
v_mfma_f32_32x32x16_bf16 v[16:31], a[28:31], v[60:63], v[16:31]
ds_read_b128 v[60:63], v5 offset:15360
s_waitcnt lgkmcnt(7)
v_mfma_f32_32x32x16_bf16 v[16:31], a[32:35], v[32:35], v[16:31]
ds_read_b128 v[32:35], v5 offset:16384
s_waitcnt lgkmcnt(7)
v_mfma_f32_32x32x16_bf16 v[16:31], a[36:39], v[36:39], v[16:31]
ds_read_b128 v[36:39], v5 offset:17408
s_waitcnt lgkmcnt(7)
v_mfma_f32_32x32x16_bf16 v[16:31], a[40:43], v[40:43], v[16:31]
ds_read_b128 v[40:43], v5 offset:18432
s_waitcnt lgkmcnt(7)
v_mfma_f32_32x32x16_bf16 v[16:31], a[44:47], v[44:47], v[16:31]
ds_read_b128 v[44:47], v5 offset:19456
s_waitcnt lgkmcnt(7)
v_mfma_f32_32x32x16_bf16 v[16:31], a[48:51], v[48:51], v[16:31]
ds_read_b128 v[48:51], v5 offset:20480
s_waitcnt lgkmcnt(7)
v_mfma_f32_32x32x16_bf16 v[16:31], a[52:55], v[52:55], v[16:31]
ds_read_b128 v[52:55], v5 offset:21504
s_waitcnt lgkmcnt(7)
v_mfma_f32_32x32x16_bf16 v[16:31], a[56:59], v[56:59], v[16:31]
ds_read_b128 v[56:59], v5 offset:22528
s_waitcnt lgkmcnt(7)
v_mfma_f32_32x32x16_bf16 v[16:31], a[60:63], v[60:63], v[16:31]
ds_read_b128 v[60:63], v5 offset:23552
s_waitcnt lgkmcnt(7)
v_mfma_f32_32x32x16_bf16 v[16:31], a[64:67], v[32:35], v[16:31]
ds_read_b128 v[32:35], v5 offset:24576
s_waitcnt lgkmcnt(7)
v_mfma_f32_32x32x16_bf16 v[16:31], a[68:71], v[36:39], v[16:31]
ds_read_b128 v[36:39], v5 offset:25600
s_waitcnt lgkmcnt(7)
v_mfma_f32_32x32x16_bf16 v[16:31], a[72:75], v[40:43], v[16:31]
ds_read_b128 v[40:43], v5 offset:26624
s_waitcnt lgkmcnt(7)
v_mfma_f32_32x32x16_bf16 v[16:31], a[76:79], v[44:47], v[16:31]
ds_read_b128 v[44:47], v5 offset:27648
s_waitcnt lgkmcnt(7)
v_mfma_f32_32x32x16_bf16 v[16:31], a[80:83], v[48:51], v[16:31]
ds_read_b128 v[48:51], v5 offset:28672
s_waitcnt lgkmcnt(7)
v_mfma_f32_32x32x16_bf16 v[16:31], a[84:87], v[52:55], v[16:31]
ds_read_b128 v[52:55], v5 offset:29696
s_waitcnt lgkmcnt(7)
v_mfma_f32_32x32x16_bf16 v[16:31], a[88:91], v[56:59], v[16:31]
ds_read_b128 v[56:59], v5 offset:30720
s_waitcnt lgkmcnt(7)
v_mfma_f32_32x32x16_bf16 v[16:31], a[92:95], v[60:63], v[16:31]
ds_read_b128 v[60:63], v5 offset:31744
s_waitcnt lgkmcnt(7)
v_mfma_f32_32x32x16_bf16 v[16:31], a[96:99], v[32:35], v[16:31]
ds_read_b128 v[32:35], v5 offset:32768
s_waitcnt lgkmcnt(7)
v_mfma_f32_32x32x16_bf16 v[16:31], a[100:103], v[36:39], v[16:31]
ds_read_b128 v[36:39], v5 offset:33792
s_waitcnt lgkmcnt(7)
v_mfma_f32_32x32x16_bf16 v[16:31], a[104:107], v[40:43], v[16:31]
ds_read_b128 v[40:43], v5 offset:34816
s_waitcnt lgkmcnt(7)
v_mfma_f32_32x32x16_bf16 v[16:31], a[108:111], v[44:47], v[16:31]
ds_read_b128 v[44:47], v5 offset:35840
s_waitcnt lgkmcnt(7)
v_mfma_f32_32x32x16_bf16 v[16:31], a[112:115], v[48:51], v[16:31]
ds_read_b128 v[48:51], v5 offset:36864
s_waitcnt lgkmcnt(7)
v_mfma_f32_32x32x16_bf16 v[16:31], a[116:119], v[52:55], v[16:31]
ds_read_b128 v[52:55], v5 offset:37888
s_waitcnt lgkmcnt(7)
v_mfma_f32_32x32x16_bf16 v[16:31], a[120:123], v[56:59], v[16:31]
ds_read_b128 v[56:59], v5 offset:38912
s_waitcnt lgkmcnt(7)
v_mfma_f32_32x32x16_bf16 v[16:31], a[124:127], v[60:63], v[16:31]
ds_read_b128 v[60:63], v5 offset:39936
s_waitcnt lgkmcnt(7)
v_mfma_f32_32x32x16_bf16 v[16:31], a[128:131], v[32:35], v[16:31]
s_waitcnt lgkmcnt(6)
v_mfma_f32_32x32x16_bf16 v[16:31], a[132:135], v[36:39], v[16:31]
s_waitcnt lgkmcnt(5)
v_mfma_f32_32x32x16_bf16 v[16:31], a[136:139], v[40:43], v[16:31]
s_waitcnt lgkmcnt(4)
v_mfma_f32_32x32x16_bf16 v[16:31], a[140:143], v[44:47], v[16:31]
s_waitcnt lgkmcnt(3)
v_mfma_f32_32x32x16_bf16 v[16:31], a[144:147], v[48:51], v[16:31]
s_waitcnt lgkmcnt(2)
v_mfma_f32_32x32x16_bf16 v[16:31], a[148:151], v[52:55], v[16:31]
s_waitcnt lgkmcnt(1)
v_mfma_f32_32x32x16_bf16 v[16:31], a[152:155], v[56:59], v[16:31]
s_waitcnt lgkmcnt(0)
v_mfma_f32_32x32x16_bf16 v[16:31], a[156:159], v[60:63], v[16:31]
v_xor_b32 v5, 0xa000, v5
s_waitcnt vmcnt(10)
s_mov_b64 exec, 1
v_mov_b32 v8, s42
global_store_dword v7, v8, s[30:31] sc1
s_mov_b64 exec, -1
s_cmp_eq_u32 s61, 0
s_cbranch_scc1 L_H_skip
s_nop 3
v_add_f32 v16, v16, v80
v_add_f32 v17, v17, v81
v_add_f32 v18, v18, v82
v_add_f32 v19, v19, v83
v_add_f32 v20, v20, v84
v_add_f32 v21, v21, v85
v_add_f32 v22, v22, v86
v_add_f32 v23, v23, v87
v_mul_f32 v96, s60, abs(v16)
v_mul_f32 v97, s60, abs(v17)
v_mul_f32 v98, s60, abs(v18)
v_mul_f32 v99, s60, abs(v19)
v_mul_f32 v100, s60, abs(v20)
v_mul_f32 v101, s60, abs(v21)
v_mul_f32 v102, s60, abs(v22)
v_mul_f32 v103, s60, abs(v23)
v_exp_f32 v96, v96
v_exp_f32 v97, v97
v_exp_f32 v98, v98
v_exp_f32 v99, v99
v_exp_f32 v100, v100
v_exp_f32 v101, v101
v_exp_f32 v102, v102
v_exp_f32 v103, v103
v_cmp_lt_f32 s[44:45], 0, v16
v_cmp_lt_f32 s[46:47], 0, v17
v_cmp_lt_f32 s[48:49], 0, v18
v_cmp_lt_f32 s[50:51], 0, v19
v_cmp_lt_f32 s[52:53], 0, v20
v_cmp_lt_f32 s[54:55], 0, v21
v_cmp_lt_f32 s[56:57], 0, v22
v_cmp_lt_f32 s[58:59], 0, v23
v_mul_f32 v112, v96, v96
v_mul_f32 v113, v97, v97
v_mul_f32 v114, v98, v98
v_mul_f32 v115, v99, v99
v_mul_f32 v116, v100, v100
v_mul_f32 v117, v101, v101
v_mul_f32 v118, v102, v102
v_mul_f32 v119, v103, v103
v_fma_f32 v128, 2.0, v96, 1.0
v_fma_f32 v129, 2.0, v97, 1.0
v_fma_f32 v130, 2.0, v98, 1.0
v_fma_f32 v131, 2.0, v99, 1.0
v_fma_f32 v132, 2.0, v100, 1.0
v_fma_f32 v133, 2.0, v101, 1.0
v_fma_f32 v134, 2.0, v102, 1.0
v_fma_f32 v135, 2.0, v103, 1.0
v_fma_f32 v96, 2.0, v96, v112
v_fma_f32 v97, 2.0, v97, v113
v_fma_f32 v98, 2.0, v98, v114
v_fma_f32 v99, 2.0, v99, v115
v_fma_f32 v100, 2.0, v100, v116
v_fma_f32 v101, 2.0, v101, v117
v_fma_f32 v102, 2.0, v102, v118
v_fma_f32 v103, 2.0, v103, v119
v_add_f32 v112, v112, v112
v_add_f32 v113, v113, v113
v_add_f32 v114, v114, v114
v_add_f32 v115, v115, v115
v_add_f32 v116, v116, v116
v_add_f32 v117, v117, v117
v_add_f32 v118, v118, v118
v_add_f32 v119, v119, v119
v_cndmask_b32 v96, v96, v128, s[44:45]
v_cndmask_b32 v97, v97, v129, s[46:47]
v_cndmask_b32 v98, v98, v130, s[48:49]
v_cndmask_b32 v99, v99, v131, s[50:51]
v_cndmask_b32 v100, v100, v132, s[52:53]
v_cndmask_b32 v101, v101, v133, s[54:55]
v_cndmask_b32 v102, v102, v134, s[56:57]
v_cndmask_b32 v103, v103, v135, s[58:59]
v_cndmask_b32 v112, 2.0, v112, s[44:45]
v_cndmask_b32 v113, 2.0, v113, s[46:47]
v_cndmask_b32 v114, 2.0, v114, s[48:49]
v_cndmask_b32 v115, 2.0, v115, s[50:51]
v_cndmask_b32 v116, 2.0, v116, s[52:53]
v_cndmask_b32 v117, 2.0, v117, s[54:55]
v_cndmask_b32 v118, 2.0, v118, s[56:57]
v_cndmask_b32 v119, 2.0, v119, s[58:59]
v_add_f32 v112, v112, v96
v_add_f32 v113, v113, v97
v_add_f32 v114, v114, v98
v_add_f32 v115, v115, v99
v_add_f32 v116, v116, v100
v_add_f32 v117, v117, v101
v_add_f32 v118, v118, v102
v_add_f32 v119, v119, v103
v_rcp_f32 v112, v112
v_rcp_f32 v113, v113
v_rcp_f32 v114, v114
v_rcp_f32 v115, v115
v_rcp_f32 v116, v116
v_rcp_f32 v117, v117
v_rcp_f32 v118, v118
v_rcp_f32 v119, v119
v_mul_f32 v16, v16, v96
v_mul_f32 v17, v17, v97
v_mul_f32 v18, v18, v98
v_mul_f32 v19, v19, v99
v_mul_f32 v20, v20, v100
v_mul_f32 v21, v21, v101
v_mul_f32 v22, v22, v102
v_mul_f32 v23, v23, v103
v_mul_f32 v16, v16, v112
v_mul_f32 v17, v17, v113
v_mul_f32 v18, v18, v114
v_mul_f32 v19, v19, v115
v_mul_f32 v20, v20, v116
v_mul_f32 v21, v21, v117
v_mul_f32 v22, v22, v118
v_mul_f32 v23, v23, v119
v_add_f32 v24, v24, v88
v_add_f32 v25, v25, v89
v_add_f32 v26, v26, v90
v_add_f32 v27, v27, v91
v_add_f32 v28, v28, v92
v_add_f32 v29, v29, v93
v_add_f32 v30, v30, v94
v_add_f32 v31, v31, v95
v_mul_f32 v104, s60, abs(v24)
v_mul_f32 v105, s60, abs(v25)
v_mul_f32 v106, s60, abs(v26)
v_mul_f32 v107, s60, abs(v27)
v_mul_f32 v108, s60, abs(v28)
v_mul_f32 v109, s60, abs(v29)
v_mul_f32 v110, s60, abs(v30)
v_mul_f32 v111, s60, abs(v31)
v_exp_f32 v104, v104
v_exp_f32 v105, v105
v_exp_f32 v106, v106
v_exp_f32 v107, v107
v_exp_f32 v108, v108
v_exp_f32 v109, v109
v_exp_f32 v110, v110
v_exp_f32 v111, v111
v_cmp_lt_f32 s[44:45], 0, v24
v_cmp_lt_f32 s[46:47], 0, v25
v_cmp_lt_f32 s[48:49], 0, v26
v_cmp_lt_f32 s[50:51], 0, v27
v_cmp_lt_f32 s[52:53], 0, v28
v_cmp_lt_f32 s[54:55], 0, v29
v_cmp_lt_f32 s[56:57], 0, v30
v_cmp_lt_f32 s[58:59], 0, v31
v_mul_f32 v120, v104, v104
v_mul_f32 v121, v105, v105
v_mul_f32 v122, v106, v106
v_mul_f32 v123, v107, v107
v_mul_f32 v124, v108, v108
v_mul_f32 v125, v109, v109
v_mul_f32 v126, v110, v110
v_mul_f32 v127, v111, v111
v_fma_f32 v136, 2.0, v104, 1.0
v_fma_f32 v137, 2.0, v105, 1.0
v_fma_f32 v138, 2.0, v106, 1.0
v_fma_f32 v139, 2.0, v107, 1.0
v_fma_f32 v140, 2.0, v108, 1.0
v_fma_f32 v141, 2.0, v109, 1.0
v_fma_f32 v142, 2.0, v110, 1.0
v_fma_f32 v143, 2.0, v111, 1.0
v_fma_f32 v104, 2.0, v104, v120
v_fma_f32 v105, 2.0, v105, v121
v_fma_f32 v106, 2.0, v106, v122
v_fma_f32 v107, 2.0, v107, v123
v_fma_f32 v108, 2.0, v108, v124
v_fma_f32 v109, 2.0, v109, v125
v_fma_f32 v110, 2.0, v110, v126
v_fma_f32 v111, 2.0, v111, v127
v_add_f32 v120, v120, v120
v_add_f32 v121, v121, v121
v_add_f32 v122, v122, v122
v_add_f32 v123, v123, v123
v_add_f32 v124, v124, v124
v_add_f32 v125, v125, v125
v_add_f32 v126, v126, v126
v_add_f32 v127, v127, v127
v_cndmask_b32 v104, v104, v136, s[44:45]
v_cndmask_b32 v105, v105, v137, s[46:47]
v_cndmask_b32 v106, v106, v138, s[48:49]
v_cndmask_b32 v107, v107, v139, s[50:51]
v_cndmask_b32 v108, v108, v140, s[52:53]
v_cndmask_b32 v109, v109, v141, s[54:55]
v_cndmask_b32 v110, v110, v142, s[56:57]
v_cndmask_b32 v111, v111, v143, s[58:59]
v_cndmask_b32 v120, 2.0, v120, s[44:45]
v_cndmask_b32 v121, 2.0, v121, s[46:47]
v_cndmask_b32 v122, 2.0, v122, s[48:49]
v_cndmask_b32 v123, 2.0, v123, s[50:51]
v_cndmask_b32 v124, 2.0, v124, s[52:53]
v_cndmask_b32 v125, 2.0, v125, s[54:55]
v_cndmask_b32 v126, 2.0, v126, s[56:57]
v_cndmask_b32 v127, 2.0, v127, s[58:59]
v_add_f32 v120, v120, v104
v_add_f32 v121, v121, v105
v_add_f32 v122, v122, v106
v_add_f32 v123, v123, v107
v_add_f32 v124, v124, v108
v_add_f32 v125, v125, v109
v_add_f32 v126, v126, v110
v_add_f32 v127, v127, v111
v_rcp_f32 v120, v120
v_rcp_f32 v121, v121
v_rcp_f32 v122, v122
v_rcp_f32 v123, v123
v_rcp_f32 v124, v124
v_rcp_f32 v125, v125
v_rcp_f32 v126, v126
v_rcp_f32 v127, v127
v_mul_f32 v24, v24, v104
v_mul_f32 v25, v25, v105
v_mul_f32 v26, v26, v106
v_mul_f32 v27, v27, v107
v_mul_f32 v28, v28, v108
v_mul_f32 v29, v29, v109
v_mul_f32 v30, v30, v110
v_mul_f32 v31, v31, v111
v_mul_f32 v24, v24, v120
v_mul_f32 v25, v25, v121
v_mul_f32 v26, v26, v122
v_mul_f32 v27, v27, v123
v_mul_f32 v28, v28, v124
v_mul_f32 v29, v29, v125
v_mul_f32 v30, v30, v126
v_mul_f32 v31, v31, v127
v_cvt_pk_bf16_f32 v64, v16, v17
v_cvt_pk_bf16_f32 v65, v18, v19
v_cvt_pk_bf16_f32 v66, v20, v21
v_cvt_pk_bf16_f32 v67, v22, v23
v_cvt_pk_bf16_f32 v68, v24, v25
v_cvt_pk_bf16_f32 v69, v26, v27
v_cvt_pk_bf16_f32 v70, v28, v29
v_cvt_pk_bf16_f32 v71, v30, v31
global_store_dwordx4 v6, v[64:67], s[38:39] sc1
global_store_dwordx4 v6, v[68:71], s[38:39] offset:1024 sc1
s_branch L_H_done
L_H_skip:
global_load_dword v64, v7, s[30:31] sc1
global_load_dword v65, v7, s[30:31] sc1
L_H_done:
s_cmp_eq_u32 s42, 0
s_cbranch_scc0 L_H_nf0
s_waitcnt vmcnt(0)
s_mov_b64 exec, 1
v_mov_b32 v8, 1
global_store_dword v7, v8, s[30:31] sc1
s_mov_b64 exec, -1
s_waitcnt vmcnt(0)
L_H_nf0:
s_add_u32 s38, s38, 110592
s_addc_u32 s39, s39, 0
s_add_u32 s42, s42, 1
s_cmp_lt_u32 s42, 64
s_cbranch_scc1 L_H_loop
s_waitcnt vmcnt(0)
s_mov_b64 exec, 1
v_mov_b32 v8, 64
global_store_dword v7, v8, s[30:31] sc1
s_mov_b64 exec, -1
s_waitcnt vmcnt(0)
s_endpgm
L_H_wx0_s_28:
s_sleep 2
s_add_u32 s57, s57, 1
s_cmp_lt_u32 s57, 262144
s_cbranch_scc1 L_H_wx0
s_endpgm
L_H_wxn_s_29:
s_sleep 2
s_add_u32 s57, s57, 1
s_cmp_lt_u32 s57, 262144
s_cbranch_scc1 L_H_wxn
s_endpgm
L_R:
v_and_b32 v1, 63, v0
s_lshr_b32 s44, s34, 1
s_lshl_b32 s36, s35, 4
s_add_u32 s36, s36, s44
s_and_b32 s37, s34, 1
s_lshl_b32 s38, s35, 5
s_add_u32 s38, s38, s34
s_lshl_b32 s39, s32, 5
s_add_u32 s39, s39, s34
s_cmp_lt_u32 s39, 80
s_cselect_b32 s40, 1, 0
v_mov_b32 v4, -1
v_mov_b32 v5, -1
v_mov_b32 v6, -1
v_mov_b32 v7, -1
v_lshlrev_b32 v2, 4, v0
s_mul_i32 s44, s38, 10240
s_add_u32 s48, s30, 5242880
s_addc_u32 s49, s31, 0
s_add_u32 s48, s48, s44
s_addc_u32 s49, s49, 0
v_add_u32 v3, 4096, v2
v_min_u32 v8, 2032, v2
v_add_u32 v8, 8192, v8
global_store_dwordx4 v2, v[4:7], s[48:49] sc1
global_store_dwordx4 v3, v[4:7], s[48:49] sc1
global_store_dwordx4 v8, v[4:7], s[48:49] sc1
s_add_u32 s48, s48, 655360
s_addc_u32 s49, s49, 0
global_store_dwordx4 v2, v[4:7], s[48:49] sc1
global_store_dwordx4 v3, v[4:7], s[48:49] sc1
global_store_dwordx4 v8, v[4:7], s[48:49] sc1
s_lshl_b32 s44, s35, 15
s_lshl_b32 s45, s34, 10
s_add_u32 s44, s44, s45
s_and_b32 s45, s32, 1
s_lshl_b32 s45, s45, 16
s_add_u32 s44, s44, s45
s_add_u32 s48, s30, 4325376
s_addc_u32 s49, s31, 0
s_add_u32 s48, s48, s44
s_addc_u32 s49, s49, 0
v_lshlrev_b32 v9, 4, v1
global_store_dwordx4 v9, v[4:7], s[48:49] sc1
s_mul_i32 s44, s35, 10240
s_mul_i32 s45, s34, 320
s_add_u32 s44, s44, s45
s_and_b32 s45, s32, 1
s_mul_i32 s45, s45, 20480
s_add_u32 s44, s44, s45
s_add_u32 s48, s30, 4194304
s_addc_u32 s49, s31, 0
s_add_u32 s48, s48, s44
s_addc_u32 s49, s49, 0
v_min_u32 v9, 304, v9
global_store_dwordx4 v9, v[4:7], s[48:49] sc1
s_lshl_b32 s44, s36, 8
s_add_u32 s50, s12, s44
s_addc_u32 s51, s13, 0
s_add_u32 s52, s14, s44
s_addc_u32 s53, s15, 0
s_lshl_b32 s45, s37, 7
s_add_u32 s44, s44, s45
s_add_u32 s54, s16, s44
s_addc_u32 s55, s17, 0
v_lshrrev_b32 v2, 4, v1
v_and_b32 v3, 15, v1
v_lshrrev_b32 v4, 1, v3
v_and_b32 v5, 1, v3
v_and_b32 v6, 1, v2
s_and_b32 s44, s32, 1
s_lshl_b32 s44, s44, 2
v_or_b32 v6, s44, v6
s_lshl_b32 s45, s32, 4
v_add_u32 v7, s45, v2
v_or_b32 v8, 0, v6
v_xor_b32 v8, v8, v4
v_lshl_add_u32 v8, v8, 1, v5
v_add_u32 v9, 0, v7
v_lshlrev_b32 v9, 13, v9
v_lshl_add_u32 v10, v8, 4, v9
v_or_b32 v8, 2, v6
v_xor_b32 v8, v8, v4
v_lshl_add_u32 v8, v8, 1, v5
v_add_u32 v9, 4, v7
v_lshlrev_b32 v9, 13, v9
v_lshl_add_u32 v11, v8, 4, v9
v_or_b32 v8, 0, v6
v_xor_b32 v8, v8, v4
v_lshl_add_u32 v8, v8, 1, v5
v_add_u32 v9, 8, v7
v_lshlrev_b32 v9, 13, v9
v_lshl_add_u32 v12, v8, 4, v9
v_or_b32 v8, 2, v6
v_xor_b32 v8, v8, v4
v_lshl_add_u32 v8, v8, 1, v5
v_add_u32 v9, 12, v7
v_lshlrev_b32 v9, 13, v9
v_lshl_add_u32 v13, v8, 4, v9
v_lshrrev_b32 v2, 3, v1
v_and_b32 v3, 7, v1
v_lshrrev_b32 v4, 1, v3
v_and_b32 v5, 1, v3
v_bfe_u32 v6, v2, 2, 1
s_and_b32 s44, s32, 1
s_lshl_b32 s44, s44, 1
v_or_b32 v6, s44, v6
v_xor_b32 v6, v6, v4
v_lshl_add_u32 v6, v6, 1, v5
s_lshl_b32 s45, s32, 4
s_add_u32 s45, s45, 0
v_add_u32 v9, s45, v2
v_lshlrev_b32 v9, 13, v9
v_lshl_add_u32 v14, v6, 4, v9
s_lshl_b32 s45, s32, 4
s_add_u32 s45, s45, 8
v_add_u32 v9, s45, v2
v_lshlrev_b32 v9, 13, v9
v_lshl_add_u32 v15, v6, 4, v9
s_lshl_b32 s44, s36, 7
s_lshl_b32 s45, s37, 6
s_add_u32 s44, s44, s45
s_mul_i32 s44, s44, 1280
s_add_u32 s48, s18, s44
s_addc_u32 s49, s19, 0
s_mul_i32 s46, s32, 1280
v_add_u32 v16, s46, v1
s_mul_i32 s46, s32, 20480
s_add_u32 s46, s46, 81920
s_mov_b32 s47, 52429
v_mul_lo_u32 v17, v16, s47
v_lshrrev_b32 v17, 22, v17
v_mul_u32_u24 v18, 80, v17
v_sub_u32 v18, v16, v18
v_and_b32 v19, 1, v17
v_bfe_u32 v20, v17, 2, 2
v_lshl_add_u32 v19, v20, 1, v19
v_lshlrev_b32 v19, 1, v19
v_xor_b32 v18, v18, v19
v_mul_u32_u24 v17, 1280, v17
v_lshl_add_u32 v17, v18, 4, v17
s_add_u32 m0, s46, 0
s_nop 0
global_load_lds_dwordx4 v17, s[48:49]
v_add_u32 v16, 64, v16
v_mul_lo_u32 v17, v16, s47
v_lshrrev_b32 v17, 22, v17
v_mul_u32_u24 v18, 80, v17
v_sub_u32 v18, v16, v18
v_and_b32 v19, 1, v17
v_bfe_u32 v20, v17, 2, 2
v_lshl_add_u32 v19, v20, 1, v19
v_lshlrev_b32 v19, 1, v19
v_xor_b32 v18, v18, v19
v_mul_u32_u24 v17, 1280, v17
v_lshl_add_u32 v17, v18, 4, v17
s_add_u32 m0, s46, 1024
s_nop 0
global_load_lds_dwordx4 v17, s[48:49]
v_add_u32 v16, 64, v16
v_mul_lo_u32 v17, v16, s47
v_lshrrev_b32 v17, 22, v17
v_mul_u32_u24 v18, 80, v17
v_sub_u32 v18, v16, v18
v_and_b32 v19, 1, v17
v_bfe_u32 v20, v17, 2, 2
v_lshl_add_u32 v19, v20, 1, v19
v_lshlrev_b32 v19, 1, v19
v_xor_b32 v18, v18, v19
v_mul_u32_u24 v17, 1280, v17
v_lshl_add_u32 v17, v18, 4, v17
s_add_u32 m0, s46, 2048
s_nop 0
global_load_lds_dwordx4 v17, s[48:49]
v_add_u32 v16, 64, v16
v_mul_lo_u32 v17, v16, s47
v_lshrrev_b32 v17, 22, v17
v_mul_u32_u24 v18, 80, v17
v_sub_u32 v18, v16, v18
v_and_b32 v19, 1, v17
v_bfe_u32 v20, v17, 2, 2
v_lshl_add_u32 v19, v20, 1, v19
v_lshlrev_b32 v19, 1, v19
v_xor_b32 v18, v18, v19
v_mul_u32_u24 v17, 1280, v17
v_lshl_add_u32 v17, v18, 4, v17
s_add_u32 m0, s46, 3072
s_nop 0
global_load_lds_dwordx4 v17, s[48:49]
v_add_u32 v16, 64, v16
v_mul_lo_u32 v17, v16, s47
v_lshrrev_b32 v17, 22, v17
v_mul_u32_u24 v18, 80, v17
v_sub_u32 v18, v16, v18
v_and_b32 v19, 1, v17
v_bfe_u32 v20, v17, 2, 2
v_lshl_add_u32 v19, v20, 1, v19
v_lshlrev_b32 v19, 1, v19
v_xor_b32 v18, v18, v19
v_mul_u32_u24 v17, 1280, v17
v_lshl_add_u32 v17, v18, 4, v17
s_add_u32 m0, s46, 4096
s_nop 0
global_load_lds_dwordx4 v17, s[48:49]
v_add_u32 v16, 64, v16
v_mul_lo_u32 v17, v16, s47
v_lshrrev_b32 v17, 22, v17
v_mul_u32_u24 v18, 80, v17
v_sub_u32 v18, v16, v18
v_and_b32 v19, 1, v17
v_bfe_u32 v20, v17, 2, 2
v_lshl_add_u32 v19, v20, 1, v19
v_lshlrev_b32 v19, 1, v19
v_xor_b32 v18, v18, v19
v_mul_u32_u24 v17, 1280, v17
v_lshl_add_u32 v17, v18, 4, v17
s_add_u32 m0, s46, 5120
s_nop 0
global_load_lds_dwordx4 v17, s[48:49]
v_add_u32 v16, 64, v16
v_mul_lo_u32 v17, v16, s47
v_lshrrev_b32 v17, 22, v17
v_mul_u32_u24 v18, 80, v17
v_sub_u32 v18, v16, v18
v_and_b32 v19, 1, v17
v_bfe_u32 v20, v17, 2, 2
v_lshl_add_u32 v19, v20, 1, v19
v_lshlrev_b32 v19, 1, v19
v_xor_b32 v18, v18, v19
v_mul_u32_u24 v17, 1280, v17
v_lshl_add_u32 v17, v18, 4, v17
s_add_u32 m0, s46, 6144
s_nop 0
global_load_lds_dwordx4 v17, s[48:49]
v_add_u32 v16, 64, v16
v_mul_lo_u32 v17, v16, s47
v_lshrrev_b32 v17, 22, v17
v_mul_u32_u24 v18, 80, v17
v_sub_u32 v18, v16, v18
v_and_b32 v19, 1, v17
v_bfe_u32 v20, v17, 2, 2
v_lshl_add_u32 v19, v20, 1, v19
v_lshlrev_b32 v19, 1, v19
v_xor_b32 v18, v18, v19
v_mul_u32_u24 v17, 1280, v17
v_lshl_add_u32 v17, v18, 4, v17
s_add_u32 m0, s46, 7168
s_nop 0
global_load_lds_dwordx4 v17, s[48:49]
v_add_u32 v16, 64, v16
v_mul_lo_u32 v17, v16, s47
v_lshrrev_b32 v17, 22, v17
v_mul_u32_u24 v18, 80, v17
v_sub_u32 v18, v16, v18
v_and_b32 v19, 1, v17
v_bfe_u32 v20, v17, 2, 2
v_lshl_add_u32 v19, v20, 1, v19
v_lshlrev_b32 v19, 1, v19
v_xor_b32 v18, v18, v19
v_mul_u32_u24 v17, 1280, v17
v_lshl_add_u32 v17, v18, 4, v17
s_add_u32 m0, s46, 8192
s_nop 0
global_load_lds_dwordx4 v17, s[48:49]
v_add_u32 v16, 64, v16
v_mul_lo_u32 v17, v16, s47
v_lshrrev_b32 v17, 22, v17
v_mul_u32_u24 v18, 80, v17
v_sub_u32 v18, v16, v18
v_and_b32 v19, 1, v17
v_bfe_u32 v20, v17, 2, 2
v_lshl_add_u32 v19, v20, 1, v19
v_lshlrev_b32 v19, 1, v19
v_xor_b32 v18, v18, v19
v_mul_u32_u24 v17, 1280, v17
v_lshl_add_u32 v17, v18, 4, v17
s_add_u32 m0, s46, 9216
s_nop 0
global_load_lds_dwordx4 v17, s[48:49]
v_add_u32 v16, 64, v16
v_mul_lo_u32 v17, v16, s47
v_lshrrev_b32 v17, 22, v17
v_mul_u32_u24 v18, 80, v17
v_sub_u32 v18, v16, v18
v_and_b32 v19, 1, v17
v_bfe_u32 v20, v17, 2, 2
v_lshl_add_u32 v19, v20, 1, v19
v_lshlrev_b32 v19, 1, v19
v_xor_b32 v18, v18, v19
v_mul_u32_u24 v17, 1280, v17
v_lshl_add_u32 v17, v18, 4, v17
s_add_u32 m0, s46, 10240
s_nop 0
global_load_lds_dwordx4 v17, s[48:49]
v_add_u32 v16, 64, v16
v_mul_lo_u32 v17, v16, s47
v_lshrrev_b32 v17, 22, v17
v_mul_u32_u24 v18, 80, v17
v_sub_u32 v18, v16, v18
v_and_b32 v19, 1, v17
v_bfe_u32 v20, v17, 2, 2
v_lshl_add_u32 v19, v20, 1, v19
v_lshlrev_b32 v19, 1, v19
v_xor_b32 v18, v18, v19
v_mul_u32_u24 v17, 1280, v17
v_lshl_add_u32 v17, v18, 4, v17
s_add_u32 m0, s46, 11264
s_nop 0
global_load_lds_dwordx4 v17, s[48:49]
v_add_u32 v16, 64, v16
v_mul_lo_u32 v17, v16, s47
v_lshrrev_b32 v17, 22, v17
v_mul_u32_u24 v18, 80, v17
v_sub_u32 v18, v16, v18
v_and_b32 v19, 1, v17
v_bfe_u32 v20, v17, 2, 2
v_lshl_add_u32 v19, v20, 1, v19
v_lshlrev_b32 v19, 1, v19
v_xor_b32 v18, v18, v19
v_mul_u32_u24 v17, 1280, v17
v_lshl_add_u32 v17, v18, 4, v17
s_add_u32 m0, s46, 12288
s_nop 0
global_load_lds_dwordx4 v17, s[48:49]
v_add_u32 v16, 64, v16
v_mul_lo_u32 v17, v16, s47
v_lshrrev_b32 v17, 22, v17
v_mul_u32_u24 v18, 80, v17
v_sub_u32 v18, v16, v18
v_and_b32 v19, 1, v17
v_bfe_u32 v20, v17, 2, 2
v_lshl_add_u32 v19, v20, 1, v19
v_lshlrev_b32 v19, 1, v19
v_xor_b32 v18, v18, v19
v_mul_u32_u24 v17, 1280, v17
v_lshl_add_u32 v17, v18, 4, v17
s_add_u32 m0, s46, 13312
s_nop 0
global_load_lds_dwordx4 v17, s[48:49]
v_add_u32 v16, 64, v16
v_mul_lo_u32 v17, v16, s47
v_lshrrev_b32 v17, 22, v17
v_mul_u32_u24 v18, 80, v17
v_sub_u32 v18, v16, v18
v_and_b32 v19, 1, v17
v_bfe_u32 v20, v17, 2, 2
v_lshl_add_u32 v19, v20, 1, v19
v_lshlrev_b32 v19, 1, v19
v_xor_b32 v18, v18, v19
v_mul_u32_u24 v17, 1280, v17
v_lshl_add_u32 v17, v18, 4, v17
s_add_u32 m0, s46, 14336
s_nop 0
global_load_lds_dwordx4 v17, s[48:49]
v_add_u32 v16, 64, v16
v_mul_lo_u32 v17, v16, s47
v_lshrrev_b32 v17, 22, v17
v_mul_u32_u24 v18, 80, v17
v_sub_u32 v18, v16, v18
v_and_b32 v19, 1, v17
v_bfe_u32 v20, v17, 2, 2
v_lshl_add_u32 v19, v20, 1, v19
v_lshlrev_b32 v19, 1, v19
v_xor_b32 v18, v18, v19
v_mul_u32_u24 v17, 1280, v17
v_lshl_add_u32 v17, v18, 4, v17
s_add_u32 m0, s46, 15360
s_nop 0
global_load_lds_dwordx4 v17, s[48:49]
v_add_u32 v16, 64, v16
v_mul_lo_u32 v17, v16, s47
v_lshrrev_b32 v17, 22, v17
v_mul_u32_u24 v18, 80, v17
v_sub_u32 v18, v16, v18
v_and_b32 v19, 1, v17
v_bfe_u32 v20, v17, 2, 2
v_lshl_add_u32 v19, v20, 1, v19
v_lshlrev_b32 v19, 1, v19
v_xor_b32 v18, v18, v19
v_mul_u32_u24 v17, 1280, v17
v_lshl_add_u32 v17, v18, 4, v17
s_add_u32 m0, s46, 16384
s_nop 0
global_load_lds_dwordx4 v17, s[48:49]
v_add_u32 v16, 64, v16
v_mul_lo_u32 v17, v16, s47
v_lshrrev_b32 v17, 22, v17
v_mul_u32_u24 v18, 80, v17
v_sub_u32 v18, v16, v18
v_and_b32 v19, 1, v17
v_bfe_u32 v20, v17, 2, 2
v_lshl_add_u32 v19, v20, 1, v19
v_lshlrev_b32 v19, 1, v19
v_xor_b32 v18, v18, v19
v_mul_u32_u24 v17, 1280, v17
v_lshl_add_u32 v17, v18, 4, v17
s_add_u32 m0, s46, 17408
s_nop 0
global_load_lds_dwordx4 v17, s[48:49]
v_add_u32 v16, 64, v16
v_mul_lo_u32 v17, v16, s47
v_lshrrev_b32 v17, 22, v17
v_mul_u32_u24 v18, 80, v17
v_sub_u32 v18, v16, v18
v_and_b32 v19, 1, v17
v_bfe_u32 v20, v17, 2, 2
v_lshl_add_u32 v19, v20, 1, v19
v_lshlrev_b32 v19, 1, v19
v_xor_b32 v18, v18, v19
v_mul_u32_u24 v17, 1280, v17
v_lshl_add_u32 v17, v18, 4, v17
s_add_u32 m0, s46, 18432
s_nop 0
global_load_lds_dwordx4 v17, s[48:49]
v_add_u32 v16, 64, v16
v_mul_lo_u32 v17, v16, s47
v_lshrrev_b32 v17, 22, v17
v_mul_u32_u24 v18, 80, v17
v_sub_u32 v18, v16, v18
v_and_b32 v19, 1, v17
v_bfe_u32 v20, v17, 2, 2
v_lshl_add_u32 v19, v20, 1, v19
v_lshlrev_b32 v19, 1, v19
v_xor_b32 v18, v18, v19
v_mul_u32_u24 v17, 1280, v17
v_lshl_add_u32 v17, v18, 4, v17
s_add_u32 m0, s46, 19456
s_nop 0
global_load_lds_dwordx4 v17, s[48:49]
v_add_u32 v16, 64, v16
s_lshl_b32 s44, s32, 12
s_add_u32 s44, s44, 0
s_add_u32 m0, s44, 0
s_nop 0
global_load_lds_dwordx4 v10, s[50:51]
s_add_u32 m0, s44, 1024
s_nop 0
global_load_lds_dwordx4 v11, s[50:51]
s_add_u32 m0, s44, 2048
s_nop 0
global_load_lds_dwordx4 v12, s[50:51]
s_add_u32 m0, s44, 3072
s_nop 0
global_load_lds_dwordx4 v13, s[50:51]
s_add_u32 m0, s44, 16384
s_nop 0
global_load_lds_dwordx4 v10, s[52:53]
s_add_u32 m0, s44, 17408
s_nop 0
global_load_lds_dwordx4 v11, s[52:53]
s_add_u32 m0, s44, 18432
s_nop 0
global_load_lds_dwordx4 v12, s[52:53]
s_add_u32 m0, s44, 19456
s_nop 0
global_load_lds_dwordx4 v13, s[52:53]
s_lshl_b32 s44, s32, 11
s_add_u32 s44, s44, 32768
s_add_u32 m0, s44, 0
s_nop 0
global_load_lds_dwordx4 v14, s[54:55]
s_add_u32 m0, s44, 1024
s_nop 0
global_load_lds_dwordx4 v15, s[54:55]
s_add_u32 s50, s50, 524288
s_addc_u32 s51, s51, 0
s_add_u32 s52, s52, 524288
s_addc_u32 s53, s53, 0
s_add_u32 s54, s54, 524288
s_addc_u32 s55, s55, 0
s_lshl_b32 s44, s32, 12
s_add_u32 s44, s44, 40960
s_add_u32 m0, s44, 0
s_nop 0
global_load_lds_dwordx4 v10, s[50:51]
s_add_u32 m0, s44, 1024
s_nop 0
global_load_lds_dwordx4 v11, s[50:51]
s_add_u32 m0, s44, 2048
s_nop 0
global_load_lds_dwordx4 v12, s[50:51]
s_add_u32 m0, s44, 3072
s_nop 0
global_load_lds_dwordx4 v13, s[50:51]
s_add_u32 m0, s44, 16384
s_nop 0
global_load_lds_dwordx4 v10, s[52:53]
s_add_u32 m0, s44, 17408
s_nop 0
global_load_lds_dwordx4 v11, s[52:53]
s_add_u32 m0, s44, 18432
s_nop 0
global_load_lds_dwordx4 v12, s[52:53]
s_add_u32 m0, s44, 19456
s_nop 0
global_load_lds_dwordx4 v13, s[52:53]
s_lshl_b32 s44, s32, 11
s_add_u32 s44, s44, 73728
s_add_u32 m0, s44, 0
s_nop 0
global_load_lds_dwordx4 v14, s[54:55]
s_add_u32 m0, s44, 1024
s_nop 0
global_load_lds_dwordx4 v15, s[54:55]
s_add_u32 s50, s50, 524288
s_addc_u32 s51, s51, 0
s_add_u32 s52, s52, 524288
s_addc_u32 s53, s53, 0
s_add_u32 s54, s54, 524288
s_addc_u32 s55, s55, 0
v_lshrrev_b32 v5, 4, v1
v_bfe_u32 v6, v1, 2, 2
v_lshrrev_b32 v7, 1, v5
v_lshlrev_b32 v7, 4, v7
v_and_b32 v8, 1, v5
v_lshl_add_u32 v7, v8, 2, v7
v_and_b32 v9, 1, v6
v_add_u32 v7, v7, v9
v_lshrrev_b32 v16, 1, v6
v_lshl_add_u32 v7, v16, 3, v7
v_mul_u32_u24 v7, 1280, v7
v_and_b32 v17, 3, v1
v_lshl_add_u32 v7, v17, 3, v7
v_add_u32 v7, 81920, v7
v_lshl_add_u32 v9, v8, 1, v9
v_lshl_add_u32 v9, v16, 2, v9
s_waitcnt vmcnt(20)
s_barrier
s_cmp_eq_u32 s32, 0
s_cbranch_scc0 L_R_noid
s_mov_b64 exec, 1
v_mov_b32 v28, 160
v_mov_b32 v29, 1
global_atomic_add v28, v29, s[28:29]
s_mov_b64 exec, -1
L_R_noid:
s_mul_i32 s44, s32, 10
s_add_u32 s44, s44, 0
s_and_b32 s45, s44, 7
s_and_b32 s46, s44, 0xf8
v_xor_b32 v17, s45, v9
v_add_u32 v17, s46, v17
v_lshl_add_u32 v17, v17, 5, v7
ds_read_b64_tr_b16 v[30:31], v17 offset:0
ds_read_b64_tr_b16 v[32:33], v17 offset:2560
ds_read_b64_tr_b16 v[34:35], v17 offset:40960
ds_read_b64_tr_b16 v[36:37], v17 offset:43520
s_mul_i32 s44, s32, 10
s_add_u32 s44, s44, 1
s_and_b32 s45, s44, 7
s_and_b32 s46, s44, 0xf8
v_xor_b32 v17, s45, v9
v_add_u32 v17, s46, v17
v_lshl_add_u32 v17, v17, 5, v7
ds_read_b64_tr_b16 v[38:39], v17 offset:0
ds_read_b64_tr_b16 v[40:41], v17 offset:2560
ds_read_b64_tr_b16 v[42:43], v17 offset:40960
ds_read_b64_tr_b16 v[44:45], v17 offset:43520
s_mul_i32 s44, s32, 10
s_add_u32 s44, s44, 2
s_and_b32 s45, s44, 7
s_and_b32 s46, s44, 0xf8
v_xor_b32 v17, s45, v9
v_add_u32 v17, s46, v17
v_lshl_add_u32 v17, v17, 5, v7
ds_read_b64_tr_b16 v[46:47], v17 offset:0
ds_read_b64_tr_b16 v[48:49], v17 offset:2560
ds_read_b64_tr_b16 v[50:51], v17 offset:40960
ds_read_b64_tr_b16 v[52:53], v17 offset:43520
s_waitcnt lgkmcnt(0)
s_mul_i32 s44, s32, 10
s_add_u32 s44, s44, 3
s_and_b32 s45, s44, 7
s_and_b32 s46, s44, 0xf8
v_xor_b32 v17, s45, v9
v_add_u32 v17, s46, v17
v_lshl_add_u32 v17, v17, 5, v7
ds_read_b64_tr_b16 v[54:55], v17 offset:0
ds_read_b64_tr_b16 v[56:57], v17 offset:2560
ds_read_b64_tr_b16 v[58:59], v17 offset:40960
ds_read_b64_tr_b16 v[60:61], v17 offset:43520
s_mul_i32 s44, s32, 10
s_add_u32 s44, s44, 4
s_and_b32 s45, s44, 7
s_and_b32 s46, s44, 0xf8
v_xor_b32 v17, s45, v9
v_add_u32 v17, s46, v17
v_lshl_add_u32 v17, v17, 5, v7
ds_read_b64_tr_b16 v[62:63], v17 offset:0
ds_read_b64_tr_b16 v[64:65], v17 offset:2560
ds_read_b64_tr_b16 v[66:67], v17 offset:40960
ds_read_b64_tr_b16 v[68:69], v17 offset:43520
s_mul_i32 s44, s32, 10
s_add_u32 s44, s44, 5
s_and_b32 s45, s44, 7
s_and_b32 s46, s44, 0xf8
v_xor_b32 v17, s45, v9
v_add_u32 v17, s46, v17
v_lshl_add_u32 v17, v17, 5, v7
ds_read_b64_tr_b16 v[70:71], v17 offset:0
ds_read_b64_tr_b16 v[72:73], v17 offset:2560
ds_read_b64_tr_b16 v[74:75], v17 offset:40960
ds_read_b64_tr_b16 v[76:77], v17 offset:43520
s_waitcnt lgkmcnt(0)
s_mul_i32 s44, s32, 10
s_add_u32 s44, s44, 6
s_and_b32 s45, s44, 7
s_and_b32 s46, s44, 0xf8
v_xor_b32 v17, s45, v9
v_add_u32 v17, s46, v17
v_lshl_add_u32 v17, v17, 5, v7
ds_read_b64_tr_b16 v[78:79], v17 offset:0
ds_read_b64_tr_b16 v[80:81], v17 offset:2560
ds_read_b64_tr_b16 v[82:83], v17 offset:40960
ds_read_b64_tr_b16 v[84:85], v17 offset:43520
s_mul_i32 s44, s32, 10
s_add_u32 s44, s44, 7
s_and_b32 s45, s44, 7
s_and_b32 s46, s44, 0xf8
v_xor_b32 v17, s45, v9
v_add_u32 v17, s46, v17
v_lshl_add_u32 v17, v17, 5, v7
ds_read_b64_tr_b16 v[86:87], v17 offset:0
ds_read_b64_tr_b16 v[88:89], v17 offset:2560
ds_read_b64_tr_b16 v[90:91], v17 offset:40960
ds_read_b64_tr_b16 v[92:93], v17 offset:43520
s_mul_i32 s44, s32, 10
s_add_u32 s44, s44, 8
s_and_b32 s45, s44, 7
s_and_b32 s46, s44, 0xf8
v_xor_b32 v17, s45, v9
v_add_u32 v17, s46, v17
v_lshl_add_u32 v17, v17, 5, v7
ds_read_b64_tr_b16 v[94:95], v17 offset:0
ds_read_b64_tr_b16 v[96:97], v17 offset:2560
ds_read_b64_tr_b16 v[98:99], v17 offset:40960
ds_read_b64_tr_b16 v[100:101], v17 offset:43520
s_waitcnt lgkmcnt(0)
s_mul_i32 s44, s32, 10
s_add_u32 s44, s44, 9
s_and_b32 s45, s44, 7
s_and_b32 s46, s44, 0xf8
v_xor_b32 v17, s45, v9
v_add_u32 v17, s46, v17
v_lshl_add_u32 v17, v17, 5, v7
ds_read_b64_tr_b16 v[102:103], v17 offset:0
ds_read_b64_tr_b16 v[104:105], v17 offset:2560
ds_read_b64_tr_b16 v[106:107], v17 offset:40960
ds_read_b64_tr_b16 v[108:109], v17 offset:43520
s_waitcnt lgkmcnt(0)
s_barrier
s_lshl_b32 s44, s32, 12
s_add_u32 s44, s44, 81920
s_add_u32 m0, s44, 0
s_nop 0
global_load_lds_dwordx4 v10, s[50:51]
s_add_u32 m0, s44, 1024
s_nop 0
global_load_lds_dwordx4 v11, s[50:51]
s_add_u32 m0, s44, 2048
s_nop 0
global_load_lds_dwordx4 v12, s[50:51]
s_add_u32 m0, s44, 3072
s_nop 0
global_load_lds_dwordx4 v13, s[50:51]
s_add_u32 m0, s44, 16384
s_nop 0
global_load_lds_dwordx4 v10, s[52:53]
s_add_u32 m0, s44, 17408
s_nop 0
global_load_lds_dwordx4 v11, s[52:53]
s_add_u32 m0, s44, 18432
s_nop 0
global_load_lds_dwordx4 v12, s[52:53]
s_add_u32 m0, s44, 19456
s_nop 0
global_load_lds_dwordx4 v13, s[52:53]
s_lshl_b32 s44, s32, 11
s_add_u32 s44, s44, 114688
s_add_u32 m0, s44, 0
s_nop 0
global_load_lds_dwordx4 v14, s[54:55]
s_add_u32 m0, s44, 1024
s_nop 0
global_load_lds_dwordx4 v15, s[54:55]
s_add_u32 s50, s50, 524288
s_addc_u32 s51, s51, 0
s_add_u32 s52, s52, 524288
s_addc_u32 s53, s53, 0
s_add_u32 s54, s54, 524288
s_addc_u32 s55, s55, 0
s_lshl_b32 s44, s32, 12
s_add_u32 s44, s44, 122880
s_add_u32 m0, s44, 0
s_nop 0
global_load_lds_dwordx4 v10, s[50:51]
s_add_u32 m0, s44, 1024
s_nop 0
global_load_lds_dwordx4 v11, s[50:51]
s_add_u32 m0, s44, 2048
s_nop 0
global_load_lds_dwordx4 v12, s[50:51]
s_add_u32 m0, s44, 3072
s_nop 0
global_load_lds_dwordx4 v13, s[50:51]
s_add_u32 m0, s44, 16384
s_nop 0
global_load_lds_dwordx4 v10, s[52:53]
s_add_u32 m0, s44, 17408
s_nop 0
global_load_lds_dwordx4 v11, s[52:53]
s_add_u32 m0, s44, 18432
s_nop 0
global_load_lds_dwordx4 v12, s[52:53]
s_add_u32 m0, s44, 19456
s_nop 0
global_load_lds_dwordx4 v13, s[52:53]
s_lshl_b32 s44, s32, 11
s_add_u32 s44, s44, 155648
s_add_u32 m0, s44, 0
s_nop 0
global_load_lds_dwordx4 v14, s[54:55]
s_add_u32 m0, s44, 1024
s_nop 0
global_load_lds_dwordx4 v15, s[54:55]
s_add_u32 s50, s50, 524288
s_addc_u32 s51, s51, 0
s_add_u32 s52, s52, 524288
s_addc_u32 s53, s53, 0
s_add_u32 s54, s54, 524288
s_addc_u32 s55, s55, 0
v_lshrrev_b32 v5, 4, v1
v_bfe_u32 v6, v1, 2, 2
v_lshlrev_b32 v7, 2, v5
v_and_b32 v8, 1, v6
v_add_u32 v7, v7, v8
v_lshrrev_b32 v9, 1, v6
v_lshl_add_u32 v7, v9, 4, v7
v_and_b32 v16, 1, v5
v_lshl_add_u32 v17, v16, 1, v8
v_lshl_add_u32 v17, v9, 2, v17
v_lshl_add_u32 v21, v9, 1, v16
v_and_b32 v22, 3, v1
v_lshlrev_b32 v23, 8, v7
v_lshl_add_u32 v23, v22, 3, v23
s_lshl_b32 s44, s32, 1
s_add_u32 s44, s44, 0
v_xor_b32 v24, s44, v17
v_lshl_add_u32 v18, v24, 5, v23
s_lshl_b32 s44, s32, 1
s_add_u32 s44, s44, 1
v_xor_b32 v24, s44, v17
v_lshl_add_u32 v19, v24, 5, v23
v_lshlrev_b32 v23, 7, v7
v_lshl_add_u32 v23, v22, 3, v23
v_add_u32 v23, 32768, v23
v_xor_b32 v24, s32, v21
v_lshl_add_u32 v20, v24, 5, v23
s_waitcnt vmcnt(30)
s_barrier
v_add_u32 v25, 0, v18
v_add_u32 v26, 0, v19
v_add_u32 v27, 0, v20
ds_read_b64_tr_b16 a[0:1], v25 offset:0
ds_read_b64_tr_b16 a[2:3], v25 offset:512
ds_read_b64_tr_b16 a[4:5], v25 offset:8192
ds_read_b64_tr_b16 a[6:7], v25 offset:8704
ds_read_b64_tr_b16 a[8:9], v26 offset:0
ds_read_b64_tr_b16 a[10:11], v26 offset:512
ds_read_b64_tr_b16 a[12:13], v26 offset:8192
ds_read_b64_tr_b16 a[14:15], v26 offset:8704
ds_read_b64_tr_b16 a[16:17], v25 offset:16384
ds_read_b64_tr_b16 a[18:19], v25 offset:16896
ds_read_b64_tr_b16 a[20:21], v25 offset:24576
ds_read_b64_tr_b16 a[22:23], v25 offset:25088
ds_read_b64_tr_b16 a[240:241], v26 offset:16384
ds_read_b64_tr_b16 a[242:243], v26 offset:16896
ds_read_b64_tr_b16 a[244:245], v26 offset:24576
s_waitcnt lgkmcnt(14)
ds_read_b64_tr_b16 a[246:247], v26 offset:25088
s_waitcnt lgkmcnt(14)
ds_read_b64_tr_b16 v[176:177], v27 offset:0
s_waitcnt lgkmcnt(14)
ds_read_b64_tr_b16 v[178:179], v27 offset:256
s_waitcnt lgkmcnt(14)
ds_read_b64_tr_b16 v[180:181], v27 offset:4096
s_waitcnt lgkmcnt(14)
ds_read_b64_tr_b16 v[182:183], v27 offset:4352
s_waitcnt lgkmcnt(0)
s_barrier
s_lshl_b32 s44, s32, 12
s_add_u32 s44, s44, 0
s_add_u32 m0, s44, 0
s_nop 0
global_load_lds_dwordx4 v10, s[50:51]
s_add_u32 m0, s44, 1024
s_nop 0
global_load_lds_dwordx4 v11, s[50:51]
s_add_u32 m0, s44, 2048
s_nop 0
global_load_lds_dwordx4 v12, s[50:51]
s_add_u32 m0, s44, 3072
s_nop 0
global_load_lds_dwordx4 v13, s[50:51]
s_add_u32 m0, s44, 16384
s_nop 0
global_load_lds_dwordx4 v10, s[52:53]
s_add_u32 m0, s44, 17408
s_nop 0
global_load_lds_dwordx4 v11, s[52:53]
s_add_u32 m0, s44, 18432
s_nop 0
global_load_lds_dwordx4 v12, s[52:53]
s_add_u32 m0, s44, 19456
s_nop 0
global_load_lds_dwordx4 v13, s[52:53]
s_lshl_b32 s44, s32, 11
s_add_u32 s44, s44, 32768
s_add_u32 m0, s44, 0
s_nop 0
global_load_lds_dwordx4 v14, s[54:55]
s_add_u32 m0, s44, 1024
s_nop 0
global_load_lds_dwordx4 v15, s[54:55]
s_add_u32 s50, s50, 524288
s_addc_u32 s51, s51, 0
s_add_u32 s52, s52, 524288
s_addc_u32 s53, s53, 0
s_add_u32 s54, s54, 524288
s_addc_u32 s55, s55, 0
s_waitcnt vmcnt(30)
s_barrier
v_add_u32 v25, 40960, v18
v_add_u32 v26, 40960, v19
v_add_u32 v27, 40960, v20
ds_read_b64_tr_b16 a[24:25], v25 offset:0
ds_read_b64_tr_b16 a[26:27], v25 offset:512
ds_read_b64_tr_b16 a[28:29], v25 offset:8192
ds_read_b64_tr_b16 a[30:31], v25 offset:8704
ds_read_b64_tr_b16 a[32:33], v26 offset:0
ds_read_b64_tr_b16 a[34:35], v26 offset:512
ds_read_b64_tr_b16 a[36:37], v26 offset:8192
ds_read_b64_tr_b16 a[38:39], v26 offset:8704
ds_read_b64_tr_b16 a[40:41], v25 offset:16384
ds_read_b64_tr_b16 a[42:43], v25 offset:16896
ds_read_b64_tr_b16 a[44:45], v25 offset:24576
ds_read_b64_tr_b16 a[46:47], v25 offset:25088
ds_read_b64_tr_b16 a[248:249], v26 offset:16384
ds_read_b64_tr_b16 a[250:251], v26 offset:16896
ds_read_b64_tr_b16 a[252:253], v26 offset:24576
s_waitcnt lgkmcnt(14)
ds_read_b64_tr_b16 a[254:255], v26 offset:25088
s_waitcnt lgkmcnt(14)
ds_read_b64_tr_b16 v[184:185], v27 offset:0
s_waitcnt lgkmcnt(14)
ds_read_b64_tr_b16 v[186:187], v27 offset:256
s_waitcnt lgkmcnt(14)
ds_read_b64_tr_b16 v[188:189], v27 offset:4096
s_waitcnt lgkmcnt(14)
ds_read_b64_tr_b16 v[190:191], v27 offset:4352
s_waitcnt lgkmcnt(0)
s_barrier
s_lshl_b32 s44, s32, 12
s_add_u32 s44, s44, 40960
s_add_u32 m0, s44, 0
s_nop 0
global_load_lds_dwordx4 v10, s[50:51]
s_add_u32 m0, s44, 1024
s_nop 0
global_load_lds_dwordx4 v11, s[50:51]
s_add_u32 m0, s44, 2048
s_nop 0
global_load_lds_dwordx4 v12, s[50:51]
s_add_u32 m0, s44, 3072
s_nop 0
global_load_lds_dwordx4 v13, s[50:51]
s_add_u32 m0, s44, 16384
s_nop 0
global_load_lds_dwordx4 v10, s[52:53]
s_add_u32 m0, s44, 17408
s_nop 0
global_load_lds_dwordx4 v11, s[52:53]
s_add_u32 m0, s44, 18432
s_nop 0
global_load_lds_dwordx4 v12, s[52:53]
s_add_u32 m0, s44, 19456
s_nop 0
global_load_lds_dwordx4 v13, s[52:53]
s_lshl_b32 s44, s32, 11
s_add_u32 s44, s44, 73728
s_add_u32 m0, s44, 0
s_nop 0
global_load_lds_dwordx4 v14, s[54:55]
s_add_u32 m0, s44, 1024
s_nop 0
global_load_lds_dwordx4 v15, s[54:55]
s_add_u32 s50, s50, 524288
s_addc_u32 s51, s51, 0
s_add_u32 s52, s52, 524288
s_addc_u32 s53, s53, 0
s_add_u32 s54, s54, 524288
s_addc_u32 s55, s55, 0
s_waitcnt vmcnt(30)
s_barrier
v_add_u32 v25, 81920, v18
v_add_u32 v26, 81920, v19
v_add_u32 v27, 81920, v20
ds_read_b64_tr_b16 a[48:49], v25 offset:0
ds_read_b64_tr_b16 a[50:51], v25 offset:512
ds_read_b64_tr_b16 a[52:53], v25 offset:8192
ds_read_b64_tr_b16 a[54:55], v25 offset:8704
ds_read_b64_tr_b16 a[56:57], v26 offset:0
ds_read_b64_tr_b16 a[58:59], v26 offset:512
ds_read_b64_tr_b16 a[60:61], v26 offset:8192
ds_read_b64_tr_b16 a[62:63], v26 offset:8704
ds_read_b64_tr_b16 a[64:65], v25 offset:16384
ds_read_b64_tr_b16 a[66:67], v25 offset:16896
ds_read_b64_tr_b16 a[68:69], v25 offset:24576
ds_read_b64_tr_b16 a[70:71], v25 offset:25088
ds_read_b64_tr_b16 v[160:161], v26 offset:16384
ds_read_b64_tr_b16 v[162:163], v26 offset:16896
ds_read_b64_tr_b16 v[164:165], v26 offset:24576
s_waitcnt lgkmcnt(14)
ds_read_b64_tr_b16 v[166:167], v26 offset:25088
s_waitcnt lgkmcnt(14)
ds_read_b64_tr_b16 v[192:193], v27 offset:0
s_waitcnt lgkmcnt(14)
ds_read_b64_tr_b16 v[194:195], v27 offset:256
s_waitcnt lgkmcnt(14)
ds_read_b64_tr_b16 v[196:197], v27 offset:4096
s_waitcnt lgkmcnt(14)
ds_read_b64_tr_b16 v[198:199], v27 offset:4352
s_waitcnt lgkmcnt(0)
s_barrier
s_lshl_b32 s44, s32, 12
s_add_u32 s44, s44, 81920
s_add_u32 m0, s44, 0
s_nop 0
global_load_lds_dwordx4 v10, s[50:51]
s_add_u32 m0, s44, 1024
s_nop 0
global_load_lds_dwordx4 v11, s[50:51]
s_add_u32 m0, s44, 2048
s_nop 0
global_load_lds_dwordx4 v12, s[50:51]
s_add_u32 m0, s44, 3072
s_nop 0
global_load_lds_dwordx4 v13, s[50:51]
s_add_u32 m0, s44, 16384
s_nop 0
global_load_lds_dwordx4 v10, s[52:53]
s_add_u32 m0, s44, 17408
s_nop 0
global_load_lds_dwordx4 v11, s[52:53]
s_add_u32 m0, s44, 18432
s_nop 0
global_load_lds_dwordx4 v12, s[52:53]
s_add_u32 m0, s44, 19456
s_nop 0
global_load_lds_dwordx4 v13, s[52:53]
s_lshl_b32 s44, s32, 11
s_add_u32 s44, s44, 114688
s_add_u32 m0, s44, 0
s_nop 0
global_load_lds_dwordx4 v14, s[54:55]
s_add_u32 m0, s44, 1024
s_nop 0
global_load_lds_dwordx4 v15, s[54:55]
s_add_u32 s50, s50, 524288
s_addc_u32 s51, s51, 0
s_add_u32 s52, s52, 524288
s_addc_u32 s53, s53, 0
s_add_u32 s54, s54, 524288
s_addc_u32 s55, s55, 0
s_waitcnt vmcnt(30)
s_barrier
v_add_u32 v25, 122880, v18
v_add_u32 v26, 122880, v19
v_add_u32 v27, 122880, v20
ds_read_b64_tr_b16 a[72:73], v25 offset:0
ds_read_b64_tr_b16 a[74:75], v25 offset:512
ds_read_b64_tr_b16 a[76:77], v25 offset:8192
ds_read_b64_tr_b16 a[78:79], v25 offset:8704
ds_read_b64_tr_b16 a[80:81], v26 offset:0
ds_read_b64_tr_b16 a[82:83], v26 offset:512
ds_read_b64_tr_b16 a[84:85], v26 offset:8192
ds_read_b64_tr_b16 a[86:87], v26 offset:8704
ds_read_b64_tr_b16 a[88:89], v25 offset:16384
ds_read_b64_tr_b16 a[90:91], v25 offset:16896
ds_read_b64_tr_b16 a[92:93], v25 offset:24576
ds_read_b64_tr_b16 a[94:95], v25 offset:25088
ds_read_b64_tr_b16 v[168:169], v26 offset:16384
ds_read_b64_tr_b16 v[170:171], v26 offset:16896
ds_read_b64_tr_b16 v[172:173], v26 offset:24576
s_waitcnt lgkmcnt(14)
ds_read_b64_tr_b16 v[174:175], v26 offset:25088
s_waitcnt lgkmcnt(14)
ds_read_b64_tr_b16 v[200:201], v27 offset:0
s_waitcnt lgkmcnt(14)
ds_read_b64_tr_b16 v[202:203], v27 offset:256
s_waitcnt lgkmcnt(14)
ds_read_b64_tr_b16 v[204:205], v27 offset:4096
s_waitcnt lgkmcnt(14)
ds_read_b64_tr_b16 v[206:207], v27 offset:4352
s_waitcnt lgkmcnt(0)
s_barrier
s_lshl_b32 s44, s32, 12
s_add_u32 s44, s44, 122880
s_add_u32 m0, s44, 0
s_nop 0
global_load_lds_dwordx4 v10, s[50:51]
s_add_u32 m0, s44, 1024
s_nop 0
global_load_lds_dwordx4 v11, s[50:51]
s_add_u32 m0, s44, 2048
s_nop 0
global_load_lds_dwordx4 v12, s[50:51]
s_add_u32 m0, s44, 3072
s_nop 0
global_load_lds_dwordx4 v13, s[50:51]
s_add_u32 m0, s44, 16384
s_nop 0
global_load_lds_dwordx4 v10, s[52:53]
s_add_u32 m0, s44, 17408
s_nop 0
global_load_lds_dwordx4 v11, s[52:53]
s_add_u32 m0, s44, 18432
s_nop 0
global_load_lds_dwordx4 v12, s[52:53]
s_add_u32 m0, s44, 19456
s_nop 0
global_load_lds_dwordx4 v13, s[52:53]
s_lshl_b32 s44, s32, 11
s_add_u32 s44, s44, 155648
s_add_u32 m0, s44, 0
s_nop 0
global_load_lds_dwordx4 v14, s[54:55]
s_add_u32 m0, s44, 1024
s_nop 0
global_load_lds_dwordx4 v15, s[54:55]
s_add_u32 s50, s50, 524288
s_addc_u32 s51, s51, 0
s_add_u32 s52, s52, 524288
s_addc_u32 s53, s53, 0
s_add_u32 s54, s54, 524288
s_addc_u32 s55, s55, 0
s_waitcnt vmcnt(30)
s_barrier
v_add_u32 v25, 0, v18
v_add_u32 v26, 0, v19
v_add_u32 v27, 0, v20
ds_read_b64_tr_b16 a[96:97], v25 offset:0
ds_read_b64_tr_b16 a[98:99], v25 offset:512
ds_read_b64_tr_b16 a[100:101], v25 offset:8192
ds_read_b64_tr_b16 a[102:103], v25 offset:8704
ds_read_b64_tr_b16 a[104:105], v26 offset:0
ds_read_b64_tr_b16 a[106:107], v26 offset:512
ds_read_b64_tr_b16 a[108:109], v26 offset:8192
ds_read_b64_tr_b16 a[110:111], v26 offset:8704
ds_read_b64_tr_b16 a[112:113], v25 offset:16384
ds_read_b64_tr_b16 a[114:115], v25 offset:16896
ds_read_b64_tr_b16 a[116:117], v25 offset:24576
ds_read_b64_tr_b16 a[118:119], v25 offset:25088
ds_read_b64_tr_b16 v[110:111], v26 offset:16384
ds_read_b64_tr_b16 v[112:113], v26 offset:16896
ds_read_b64_tr_b16 v[114:115], v26 offset:24576
s_waitcnt lgkmcnt(14)
ds_read_b64_tr_b16 v[116:117], v26 offset:25088
s_waitcnt lgkmcnt(14)
ds_read_b64_tr_b16 v[208:209], v27 offset:0
s_waitcnt lgkmcnt(14)
ds_read_b64_tr_b16 v[210:211], v27 offset:256
s_waitcnt lgkmcnt(14)
ds_read_b64_tr_b16 v[212:213], v27 offset:4096
s_waitcnt lgkmcnt(14)
ds_read_b64_tr_b16 v[214:215], v27 offset:4352
s_waitcnt lgkmcnt(0)
s_barrier
s_lshl_b32 s44, s32, 12
s_add_u32 s44, s44, 0
s_add_u32 m0, s44, 0
s_nop 0
global_load_lds_dwordx4 v10, s[50:51]
s_add_u32 m0, s44, 1024
s_nop 0
global_load_lds_dwordx4 v11, s[50:51]
s_add_u32 m0, s44, 2048
s_nop 0
global_load_lds_dwordx4 v12, s[50:51]
s_add_u32 m0, s44, 3072
s_nop 0
global_load_lds_dwordx4 v13, s[50:51]
s_add_u32 m0, s44, 16384
s_nop 0
global_load_lds_dwordx4 v10, s[52:53]
s_add_u32 m0, s44, 17408
s_nop 0
global_load_lds_dwordx4 v11, s[52:53]
s_add_u32 m0, s44, 18432
s_nop 0
global_load_lds_dwordx4 v12, s[52:53]
s_add_u32 m0, s44, 19456
s_nop 0
global_load_lds_dwordx4 v13, s[52:53]
s_lshl_b32 s44, s32, 11
s_add_u32 s44, s44, 32768
s_add_u32 m0, s44, 0
s_nop 0
global_load_lds_dwordx4 v14, s[54:55]
s_add_u32 m0, s44, 1024
s_nop 0
global_load_lds_dwordx4 v15, s[54:55]
s_add_u32 s50, s50, 524288
s_addc_u32 s51, s51, 0
s_add_u32 s52, s52, 524288
s_addc_u32 s53, s53, 0
s_add_u32 s54, s54, 524288
s_addc_u32 s55, s55, 0
s_waitcnt vmcnt(30)
s_barrier
v_add_u32 v25, 40960, v18
v_add_u32 v26, 40960, v19
v_add_u32 v27, 40960, v20
ds_read_b64_tr_b16 a[120:121], v25 offset:0
ds_read_b64_tr_b16 a[122:123], v25 offset:512
ds_read_b64_tr_b16 a[124:125], v25 offset:8192
ds_read_b64_tr_b16 a[126:127], v25 offset:8704
ds_read_b64_tr_b16 a[128:129], v26 offset:0
ds_read_b64_tr_b16 a[130:131], v26 offset:512
ds_read_b64_tr_b16 a[132:133], v26 offset:8192
ds_read_b64_tr_b16 a[134:135], v26 offset:8704
ds_read_b64_tr_b16 a[136:137], v25 offset:16384
ds_read_b64_tr_b16 a[138:139], v25 offset:16896
ds_read_b64_tr_b16 a[140:141], v25 offset:24576
ds_read_b64_tr_b16 a[142:143], v25 offset:25088
ds_read_b64_tr_b16 v[118:119], v26 offset:16384
ds_read_b64_tr_b16 v[120:121], v26 offset:16896
ds_read_b64_tr_b16 v[122:123], v26 offset:24576
s_waitcnt lgkmcnt(14)
ds_read_b64_tr_b16 v[124:125], v26 offset:25088
s_waitcnt lgkmcnt(14)
ds_read_b64_tr_b16 v[216:217], v27 offset:0
s_waitcnt lgkmcnt(14)
ds_read_b64_tr_b16 v[218:219], v27 offset:256
s_waitcnt lgkmcnt(14)
ds_read_b64_tr_b16 v[220:221], v27 offset:4096
s_waitcnt lgkmcnt(14)
ds_read_b64_tr_b16 v[222:223], v27 offset:4352
s_waitcnt lgkmcnt(0)
s_barrier
s_lshl_b32 s44, s32, 12
s_add_u32 s44, s44, 40960
s_add_u32 m0, s44, 0
s_nop 0
global_load_lds_dwordx4 v10, s[50:51]
s_add_u32 m0, s44, 1024
s_nop 0
global_load_lds_dwordx4 v11, s[50:51]
s_add_u32 m0, s44, 2048
s_nop 0
global_load_lds_dwordx4 v12, s[50:51]
s_add_u32 m0, s44, 3072
s_nop 0
global_load_lds_dwordx4 v13, s[50:51]
s_add_u32 m0, s44, 16384
s_nop 0
global_load_lds_dwordx4 v10, s[52:53]
s_add_u32 m0, s44, 17408
s_nop 0
global_load_lds_dwordx4 v11, s[52:53]
s_add_u32 m0, s44, 18432
s_nop 0
global_load_lds_dwordx4 v12, s[52:53]
s_add_u32 m0, s44, 19456
s_nop 0
global_load_lds_dwordx4 v13, s[52:53]
s_lshl_b32 s44, s32, 11
s_add_u32 s44, s44, 73728
s_add_u32 m0, s44, 0
s_nop 0
global_load_lds_dwordx4 v14, s[54:55]
s_add_u32 m0, s44, 1024
s_nop 0
global_load_lds_dwordx4 v15, s[54:55]
s_add_u32 s50, s50, 524288
s_addc_u32 s51, s51, 0
s_add_u32 s52, s52, 524288
s_addc_u32 s53, s53, 0
s_add_u32 s54, s54, 524288
s_addc_u32 s55, s55, 0
s_waitcnt vmcnt(30)
s_barrier
v_add_u32 v25, 81920, v18
v_add_u32 v26, 81920, v19
v_add_u32 v27, 81920, v20
ds_read_b64_tr_b16 a[144:145], v25 offset:0
ds_read_b64_tr_b16 a[146:147], v25 offset:512
ds_read_b64_tr_b16 a[148:149], v25 offset:8192
ds_read_b64_tr_b16 a[150:151], v25 offset:8704
ds_read_b64_tr_b16 a[152:153], v26 offset:0
ds_read_b64_tr_b16 a[154:155], v26 offset:512
ds_read_b64_tr_b16 a[156:157], v26 offset:8192
ds_read_b64_tr_b16 a[158:159], v26 offset:8704
ds_read_b64_tr_b16 a[160:161], v25 offset:16384
ds_read_b64_tr_b16 a[162:163], v25 offset:16896
ds_read_b64_tr_b16 a[164:165], v25 offset:24576
ds_read_b64_tr_b16 a[166:167], v25 offset:25088
ds_read_b64_tr_b16 v[126:127], v26 offset:16384
ds_read_b64_tr_b16 v[128:129], v26 offset:16896
ds_read_b64_tr_b16 v[130:131], v26 offset:24576
s_waitcnt lgkmcnt(14)
ds_read_b64_tr_b16 v[132:133], v26 offset:25088
s_waitcnt lgkmcnt(14)
ds_read_b64_tr_b16 v[224:225], v27 offset:0
s_waitcnt lgkmcnt(14)
ds_read_b64_tr_b16 v[226:227], v27 offset:256
s_waitcnt lgkmcnt(14)
ds_read_b64_tr_b16 v[228:229], v27 offset:4096
s_waitcnt lgkmcnt(14)
ds_read_b64_tr_b16 v[230:231], v27 offset:4352
s_waitcnt lgkmcnt(0)
s_barrier
s_waitcnt vmcnt(20)
s_barrier
v_add_u32 v25, 122880, v18
v_add_u32 v26, 122880, v19
v_add_u32 v27, 122880, v20
ds_read_b64_tr_b16 a[168:169], v25 offset:0
ds_read_b64_tr_b16 a[170:171], v25 offset:512
ds_read_b64_tr_b16 a[172:173], v25 offset:8192
ds_read_b64_tr_b16 a[174:175], v25 offset:8704
ds_read_b64_tr_b16 a[176:177], v26 offset:0
ds_read_b64_tr_b16 a[178:179], v26 offset:512
ds_read_b64_tr_b16 a[180:181], v26 offset:8192
ds_read_b64_tr_b16 a[182:183], v26 offset:8704
ds_read_b64_tr_b16 a[184:185], v25 offset:16384
ds_read_b64_tr_b16 a[186:187], v25 offset:16896
ds_read_b64_tr_b16 a[188:189], v25 offset:24576
ds_read_b64_tr_b16 a[190:191], v25 offset:25088
ds_read_b64_tr_b16 v[134:135], v26 offset:16384
ds_read_b64_tr_b16 v[136:137], v26 offset:16896
ds_read_b64_tr_b16 v[138:139], v26 offset:24576
s_waitcnt lgkmcnt(14)
ds_read_b64_tr_b16 v[140:141], v26 offset:25088
s_waitcnt lgkmcnt(14)
ds_read_b64_tr_b16 v[232:233], v27 offset:0
s_waitcnt lgkmcnt(14)
ds_read_b64_tr_b16 v[234:235], v27 offset:256
s_waitcnt lgkmcnt(14)
ds_read_b64_tr_b16 v[236:237], v27 offset:4096
s_waitcnt lgkmcnt(14)
ds_read_b64_tr_b16 v[238:239], v27 offset:4352
s_waitcnt lgkmcnt(0)
s_barrier
s_waitcnt vmcnt(10)
s_barrier
v_add_u32 v25, 0, v18
v_add_u32 v26, 0, v19
v_add_u32 v27, 0, v20
ds_read_b64_tr_b16 a[192:193], v25 offset:0
ds_read_b64_tr_b16 a[194:195], v25 offset:512
ds_read_b64_tr_b16 a[196:197], v25 offset:8192
ds_read_b64_tr_b16 a[198:199], v25 offset:8704
ds_read_b64_tr_b16 a[200:201], v26 offset:0
ds_read_b64_tr_b16 a[202:203], v26 offset:512
ds_read_b64_tr_b16 a[204:205], v26 offset:8192
ds_read_b64_tr_b16 a[206:207], v26 offset:8704
ds_read_b64_tr_b16 a[208:209], v25 offset:16384
ds_read_b64_tr_b16 a[210:211], v25 offset:16896
ds_read_b64_tr_b16 a[212:213], v25 offset:24576
ds_read_b64_tr_b16 a[214:215], v25 offset:25088
ds_read_b64_tr_b16 v[142:143], v26 offset:16384
ds_read_b64_tr_b16 v[144:145], v26 offset:16896
ds_read_b64_tr_b16 v[146:147], v26 offset:24576
s_waitcnt lgkmcnt(14)
ds_read_b64_tr_b16 v[148:149], v26 offset:25088
s_waitcnt lgkmcnt(14)
ds_read_b64_tr_b16 v[240:241], v27 offset:0
s_waitcnt lgkmcnt(14)
ds_read_b64_tr_b16 v[242:243], v27 offset:256
s_waitcnt lgkmcnt(14)
ds_read_b64_tr_b16 v[244:245], v27 offset:4096
s_waitcnt lgkmcnt(14)
ds_read_b64_tr_b16 v[246:247], v27 offset:4352
s_waitcnt lgkmcnt(0)
s_barrier
s_waitcnt vmcnt(0)
s_barrier
v_add_u32 v25, 40960, v18
v_add_u32 v26, 40960, v19
v_add_u32 v27, 40960, v20
ds_read_b64_tr_b16 a[216:217], v25 offset:0
ds_read_b64_tr_b16 a[218:219], v25 offset:512
ds_read_b64_tr_b16 a[220:221], v25 offset:8192
ds_read_b64_tr_b16 a[222:223], v25 offset:8704
ds_read_b64_tr_b16 a[224:225], v26 offset:0
ds_read_b64_tr_b16 a[226:227], v26 offset:512
ds_read_b64_tr_b16 a[228:229], v26 offset:8192
ds_read_b64_tr_b16 a[230:231], v26 offset:8704
ds_read_b64_tr_b16 a[232:233], v25 offset:16384
ds_read_b64_tr_b16 a[234:235], v25 offset:16896
ds_read_b64_tr_b16 a[236:237], v25 offset:24576
ds_read_b64_tr_b16 a[238:239], v25 offset:25088
ds_read_b64_tr_b16 v[150:151], v26 offset:16384
ds_read_b64_tr_b16 v[152:153], v26 offset:16896
ds_read_b64_tr_b16 v[154:155], v26 offset:24576
s_waitcnt lgkmcnt(14)
ds_read_b64_tr_b16 v[156:157], v26 offset:25088
s_waitcnt lgkmcnt(14)
ds_read_b64_tr_b16 v[248:249], v27 offset:0
s_waitcnt lgkmcnt(14)
ds_read_b64_tr_b16 v[250:251], v27 offset:256
s_waitcnt lgkmcnt(14)
ds_read_b64_tr_b16 v[252:253], v27 offset:4096
s_waitcnt lgkmcnt(14)
ds_read_b64_tr_b16 v[254:255], v27 offset:4352
s_waitcnt lgkmcnt(0)
s_barrier
s_mul_i32 s44, s32, 20480
v_lshlrev_b32 v12, 4, v1
v_add_u32 v12, s44, v12
ds_write_b128 v12, v[30:33] offset:0
ds_write_b128 v12, v[34:37] offset:1024
ds_write_b128 v12, v[38:41] offset:2048
ds_write_b128 v12, v[42:45] offset:3072
ds_write_b128 v12, v[46:49] offset:4096
ds_write_b128 v12, v[50:53] offset:5120
ds_write_b128 v12, v[54:57] offset:6144
ds_write_b128 v12, v[58:61] offset:7168
ds_write_b128 v12, v[62:65] offset:8192
ds_write_b128 v12, v[66:69] offset:9216
s_waitcnt lgkmcnt(0)
ds_write_b128 v12, v[70:73] offset:10240
ds_write_b128 v12, v[74:77] offset:11264
ds_write_b128 v12, v[78:81] offset:12288
ds_write_b128 v12, v[82:85] offset:13312
ds_write_b128 v12, v[86:89] offset:14336
ds_write_b128 v12, v[90:93] offset:15360
ds_write_b128 v12, v[94:97] offset:16384
ds_write_b128 v12, v[98:101] offset:17408
ds_write_b128 v12, v[102:105] offset:18432
ds_write_b128 v12, v[106:109] offset:19456
s_waitcnt lgkmcnt(0)
s_mul_i32 s44, s32, 12288
s_add_u32 s44, s44, 81920
v_lshlrev_b32 v12, 4, v1
v_add_u32 v12, s44, v12
ds_write_b128 v12, v[110:113] offset:0
ds_write_b128 v12, v[114:117] offset:1024
ds_write_b128 v12, v[118:121] offset:2048
ds_write_b128 v12, v[122:125] offset:3072
ds_write_b128 v12, v[126:129] offset:4096
ds_write_b128 v12, v[130:133] offset:5120
ds_write_b128 v12, v[134:137] offset:6144
ds_write_b128 v12, v[138:141] offset:7168
ds_write_b128 v12, v[142:145] offset:8192
ds_write_b128 v12, v[146:149] offset:9216
ds_write_b128 v12, v[150:153] offset:10240
ds_write_b128 v12, v[154:157] offset:11264
s_waitcnt lgkmcnt(0)
v_mov_b32 v19, v1
v_lshrrev_b32 v56, 4, v19
v_and_b32 v57, 15, v19
v_bfe_u32 v58, v19, 2, 2
v_and_b32 v59, 3, v19
v_and_b32 v60, 2, v19
v_cmp_eq_u32 vcc, 0, v60
v_mov_b32 v61, 0xeeeeeeee
v_mov_b32 v62, 0x44444444
v_cndmask_b32 v1, v61, v62, vcc
v_lshlrev_b32 v2, 4, v19
v_lshlrev_b32 v3, 3, v19
v_lshrrev_b32 v60, 1, v56
v_lshlrev_b32 v60, 9, v60
v_lshl_add_u32 v60, v59, 7, v60
v_and_b32 v61, 1, v56
v_lshl_add_u32 v60, v61, 6, v60
v_lshl_add_u32 v60, v58, 3, v60
v_add_u32 v60, 131072, v60
v_lshrrev_b32 v61, 1, v59
v_lshl_add_u32 v4, v61, 5, v60
v_xor_b32 v61, 1, v61
v_lshl_add_u32 v5, v61, 5, v60
s_lshl_b32 s44, s32, 5
v_add_u32 v60, s44, v57
v_lshrrev_b32 v61, 2, v60
v_lshrrev_b32 v62, 1, v56
v_add_u32 v61, v61, v62
v_lshlrev_b32 v60, 5, v60
v_and_b32 v62, 1, v56
v_lshl_add_u32 v60, v62, 2, v60
v_add_u32 v60, 157696, v60
v_and_b32 v62, 3, v61
v_lshl_add_u32 v6, v62, 3, v60
v_add_u32 v61, 2, v61
v_and_b32 v62, 3, v61
v_lshl_add_u32 v7, v62, 3, v60
v_lshl_add_u32 v60, v56, 2, v58
v_lshlrev_b32 v60, 5, v60
v_add_u32 v61, v59, v56
v_and_b32 v61, 3, v61
v_lshl_add_u32 v60, v61, 3, v60
v_add_u32 v8, 157696, v60
v_add_u32 v9, 141312, v2
s_mul_i32 s44, s32, 20480
v_add_u32 v10, s44, v2
s_mul_i32 s44, s32, 12288
s_add_u32 s44, s44, 81920
v_add_u32 v11, s44, v2
s_lshl_b32 s44, s32, 1
v_lshrrev_b32 v60, 1, v56
v_add_u32 v60, s44, v60
v_and_b32 v61, 6, v57
v_xor_b32 v60, v60, v61
v_lshlrev_b32 v60, 4, v60
v_and_b32 v61, 7, v57
v_lshl_add_u32 v60, v61, 7, v60
v_and_b32 v61, 1, v56
v_lshl_add_u32 v60, v61, 3, v60
v_add_u32 v12, 161792, v60
v_lshrrev_b32 v60, 2, v57
v_lshlrev_b32 v60, 1, v60
v_and_b32 v61, 1, v57
v_add_u32 v60, v60, v61
v_bfe_u32 v61, v57, 1, 1
v_lshl_add_u32 v61, v56, 1, v61
v_and_b32 v62, 6, v60
v_xor_b32 v61, v61, v62
v_lshlrev_b32 v61, 4, v61
v_lshl_add_u32 v61, v60, 7, v61
v_add_u32 v13, 161792, v61
s_lshl_b32 s44, s32, 8
s_add_u32 s44, s44, 162816
v_lshlrev_b32 v60, 4, v57
v_add_u32 v60, s44, v60
v_lshl_add_u32 v14, v56, 2, v60
v_and_b32 v61, 1, v56
v_lshl_add_u32 v15, v61, 3, v60
s_mov_b32 s44, s32
s_mul_i32 s44, s44, 2560
s_add_u32 s44, s44, 131072
v_lshrrev_b32 v60, 5, v19
v_lshlrev_b32 v60, 9, v60
v_bfe_u32 v61, v19, 3, 2
v_lshl_add_u32 v60, v61, 7, v60
v_lshrrev_b32 v61, 1, v61
v_lshlrev_b32 v61, 5, v61
v_and_b32 v62, 7, v19
v_lshlrev_b32 v62, 4, v62
v_xor_b32 v62, v62, v61
v_add_u32 v60, v60, v62
v_add_u32 v16, s44, v60
v_lshrrev_b32 v61, 1, v56
v_lshlrev_b32 v61, 5, v61
v_lshlrev_b32 v62, 3, v57
v_xor_b32 v62, v62, v61
v_lshl_add_u32 v60, v56, 7, v62
v_add_u32 v17, s44, v60
v_lshrrev_b32 v60, 3, v57
v_lshl_add_u32 v60, v56, 1, v60
v_mul_u32_u24 v60, 10240, v60
v_and_b32 v61, 7, v57
v_lshl_add_u32 v60, v61, 4, v60
s_min_u32 s44, s39, 79
s_lshl_b32 s44, s44, 7
v_add_u32 v18, s44, v60
v_mov_b32 v20, 0x3f803f80
v_mov_b32 v21, 0x3f803f80
v_mov_b32 v22, 0x3f803f80
v_mov_b32 v23, 0x3f803f80
v_mov_b32 v60, 0
v_cmp_eq_u32 vcc, 0, v57
v_mov_b32 v61, 0x3f80
s_nop 0
v_cndmask_b32 v60, v60, v61, vcc
v_cmp_eq_u32 vcc, 1, v57
v_mov_b32 v61, 0x3f800000
s_nop 0
v_cndmask_b32 v24, v60, v61, vcc
v_mov_b32 v60, 0
v_cmp_eq_u32 vcc, 2, v57
v_mov_b32 v61, 0x3f80
s_nop 0
v_cndmask_b32 v60, v60, v61, vcc
v_cmp_eq_u32 vcc, 3, v57
v_mov_b32 v61, 0x3f800000
s_nop 0
v_cndmask_b32 v25, v60, v61, vcc
v_mov_b32 v60, 0
v_cmp_eq_u32 vcc, 4, v57
v_mov_b32 v61, 0x3f80
s_nop 0
v_cndmask_b32 v60, v60, v61, vcc
v_cmp_eq_u32 vcc, 5, v57
v_mov_b32 v61, 0x3f800000
s_nop 0
v_cndmask_b32 v26, v60, v61, vcc
v_mov_b32 v60, 0
v_cmp_eq_u32 vcc, 6, v57
v_mov_b32 v61, 0x3f80
s_nop 0
v_cndmask_b32 v60, v60, v61, vcc
v_cmp_eq_u32 vcc, 7, v57
v_mov_b32 v61, 0x3f800000
s_nop 0
v_cndmask_b32 v27, v60, v61, vcc
v_cmp_gt_u32 vcc, 2, v56
v_mov_b32 v61, 0xff800000
v_mov_b32 v60, 0
v_cndmask_b32 v28, v60, v61, vcc
v_cndmask_b32 v29, v60, v61, vcc
v_cndmask_b32 v30, v60, v61, vcc
v_cndmask_b32 v31, v60, v61, vcc
s_mov_b32 s88, 0x3e0293ee
s_mov_b32 s89, s88
s_mov_b32 s90, 0x00003f80
s_mov_b32 s91, 0x3f800000
s_mov_b32 s92, 0x00ff00ff
s_mov_b32 s93, 0x00ff00ff
v_bfe_u32 v56, v19, 4, 2
v_and_b32 v57, 15, v19
v_mul_u32_u24 v58, 2560, v56
s_lshl_b32 s44, s32, 5
v_add_u32 v59, s44, v57
v_lshl_add_u32 v58, v59, 1, v58
global_load_ushort v64, v58, s[10:11] offset:0
global_load_ushort v65, v58, s[10:11] offset:1280
global_load_ushort v66, v58, s[10:11] offset:32
global_load_ushort v67, v58, s[10:11] offset:1312
global_load_ushort v68, v58, s[10:11] offset:256
global_load_ushort v69, v58, s[10:11] offset:1536
global_load_ushort v70, v58, s[10:11] offset:288
global_load_ushort v71, v58, s[10:11] offset:1568
global_load_ushort v72, v58, s[10:11] offset:512
global_load_ushort v73, v58, s[10:11] offset:1792
global_load_ushort v74, v58, s[10:11] offset:544
global_load_ushort v75, v58, s[10:11] offset:1824
global_load_ushort v76, v58, s[10:11] offset:768
global_load_ushort v77, v58, s[10:11] offset:2048
global_load_ushort v78, v58, s[10:11] offset:800
global_load_ushort v79, v58, s[10:11] offset:2080
global_load_ushort v80, v58, s[10:11] offset:1024
global_load_ushort v81, v58, s[10:11] offset:2304
global_load_ushort v82, v58, s[10:11] offset:1056
global_load_ushort v83, v58, s[10:11] offset:2336
v_lshrrev_b32 v59, 1, v56
v_lshlrev_b32 v59, 5, v59
v_lshlrev_b32 v60, 3, v57
v_xor_b32 v60, v60, v59
v_lshl_add_u32 v60, v56, 7, v60
s_lshl_b32 s44, s32, 9
s_add_u32 s44, s44, 131072
v_add_u32 v60, s44, v60
s_mov_b32 s74, 0
v_and_b32 v90, 3, v19
v_bfe_u32 v91, v19, 2, 1
v_lshl_add_u32 v90, v91, 5, v90
v_lshlrev_b32 v90, 2, v90
v_cmp_eq_u32 vcc, 8, v19
v_mov_b32 v91, 40
s_nop 0
v_cndmask_b32 v90, v90, v91, vcc
v_cmp_lt_u32 vcc, 8, v19
v_mov_b32 v91, 44
s_nop 0
v_cndmask_b32 v90, v90, v91, vcc
v_mov_b32 v92, 160
v_cmp_eq_u32 vcc, 12, v19
s_nop 1
v_cndmask_b32 v90, v90, v92, vcc
global_load_dword v91, v90, s[28:29] sc1
s_waitcnt vmcnt(0)
v_lshl_or_b32 v64, v65, 16, v64
v_lshl_or_b32 v65, v67, 16, v66
ds_write_b64 v60, v[64:65] offset:0
v_lshl_or_b32 v68, v69, 16, v68
v_lshl_or_b32 v69, v71, 16, v70
ds_write_b64 v60, v[68:69] offset:2048
v_lshl_or_b32 v72, v73, 16, v72
v_lshl_or_b32 v73, v75, 16, v74
ds_write_b64 v60, v[72:73] offset:4096
v_lshl_or_b32 v76, v77, 16, v76
v_lshl_or_b32 v77, v79, 16, v78
ds_write_b64 v60, v[76:77] offset:6144
v_lshl_or_b32 v80, v81, 16, v80
v_lshl_or_b32 v81, v83, 16, v82
ds_write_b64 v60, v[80:81] offset:8192
s_branch L_R_census_chk
L_R_census:
global_load_dword v91, v90, s[28:29] sc1
s_waitcnt vmcnt(0)
L_R_census_chk:
v_readlane_b32 s44, v91, 0
v_readlane_b32 s45, v91, 1
s_nop 2
s_add_u32 s44, s44, s45
v_readlane_b32 s45, v91, 2
s_nop 2
s_add_u32 s44, s44, s45
v_readlane_b32 s45, v91, 3
s_nop 2
s_add_u32 s44, s44, s45
v_readlane_b32 s45, v91, 4
s_nop 2
s_add_u32 s44, s44, s45
v_readlane_b32 s45, v91, 5
s_nop 2
s_add_u32 s44, s44, s45
v_readlane_b32 s45, v91, 6
s_nop 2
s_add_u32 s44, s44, s45
v_readlane_b32 s45, v91, 7
s_nop 2
s_add_u32 s44, s44, s45
v_readlane_b32 s45, v91, 8
s_nop 2
s_add_u32 s44, s44, s45
v_readlane_b32 s45, v91, 12
v_readlane_b32 s86, v91, 11
s_nop 1
s_cmp_ge_u32 s45, 64
s_cselect_b32 s44, s44, 0
s_cmp_ge_u32 s44, 256
s_cselect_b32 s44, s86, 0
s_cmp_lg_u32 s44, 0
s_cbranch_scc1 L_R_census_ok
s_sleep 4
s_add_u32 s74, s74, 1
s_cmp_lt_u32 s74, 131072
s_cbranch_scc1 L_R_census
s_endpgm
L_R_census_ok:
s_cmp_eq_u32 s86, 2
s_cselect_b32 s86, 8192, 0
v_readlane_b32 s44, v91, 0
v_readlane_b32 s45, v91, 1
s_nop 2
s_min_u32 s44, s44, s45
s_waitcnt lgkmcnt(0)
s_cmp_ge_u32 s44, 32
s_cbranch_scc0 L_Rslow_start
s_branch L_Rfast_start
L_Rfast_start:
s_mov_b32 s41, 0
s_mov_b32 s96, 0
s_mov_b32 s97, 0
s_mov_b32 s99, 0
s_lshl_b32 s44, s36, 13
s_add_u32 s66, s30, 16777216
s_addc_u32 s67, s31, 0
s_add_u32 s66, s66, s44
s_addc_u32 s67, s67, 0
s_lshl_b32 s45, s32, 11
s_add_u32 s66, s66, s45
s_addc_u32 s67, s67, 0
s_add_u32 s68, s30, 33554432
s_addc_u32 s69, s31, 0
s_add_u32 s68, s68, s44
s_addc_u32 s69, s69, 0
s_lshl_b32 s45, s37, 2
s_add_u32 s45, s45, s32
s_lshl_b32 s46, s45, 10
s_add_u32 s68, s68, s46
s_addc_u32 s69, s69, 0
s_lshl_b32 s44, s36, 12
s_add_u32 s70, s30, 67108864
s_addc_u32 s71, s31, 0
s_add_u32 s70, s70, s44
s_addc_u32 s71, s71, 0
s_and_b32 s95, s32, 1
s_lshl_b32 s47, s37, 1
s_add_u32 s95, s95, s47
s_lshl_b32 s95, s95, 10
s_add_u32 s70, s70, s95
s_addc_u32 s71, s71, 0
s_add_u32 s72, s30, 75497472
s_addc_u32 s73, s31, 0
s_add_u32 s72, s72, s44
s_addc_u32 s73, s73, 0
s_lshl_b32 s46, s45, 9
s_add_u32 s72, s72, s46
s_addc_u32 s73, s73, 0
s_lshl_b32 s44, s36, 1
s_add_u32 s44, s44, s37
s_lshl_b32 s44, s44, 6
s_add_u32 s44, s44, 16384
s_add_u32 s100, s30, s44
s_addc_u32 s101, s31, 0
v_lshrrev_b32 v56, 4, v2
v_and_b32 v57, 3, v56
v_lshlrev_b32 v57, 2, v57
v_bfe_u32 v58, v56, 2, 1
v_mul_u32_u24 v58, 4096, v58
v_add_u32 v57, v57, v58
s_lshl_b32 s44, s36, 6
v_add_u32 v19, s44, v57
s_mul_i32 s45, s38, 10240
s_mul_i32 s46, s32, 2560
s_add_u32 s45, s45, s46
s_add_u32 s8, s30, 5242880
s_addc_u32 s9, s31, 0
s_add_u32 s8, s8, s45
s_addc_u32 s9, s9, 0
s_mul_i32 s45, s35, 327680
s_add_u32 s45, s45, 5242880
s_cmp_eq_u32 s40, 0
s_cselect_b32 s45, 8388608, s45
s_add_u32 s10, s30, s45
s_addc_u32 s11, s31, 0
s_min_u32 s47, s39, 79
s_mul_i32 s45, s35, 10240
s_lshl_b32 s46, s47, 7
s_add_u32 s46, s46, s45
s_add_u32 s46, s46, 4194304
s_lshl_b32 s44, s47, 7
s_sub_u32 s45, s44, 7680
s_add_u32 s45, s45, 16384
s_cmp_ge_u32 s47, 60
s_cselect_b32 s44, s45, s44
s_lshl_b32 s45, s35, 15
s_add_u32 s44, s44, s45
s_add_u32 s44, s44, s86
s_add_u32 s44, s44, 4325376
s_lshl_b32 s47, s38, 8
s_add_u32 s47, s47, 10485760
s_cmp_eq_u32 s40, 0
s_cselect_b32 s44, s47, s44
s_cselect_b32 s46, s47, s46
s_add_u32 s12, s30, s44
s_addc_u32 s13, s31, 0
s_add_u32 s14, s30, s46
s_addc_u32 s15, s31, 0
s_mov_b32 s46, s32
s_mul_i32 s45, s35, 10240
s_mul_i32 s47, s46, 2560
s_add_u32 s44, s45, s47
s_add_u32 s44, s44, 4194304
s_add_u32 s16, s30, s44
s_addc_u32 s17, s31, 0
s_cmp_eq_u32 s46, 3
s_cselect_b32 s47, 16384, s47
s_xor_b32 s45, s35, 1
s_lshl_b32 s45, s45, 15
s_add_u32 s44, s45, s47
s_add_u32 s44, s44, s86
s_add_u32 s44, s44, 4325376
s_add_u32 s18, s30, s44
s_addc_u32 s19, s31, 0
s_mov_b32 s85, 0
s_mov_b32 s24, -1
s_mov_b32 s25, 0
s_lshl_b32 s45, s34, 7
s_add_u32 s45, s45, s86
s_add_u32 s45, s45, 4344320
s_lshl_b32 s44, s35, 15
s_add_u32 s44, s44, s45
s_add_u32 s80, s30, s44
s_addc_u32 s81, s31, 0
s_xor_b32 s44, s35, 1
s_lshl_b32 s44, s44, 15
s_add_u32 s44, s44, s45
s_add_u32 s82, s30, s44
s_addc_u32 s83, s31, 0
s_mov_b32 s76, s70
s_mov_b32 s77, s71
s_mov_b32 s78, s72
s_mov_b32 s79, s73
s_lshl_b32 s44, s38, 2
s_add_u32 s44, s44, s32
s_lshl_b32 s44, s44, 10
s_add_u32 s44, s44, 8388608
s_add_u32 s70, s30, s44
s_addc_u32 s71, s31, 0
s_add_u32 s72, s30, s44
s_addc_u32 s73, s31, 0
s_lshl_b32 s87, 1, s32
v_mov_b32 v158, 0
s_mov_b32 s94, 1
s_branch L_Rfast_fs_31
L_Rfast_prime_30:
s_lshl_b32 s44, s32, 11
s_add_u32 m0, s44, 141312
s_add_u32 s98, s44, 149504
global_load_lds_dwordx4 v2, s[66:67] sc1
global_load_lds_dwordx4 v2, s[66:67] offset:1024 sc1
s_add_u32 s66, s66, 262144
s_addc_u32 s67, s67, 0
s_mov_b32 s94, 2
s_add_u32 s48, s8, s96
s_addc_u32 s49, s9, 0
s_add_u32 s50, s10, s96
s_addc_u32 s51, s11, 0
s_add_u32 s52, s50, 81920
s_addc_u32 s53, s51, 0
s_add_u32 s54, s52, 81920
s_addc_u32 s55, s53, 0
s_add_u32 s56, s54, 81920
s_addc_u32 s57, s55, 0
v_mov_b64 v[32:33], 0
v_mov_b64 v[34:35], 0
v_mov_b64 v[36:37], 0
v_mov_b64 v[38:39], 0
v_mov_b64 v[40:41], 0
v_mov_b64 v[42:43], 0
v_mov_b64 v[44:45], 0
v_mov_b64 v[46:47], 0
v_mov_b64 v[48:49], 0
v_mov_b64 v[50:51], 0
s_waitcnt vmcnt(0)
L_Rfast_loop:
s_barrier
ds_read_b64_tr_b16 v[56:57], v4 offset:0
ds_read_b64_tr_b16 v[58:59], v5 offset:0
ds_read_b64_tr_b16 v[60:61], v4 offset:1024
ds_read_b64_tr_b16 v[62:63], v5 offset:1024
ds_read_b64_tr_b16 v[64:65], v4 offset:2048
ds_read_b64_tr_b16 v[66:67], v5 offset:2048
ds_read_b64_tr_b16 v[68:69], v4 offset:3072
ds_read_b64_tr_b16 v[70:71], v5 offset:3072
s_waitcnt lgkmcnt(6)
v_smfmac_f32_16x16x64_bf16 v[32:35], v[56:59], a[0:7], v1
v_cmp_gt_u32 vcc, s94, v0
ds_read_b64_tr_b16 v[72:73], v4 offset:4096
v_smfmac_f32_16x16x64_bf16 v[36:39], v[56:59], a[8:15], v1
s_nop 0
s_cbranch_vccnz L_Rfast_fs_33
L_Rfast_fret_32:
ds_read_b64_tr_b16 v[74:75], v5 offset:4096
v_smfmac_f32_16x16x64_bf16 v[40:43], v[56:59], a[16:23], v1
s_lshr_b32 s99, s41, 1
s_and_b32 s99, s99, 1
ds_read_b128 v[96:99], v11 offset:0
global_load_dwordx4 v[52:55], v2, s[68:69] sc1
v_smfmac_f32_16x16x64_bf16 v[44:47], v[56:59], a[240:247], v1
ds_read_b128 v[100:103], v11 offset:1024
s_waitcnt lgkmcnt(8)
v_smfmac_f32_16x16x64_bf16 v[32:35], v[60:63], a[24:31], v1
ds_read_b64_tr_b16 v[76:77], v4 offset:5120
v_smfmac_f32_16x16x64_bf16 v[36:39], v[60:63], a[32:39], v1
ds_read_b64_tr_b16 v[78:79], v5 offset:5120
v_smfmac_f32_16x16x64_bf16 v[40:43], v[60:63], a[40:47], v1
ds_read_b128 v[104:107], v11 offset:2048
s_mov_b32 m0, s98
s_nop 0
global_load_lds_dwordx4 v2, s[66:67] sc1
v_smfmac_f32_16x16x64_bf16 v[44:47], v[60:63], a[248:255], v1
ds_read_b128 v[108:111], v11 offset:3072
s_waitcnt lgkmcnt(10)
v_smfmac_f32_16x16x64_bf16 v[32:35], v[64:67], a[48:55], v1
ds_read_b64_tr_b16 v[80:81], v4 offset:6144
v_smfmac_f32_16x16x64_bf16 v[36:39], v[64:67], a[56:63], v1
ds_read_b64_tr_b16 v[82:83], v5 offset:6144
v_smfmac_f32_16x16x64_bf16 v[40:43], v[64:67], a[64:71], v1
ds_read_b64_tr_b16 v[84:85], v4 offset:7168
global_load_lds_dwordx4 v2, s[66:67] offset:1024 sc1
v_smfmac_f32_16x16x64_bf16 v[44:47], v[64:67], v[160:167], v1
ds_read_b64_tr_b16 v[86:87], v5 offset:7168
s_waitcnt lgkmcnt(12)
v_smfmac_f32_16x16x64_bf16 v[32:35], v[68:71], a[72:79], v1
ds_read_b64_tr_b16 v[88:89], v4 offset:8192
v_smfmac_f32_16x16x64_bf16 v[36:39], v[68:71], a[80:87], v1
ds_read_b64_tr_b16 v[90:91], v5 offset:8192
v_smfmac_f32_16x16x64_bf16 v[40:43], v[68:71], a[88:95], v1
ds_read_b64_tr_b16 v[92:93], v4 offset:9216
global_store_dwordx4 v2, v[152:155], s[70:71] sc1
v_smfmac_f32_16x16x64_bf16 v[44:47], v[68:71], v[168:175], v1
s_waitcnt lgkmcnt(14)
ds_read_b64_tr_b16 v[94:95], v5 offset:9216
s_waitcnt lgkmcnt(14)
v_smfmac_f32_16x16x64_bf16 v[32:35], v[72:75], a[96:103], v1
v_smfmac_f32_16x16x64_bf16 v[36:39], v[72:75], a[104:111], v1
v_smfmac_f32_16x16x64_bf16 v[40:43], v[72:75], a[112:119], v1
global_store_dwordx2 v3, v[156:157], s[72:73] sc1
s_waitcnt lgkmcnt(12)
v_smfmac_f32_16x16x64_bf16 v[44:47], v[72:75], v[96:103], v1
s_waitcnt lgkmcnt(10)
v_smfmac_f32_16x16x64_bf16 v[32:35], v[76:79], a[120:127], v1
ds_read_b128 v[96:99], v11 offset:4096
v_smfmac_f32_16x16x64_bf16 v[36:39], v[76:79], a[128:135], v1
ds_read_b128 v[100:103], v11 offset:5120
v_smfmac_f32_16x16x64_bf16 v[40:43], v[76:79], a[136:143], v1
s_waitcnt vmcnt(5)
ds_read_b128 v[112:115], v9 offset:0
s_mov_b64 exec, 1
global_store_dword v3, v158, s[100:101] sc1
s_mov_b64 exec, -1
global_load_dword v0, v19, s[30:31] sc1
s_waitcnt lgkmcnt(11)
v_smfmac_f32_16x16x64_bf16 v[44:47], v[76:79], v[104:111], v1
ds_read_b128 v[116:119], v9 offset:1024
s_waitcnt lgkmcnt(10)
v_smfmac_f32_16x16x64_bf16 v[32:35], v[80:83], a[144:151], v1
ds_read_b128 v[104:107], v11 offset:6144
v_smfmac_f32_16x16x64_bf16 v[36:39], v[80:83], a[152:159], v1
ds_read_b128 v[108:111], v11 offset:7168
v_smfmac_f32_16x16x64_bf16 v[40:43], v[80:83], a[160:167], v1
ds_read_b128 v[120:123], v9 offset:2048
s_waitcnt lgkmcnt(5)
v_smfmac_f32_16x16x64_bf16 v[44:47], v[80:83], v[96:103], v1
ds_read_b128 v[124:127], v9 offset:3072
v_smfmac_f32_16x16x64_bf16 v[32:35], v[84:87], a[168:175], v1
ds_read_b128 v[96:99], v11 offset:8192
v_smfmac_f32_16x16x64_bf16 v[36:39], v[84:87], a[176:183], v1
ds_read_b128 v[100:103], v11 offset:9216
v_smfmac_f32_16x16x64_bf16 v[40:43], v[84:87], a[184:191], v1
ds_read_b128 v[128:131], v9 offset:4096
s_waitcnt lgkmcnt(5)
v_smfmac_f32_16x16x64_bf16 v[44:47], v[84:87], v[104:111], v1
ds_read_b128 v[132:135], v9 offset:5120
v_smfmac_f32_16x16x64_bf16 v[32:35], v[88:91], a[192:199], v1
ds_read_b128 v[104:107], v11 offset:10240
v_smfmac_f32_16x16x64_bf16 v[36:39], v[88:91], a[200:207], v1
ds_read_b128 v[108:111], v11 offset:11264
v_smfmac_f32_16x16x64_bf16 v[40:43], v[88:91], a[208:215], v1
ds_read_b128 v[136:139], v9 offset:6144
s_waitcnt lgkmcnt(5)
v_smfmac_f32_16x16x64_bf16 v[44:47], v[88:91], v[96:103], v1
ds_read_b128 v[140:143], v9 offset:7168
v_smfmac_f32_16x16x64_bf16 v[32:35], v[92:95], a[216:223], v1
v_smfmac_f32_16x16x64_bf16 v[36:39], v[92:95], a[224:231], v1
v_smfmac_f32_16x16x64_bf16 v[40:43], v[92:95], a[232:239], v1
s_waitcnt lgkmcnt(2)
v_smfmac_f32_16x16x64_bf16 v[44:47], v[92:95], v[104:111], v1
s_nop 3
v_pk_add_f32 v[32:33], v[32:33], v[34:35]
v_pk_add_f32 v[36:37], v[36:37], v[38:39]
v_pk_add_f32 v[40:41], v[40:41], v[42:43]
s_nop 0
v_pk_add_f32 v[44:45], v[44:45], v[46:47]
v_cvt_pk_bf16_f32 v34, v32, v33
v_cvt_pk_bf16_f32 v38, v36, v37
v_cvt_pk_bf16_f32 v42, v40, v41
v_cvt_pk_bf16_f32 v46, v44, v45
ds_write2st64_b32 v6, v34, v38 offset0:0 offset1:2
ds_write2st64_b32 v7, v42, v46 offset0:0 offset1:2
v_smfmac_f32_16x16x64_bf16 v[48:51], v[56:59], v[176:183], v1
v_smfmac_f32_16x16x64_bf16 v[48:51], v[60:63], v[184:191], v1
v_smfmac_f32_16x16x64_bf16 v[48:51], v[64:67], v[192:199], v1
s_waitcnt lgkmcnt(0)
s_barrier
ds_read_b64_tr_b16 v[144:145], v8 offset:0
ds_read_b64_tr_b16 v[146:147], v8 offset:512
ds_read_b64_tr_b16 v[148:149], v8 offset:1024
ds_read_b64_tr_b16 v[150:151], v8 offset:1536
ds_read_b64_tr_b16 v[152:153], v8 offset:2048
ds_read_b64_tr_b16 v[154:155], v8 offset:2560
ds_read_b64_tr_b16 v[156:157], v8 offset:3072
ds_read_b64_tr_b16 v[158:159], v8 offset:3584
v_smfmac_f32_16x16x64_bf16 v[48:51], v[68:71], v[200:207], v1
ds_read_b128 v[56:59], v10 offset:0
v_smfmac_f32_16x16x64_bf16 v[48:51], v[72:75], v[208:215], v1
ds_read_b128 v[60:63], v10 offset:1024
v_smfmac_f32_16x16x64_bf16 v[48:51], v[76:79], v[216:223], v1
ds_read_b128 v[96:99], v10 offset:10240
v_smfmac_f32_16x16x64_bf16 v[48:51], v[80:83], v[224:231], v1
ds_read_b128 v[100:103], v10 offset:11264
v_smfmac_f32_16x16x64_bf16 v[48:51], v[84:87], v[232:239], v1
ds_read_b128 v[64:67], v10 offset:2048
v_smfmac_f32_16x16x64_bf16 v[48:51], v[88:91], v[240:247], v1
ds_read_b128 v[68:71], v10 offset:3072
v_smfmac_f32_16x16x64_bf16 v[48:51], v[92:95], v[248:255], v1
ds_read_b128 v[104:107], v10 offset:12288
s_waitcnt lgkmcnt(13)
v_mfma_f32_16x16x32_bf16 v[32:35], v[144:147], v[144:147], v[28:31]
ds_read_b128 v[108:111], v10 offset:13312
v_mfma_f32_16x16x32_bf16 v[36:39], v[112:115], v[144:147], 0
ds_read_b128 v[72:75], v10 offset:4096
v_mfma_f32_16x16x32_bf16 v[40:43], v[116:119], v[144:147], 0
s_waitcnt lgkmcnt(14)
ds_read_b128 v[76:79], v10 offset:5120
s_waitcnt lgkmcnt(14)
v_mfma_f32_16x16x32_bf16 v[32:35], v[148:151], v[148:151], v[32:35]
ds_read_b128 v[80:83], v10 offset:6144
v_pk_add_f32 v[48:49], v[48:49], v[50:51]
v_mfma_f32_16x16x32_bf16 v[36:39], v[120:123], v[148:151], v[36:39]
s_waitcnt lgkmcnt(14)
ds_read_b128 v[84:87], v10 offset:7168
v_cvt_pk_bf16_f32 v50, v48, v49
v_mfma_f32_16x16x32_bf16 v[40:43], v[124:127], v[148:151], v[40:43]
s_waitcnt lgkmcnt(14)
ds_write_b32 v14, v50
s_waitcnt lgkmcnt(14)
ds_read_b64 v[44:45], v15
v_mfma_f32_16x16x32_bf16 v[32:35], v[152:155], v[152:155], v[32:35]
s_waitcnt lgkmcnt(14)
ds_read_b128 v[88:91], v10 offset:8192
v_mfma_f32_16x16x32_bf16 v[36:39], v[128:131], v[152:155], v[36:39]
s_waitcnt lgkmcnt(14)
ds_read_b128 v[92:95], v10 offset:9216
v_mfma_f32_16x16x32_bf16 v[40:43], v[132:135], v[152:155], v[40:43]
v_mfma_f32_16x16x32_bf16 v[32:35], v[156:159], v[156:159], v[32:35]
v_mfma_f32_16x16x32_bf16 v[36:39], v[136:139], v[156:159], v[36:39]
v_mfma_f32_16x16x32_bf16 v[40:43], v[140:143], v[156:159], v[40:43]
s_waitcnt vmcnt(6)
s_cmp_eq_u32 s41, 63
s_cbranch_scc1 L_Rfast_finish
s_nop 2
v_max3_f32 v46, v32, v33, v34
v_max3_f32 v47, v35, v36, v37
v_max3_f32 v46, v46, v38, v39
v_max3_f32 v47, v47, v40, v41
v_max3_f32 v46, v46, v42, v43
v_max_f32 v46, v46, v47
v_mov_b32 v47, v46
v_mov_b64 v[112:113], 0
v_mov_b64 v[114:115], 0
v_permlane32_swap_b32 v46, v47
v_max_f32 v46, v46, v47
v_mov_b32 v47, v46
v_mov_b64 v[116:117], 0
v_mov_b64 v[118:119], 0
v_permlane16_swap_b32 v46, v47
v_max_f32 v46, v46, v47
v_mul_f32 v46, s88, v46
v_pk_fma_f32 v[32:33], v[32:33], s[88:89], v[46:47] op_sel_hi:[1,1,0] neg_lo:[0,0,1] neg_hi:[0,0,1]
v_pk_fma_f32 v[34:35], v[34:35], s[88:89], v[46:47] op_sel_hi:[1,1,0] neg_lo:[0,0,1] neg_hi:[0,0,1]
v_pk_fma_f32 v[36:37], v[36:37], s[88:89], v[46:47] op_sel_hi:[1,1,0] neg_lo:[0,0,1] neg_hi:[0,0,1]
v_pk_fma_f32 v[38:39], v[38:39], s[88:89], v[46:47] op_sel_hi:[1,1,0] neg_lo:[0,0,1] neg_hi:[0,0,1]
v_pk_fma_f32 v[40:41], v[40:41], s[88:89], v[46:47] op_sel_hi:[1,1,0] neg_lo:[0,0,1] neg_hi:[0,0,1]
v_pk_fma_f32 v[42:43], v[42:43], s[88:89], v[46:47] op_sel_hi:[1,1,0] neg_lo:[0,0,1] neg_hi:[0,0,1]
v_exp_f32 v36, v36
v_exp_f32 v37, v37
v_exp_f32 v38, v38
v_exp_f32 v39, v39
v_exp_f32 v40, v40
v_exp_f32 v41, v41
v_exp_f32 v42, v42
v_exp_f32 v43, v43
v_exp_f32 v32, v32
v_cvt_pk_bf16_f32 v48, v36, v37
v_cvt_pk_bf16_f32 v49, v38, v39
v_cvt_pk_bf16_f32 v50, v40, v41
v_cvt_pk_bf16_f32 v51, v42, v43
v_exp_f32 v33, v33
v_exp_f32 v34, v34
v_mfma_f32_16x16x32_bf16 v[36:39], v[20:23], v[48:51], 0
v_exp_f32 v35, v35
v_mfma_f32_16x16x32_bf16 v[40:43], v[52:55], v[48:51], 0
v_cvt_pk_bf16_f32 v46, v32, v33
v_cvt_pk_bf16_f32 v47, v34, v35
s_waitcnt lgkmcnt(14)
ds_read_b128 v[152:155], v10 offset:14336
s_waitcnt lgkmcnt(14)
ds_read_b128 v[156:159], v10 offset:15360
s_waitcnt lgkmcnt(14)
ds_read_b128 v[48:51], v10 offset:18432
s_waitcnt lgkmcnt(14)
ds_read_b128 v[52:55], v10 offset:19456
s_waitcnt lgkmcnt(6)
v_mfma_f32_16x16x16_bf16 v[36:39], v[20:21], v[46:47], v[36:39]
v_mfma_f32_16x16x16_bf16 v[40:43], v[44:45], v[46:47], v[40:43]
v_mov_b64 v[120:121], 0
v_mov_b64 v[122:123], 0
v_mov_b64 v[124:125], 0
v_mov_b64 v[126:127], 0
v_mov_b64 v[128:129], 0
v_mov_b64 v[130:131], 0
v_mov_b64 v[132:133], 0
v_rcp_f32 v36, v36
v_mov_b64 v[134:135], 0
v_pk_mul_f32 v[40:41], v[40:41], v[36:37] op_sel_hi:[1,0]
v_pk_mul_f32 v[42:43], v[42:43], v[36:37] op_sel_hi:[1,0]
v_cvt_pk_bf16_f32 v40, v40, v41
v_cvt_pk_bf16_f32 v41, v42, v43
s_mov_b64 exec, s[92:93]
ds_write_b64 v12, v[40:41]
s_mov_b64 exec, -1
v_mov_b64 v[136:137], 0
v_mov_b64 v[138:139], 0
v_mov_b64 v[140:141], 0
v_mov_b64 v[142:143], 0
v_mov_b64 v[144:145], 0
v_mov_b64 v[146:147], 0
v_mov_b64 v[148:149], 0
v_mov_b64 v[150:151], 0
s_cmp_ge_u32 s41, 62
s_cbranch_scc1 L_Rfast_efm_34
L_Rfast_efm_34_r:
s_waitcnt lgkmcnt(0)
s_barrier
ds_read_b128 v[32:35], v13
ds_read_b128 v[36:39], v10 offset:16384
ds_read_b128 v[40:43], v10 offset:17408
s_cmp_ge_u32 s41, 62
s_cbranch_scc1 L_Rfast_efm2_35
L_Rfast_efm2_35_r:
s_waitcnt lgkmcnt(2)
v_smfmac_f32_16x16x64_bf16 v[112:115], v[32:35], v[56:63], v1
v_smfmac_f32_16x16x64_bf16 v[116:119], v[32:35], v[64:71], v1
v_smfmac_f32_16x16x64_bf16 v[120:123], v[32:35], v[72:79], v1
v_smfmac_f32_16x16x64_bf16 v[124:127], v[32:35], v[80:87], v1
v_smfmac_f32_16x16x64_bf16 v[128:131], v[32:35], v[88:95], v1
v_smfmac_f32_16x16x64_bf16 v[132:135], v[32:35], v[96:103], v1
v_smfmac_f32_16x16x64_bf16 v[136:139], v[32:35], v[104:111], v1
v_smfmac_f32_16x16x64_bf16 v[140:143], v[32:35], v[152:159], v1
v_add_u32 v156, s95, v8
v_pk_add_f32 v[112:113], v[112:113], v[114:115]
v_smfmac_f32_16x16x64_bf16 v[148:151], v[32:35], v[48:55], v1
v_pk_add_f32 v[116:117], v[116:117], v[118:119]
s_waitcnt lgkmcnt(0)
v_smfmac_f32_16x16x64_bf16 v[144:147], v[32:35], v[36:43], v1
ds_read_b64_tr_b16 v[152:153], v156
ds_read_b64_tr_b16 v[154:155], v156 offset:512
v_cvt_pk_bf16_f32 v112, v112, v113
v_cvt_pk_bf16_f32 v113, v116, v117
v_and_or_b32 v112, v112, -2, s99
v_pk_add_f32 v[120:121], v[120:121], v[122:123]
v_pk_add_f32 v[124:125], v[124:125], v[126:127]
v_cvt_pk_bf16_f32 v114, v120, v121
v_cvt_pk_bf16_f32 v115, v124, v125
v_and_or_b32 v114, v114, -2, s99
global_store_dwordx4 v2, v[112:115], s[48:49] offset:0
v_pk_add_f32 v[128:129], v[128:129], v[130:131]
v_pk_add_f32 v[132:133], v[132:133], v[134:135]
v_cvt_pk_bf16_f32 v128, v128, v129
v_cvt_pk_bf16_f32 v129, v132, v133
v_and_or_b32 v128, v128, -2, s99
v_pk_add_f32 v[136:137], v[136:137], v[138:139]
v_pk_add_f32 v[140:141], v[140:141], v[142:143]
v_cvt_pk_bf16_f32 v130, v136, v137
v_cvt_pk_bf16_f32 v131, v140, v141
v_and_or_b32 v130, v130, -2, s99
global_store_dwordx4 v2, v[128:131], s[48:49] offset:1024
v_pk_add_f32 v[144:145], v[144:145], v[146:147]
v_pk_add_f32 v[148:149], v[148:149], v[150:151]
v_cvt_pk_bf16_f32 v144, v144, v145
v_cvt_pk_bf16_f32 v145, v148, v149
v_and_or_b32 v144, v144, -2, s99
global_store_dwordx2 v3, v[144:145], s[48:49] offset:2048
s_add_u32 s58, s12, s85
s_addc_u32 s59, s13, 0
s_add_u32 s60, s14, s97
s_addc_u32 s61, s15, 0
s_add_u32 s62, s16, s97
s_addc_u32 s63, s17, 0
s_add_u32 s64, s18, s85
s_addc_u32 s65, s19, 0
s_cmp_eq_u32 s40, 0
s_cbranch_scc1 L_Rfast_nored_36
s_sleep 5
global_load_dwordx4 v[56:59], v18, s[50:51] sc1
global_load_dwordx4 v[60:63], v18, s[52:53] sc1
global_load_dwordx4 v[64:67], v18, s[54:55] sc1
global_load_dwordx4 v[68:71], v18, s[56:57] sc1
s_sleep 3
global_load_dwordx4 v[72:75], v18, s[50:51] sc1
global_load_dwordx4 v[76:79], v18, s[52:53] sc1
global_load_dwordx4 v[80:83], v18, s[54:55] sc1
global_load_dwordx4 v[84:87], v18, s[56:57] sc1
s_waitcnt vmcnt(7)
v_mfma_f32_16x16x32_bf16 v[104:107], v[24:27], v[56:59], 0
v_xor_b32 v108, s99, v56
v_bitop3_b32 v108, v108, v58, s99 bitop3:0xf6
s_waitcnt vmcnt(6)
v_mfma_f32_16x16x32_bf16 v[104:107], v[24:27], v[60:63], v[104:107]
v_bitop3_b32 v108, v108, v60, s99 bitop3:0xf6
v_bitop3_b32 v108, v108, v62, s99 bitop3:0xf6
s_waitcnt vmcnt(5)
v_mfma_f32_16x16x32_bf16 v[104:107], v[24:27], v[64:67], v[104:107]
v_bitop3_b32 v108, v108, v64, s99 bitop3:0xf6
v_bitop3_b32 v108, v108, v66, s99 bitop3:0xf6
s_waitcnt vmcnt(4)
v_mfma_f32_16x16x32_bf16 v[104:107], v[24:27], v[68:71], v[104:107]
v_bitop3_b32 v108, v108, v68, s99 bitop3:0xf6
v_bitop3_b32 v108, v108, v70, s99 bitop3:0xf6
v_and_b32 v108, 1, v108
v_cmp_ne_u32 vcc, 0, v108
s_nop 2
s_cbranch_vccnz L_Rfast_rs1_38
L_Rfast_rok_39:
v_add_f32_dpp v104, v104, v104 row_ror:8 row_mask:0xf bank_mask:0xf
v_add_f32_dpp v105, v105, v105 row_ror:8 row_mask:0xf bank_mask:0xf
v_add_f32_dpp v106, v106, v106 row_ror:8 row_mask:0xf bank_mask:0xf
v_add_f32_dpp v107, v107, v107 row_ror:8 row_mask:0xf bank_mask:0xf
v_cvt_pk_bf16_f32 v112, v104, v105
v_cvt_pk_bf16_f32 v113, v106, v107
s_nop 0
v_permlane16_swap_b32 v112, v114
v_permlane16_swap_b32 v113, v115
v_and_or_b32 v112, v112, -2, s99
v_and_or_b32 v114, v114, -2, s99
s_mov_b64 exec, 0xff
global_store_dwordx4 v2, v[112:115], s[58:59] sc1
global_store_dwordx4 v2, v[112:115], s[60:61]
s_mov_b64 exec, -1
L_Rfast_redj_37:
s_barrier
s_waitcnt lgkmcnt(0)
v_mov_b64 v[156:157], v[44:45]
v_mov_b32 v158, s41
v_mov_b64 v[32:33], 0
v_mov_b64 v[34:35], 0
v_mov_b64 v[36:37], 0
v_mov_b64 v[38:39], 0
v_mov_b64 v[40:41], 0
v_mov_b64 v[42:43], 0
v_mov_b64 v[44:45], 0
v_mov_b64 v[46:47], 0
v_mov_b64 v[48:49], 0
v_mov_b64 v[50:51], 0
s_sleep 6
global_load_dwordx4 v[56:59], v2, s[62:63] sc1
global_load_dwordx4 v[60:63], v2, s[62:63] offset:1024 sc1
global_load_dwordx2 v[64:65], v3, s[62:63] offset:2048 sc1
global_load_dwordx4 v[112:115], v2, s[64:65] sc1
global_load_dwordx4 v[116:119], v2, s[64:65] offset:1024 sc1
global_load_dwordx2 v[120:121], v3, s[64:65] offset:2048 sc1
s_add_u32 s41, s41, 1
s_xor_b32 s96, s96, 655360
s_xor_b32 s97, s97, 20480
s_xor_b32 s85, s85, 65536
s_add_u32 s48, s8, s96
s_addc_u32 s49, s9, 0
s_add_u32 s50, s10, s96
s_addc_u32 s51, s11, 0
s_add_u32 s52, s50, 81920
s_addc_u32 s53, s51, 0
s_add_u32 s54, s52, 81920
s_addc_u32 s55, s53, 0
s_add_u32 s56, s54, 81920
s_addc_u32 s57, s55, 0
s_and_b32 s44, s41, 1
s_lshl_b32 s44, s44, 13
s_add_u32 s44, s44, 141312
v_add_u32 v9, s44, v2
s_xor_b32 s44, s41, 1
s_and_b32 s44, s44, 1
s_lshl_b32 s44, s44, 13
s_add_u32 s44, s44, 141312
s_lshl_b32 s45, s32, 11
s_add_u32 s98, s44, s45
s_cmp_lt_u32 s41, 63
s_cselect_b32 s44, 262144, 0
s_add_u32 s66, s66, s44
s_addc_u32 s67, s67, 0
s_add_u32 s68, s68, 262144
s_addc_u32 s69, s69, 0
s_add_u32 s94, s41, 2
s_min_u32 s94, s94, 64
s_mov_b32 s70, s76
s_mov_b32 s71, s77
s_mov_b32 s72, s78
s_mov_b32 s73, s79
s_add_u32 s76, s76, 131072
s_addc_u32 s77, s77, 0
s_add_u32 s78, s78, 131072
s_addc_u32 s79, s79, 0
s_waitcnt vmcnt(3)
v_xor_b32 v104, s99, v56
v_bitop3_b32 v104, v104, v58, s99 bitop3:0xf6
v_bitop3_b32 v104, v104, v60, s99 bitop3:0xf6
v_bitop3_b32 v104, v104, v62, s99 bitop3:0xf6
v_bitop3_b32 v104, v104, v64, s99 bitop3:0xf6
v_and_b32 v104, 1, v104
v_cmp_ne_u32 vcc, 0, v104
s_nop 2
s_cbranch_vccnz L_Rfast_lre_40
L_Rfast_lok_41:
v_lshlrev_b32 v68, 16, v56
v_and_b32 v69, 0xffff0000, v56
v_lshlrev_b32 v70, 16, v57
v_and_b32 v71, 0xffff0000, v57
v_lshlrev_b32 v72, 16, v58
v_and_b32 v73, 0xffff0000, v58
v_lshlrev_b32 v74, 16, v59
v_and_b32 v75, 0xffff0000, v59
v_lshlrev_b32 v76, 16, v60
v_and_b32 v77, 0xffff0000, v60
v_lshlrev_b32 v78, 16, v61
v_and_b32 v79, 0xffff0000, v61
v_lshlrev_b32 v80, 16, v62
v_and_b32 v81, 0xffff0000, v62
v_lshlrev_b32 v82, 16, v63
v_and_b32 v83, 0xffff0000, v63
v_lshlrev_b32 v84, 16, v64
v_and_b32 v85, 0xffff0000, v64
v_lshlrev_b32 v86, 16, v65
v_and_b32 v87, 0xffff0000, v65
s_waitcnt vmcnt(0)
v_xor_b32 v104, s99, v112
v_bitop3_b32 v104, v104, v114, s99 bitop3:0xf6
v_bitop3_b32 v104, v104, v116, s99 bitop3:0xf6
v_bitop3_b32 v104, v104, v118, s99 bitop3:0xf6
v_bitop3_b32 v104, v104, v120, s99 bitop3:0xf6
v_and_b32 v104, 1, v104
v_cmp_ne_u32 vcc, 0, v104
s_nop 2
s_cbranch_vccnz L_Rfast_gs1_42
L_Rfast_gok_43:
v_dot2_f32_bf16 v68, v112, s90, v68
v_dot2_f32_bf16 v69, v112, s91, v69
v_dot2_f32_bf16 v70, v113, s90, v70
v_dot2_f32_bf16 v71, v113, s91, v71
v_dot2_f32_bf16 v72, v114, s90, v72
v_dot2_f32_bf16 v73, v114, s91, v73
v_dot2_f32_bf16 v74, v115, s90, v74
v_dot2_f32_bf16 v75, v115, s91, v75
v_cvt_pk_bf16_f32 v56, v68, v69
v_cvt_pk_bf16_f32 v57, v70, v71
ds_write_b64 v17, v[56:57] offset:0
v_dot2_f32_bf16 v76, v116, s90, v76
v_dot2_f32_bf16 v77, v116, s91, v77
v_dot2_f32_bf16 v78, v117, s90, v78
v_dot2_f32_bf16 v79, v117, s91, v79
v_cvt_pk_bf16_f32 v58, v72, v73
v_cvt_pk_bf16_f32 v59, v74, v75
ds_write_b64 v17, v[58:59] offset:512
v_dot2_f32_bf16 v80, v118, s90, v80
v_dot2_f32_bf16 v81, v118, s91, v81
v_dot2_f32_bf16 v82, v119, s90, v82
v_dot2_f32_bf16 v83, v119, s91, v83
v_cvt_pk_bf16_f32 v60, v76, v77
v_cvt_pk_bf16_f32 v61, v78, v79
ds_write_b64 v17, v[60:61] offset:1024
v_dot2_f32_bf16 v84, v120, s90, v84
v_dot2_f32_bf16 v85, v120, s91, v85
v_dot2_f32_bf16 v86, v121, s90, v86
v_dot2_f32_bf16 v87, v121, s91, v87
v_cvt_pk_bf16_f32 v62, v80, v81
v_cvt_pk_bf16_f32 v63, v82, v83
ds_write_b64 v17, v[62:63] offset:1536
v_cvt_pk_bf16_f32 v64, v84, v85
v_cvt_pk_bf16_f32 v65, v86, v87
ds_write_b64 v17, v[64:65] offset:2048
s_waitcnt lgkmcnt(0)
s_branch L_Rfast_loop
L_Rfast_finish:
s_waitcnt lgkmcnt(0)
v_add_u32 v60, s95, v8
ds_read_b64_tr_b16 v[56:57], v60
ds_read_b64_tr_b16 v[58:59], v60 offset:512
s_waitcnt lgkmcnt(0)
global_store_dwordx4 v2, v[56:59], s[76:77] sc1
global_store_dwordx2 v3, v[44:45], s[78:79] sc1
s_waitcnt vmcnt(0)
s_barrier
s_cmp_eq_u32 s32, 0
s_cbranch_scc0 L_Rfast_end
s_mov_b64 exec, 1
v_mov_b32 v146, 64
global_store_dword v3, v146, s[100:101] sc1
s_waitcnt vmcnt(0)
L_Rfast_end:
s_endpgm
L_Rfast_fs_31:
s_mov_b32 s74, 0
L_Rfast_fs_31_l:
global_load_dword v0, v19, s[30:31] sc1
s_waitcnt vmcnt(0)
v_cmp_gt_u32 vcc, s94, v0
s_nop 2
s_cbranch_vccz L_Rfast_prime_30
s_sleep 2
s_add_u32 s74, s74, 1
s_cmp_lt_u32 s74, 131072
s_cbranch_scc1 L_Rfast_fs_31_l
s_endpgm
L_Rfast_fs_33:
s_mov_b32 s74, 0
L_Rfast_fs_33_l:
global_load_dword v0, v19, s[30:31] sc1
s_waitcnt vmcnt(0)
v_cmp_gt_u32 vcc, s94, v0
s_nop 2
s_cbranch_vccz L_Rfast_fret_32
s_sleep 2
s_add_u32 s74, s74, 1
s_cmp_lt_u32 s74, 131072
s_cbranch_scc1 L_Rfast_fs_33_l
s_endpgm
L_Rfast_efm_34:
s_waitcnt vmcnt(0)
s_branch L_Rfast_efm_34_r
L_Rfast_efm2_35:
s_mov_b64 exec, 1
v_mov_b32 v46, s41
global_store_dword v3, v46, s[100:101] sc1
s_mov_b64 exec, -1
s_branch L_Rfast_efm2_35_r
L_Rfast_nored_36:
s_branch L_Rfast_redj_37
L_Rfast_rs1_38:
s_mov_b32 s74, 0
L_Rfast_rs1_38_l:
global_load_dwordx4 v[56:59], v18, s[50:51] sc1
global_load_dwordx4 v[60:63], v18, s[52:53] sc1
global_load_dwordx4 v[64:67], v18, s[54:55] sc1
global_load_dwordx4 v[68:71], v18, s[56:57] sc1
s_waitcnt vmcnt(7)
v_mfma_f32_16x16x32_bf16 v[104:107], v[24:27], v[72:75], 0
v_xor_b32 v108, s99, v72
v_bitop3_b32 v108, v108, v74, s99 bitop3:0xf6
s_waitcnt vmcnt(6)
v_mfma_f32_16x16x32_bf16 v[104:107], v[24:27], v[76:79], v[104:107]
v_bitop3_b32 v108, v108, v76, s99 bitop3:0xf6
v_bitop3_b32 v108, v108, v78, s99 bitop3:0xf6
s_waitcnt vmcnt(5)
v_mfma_f32_16x16x32_bf16 v[104:107], v[24:27], v[80:83], v[104:107]
v_bitop3_b32 v108, v108, v80, s99 bitop3:0xf6
v_bitop3_b32 v108, v108, v82, s99 bitop3:0xf6
s_waitcnt vmcnt(4)
v_mfma_f32_16x16x32_bf16 v[104:107], v[24:27], v[84:87], v[104:107]
v_bitop3_b32 v108, v108, v84, s99 bitop3:0xf6
v_bitop3_b32 v108, v108, v86, s99 bitop3:0xf6
v_and_b32 v108, 1, v108
v_cmp_ne_u32 vcc, 0, v108
s_nop 2
s_cbranch_vccnz L_Rfast_rs1_38_n_44
s_nop 7
s_branch L_Rfast_rok_39
L_Rfast_rs1_38_n_44:
global_load_dwordx4 v[72:75], v18, s[50:51] sc1
global_load_dwordx4 v[76:79], v18, s[52:53] sc1
global_load_dwordx4 v[80:83], v18, s[54:55] sc1
global_load_dwordx4 v[84:87], v18, s[56:57] sc1
s_waitcnt vmcnt(7)
v_mfma_f32_16x16x32_bf16 v[104:107], v[24:27], v[56:59], 0
v_xor_b32 v108, s99, v56
v_bitop3_b32 v108, v108, v58, s99 bitop3:0xf6
s_waitcnt vmcnt(6)
v_mfma_f32_16x16x32_bf16 v[104:107], v[24:27], v[60:63], v[104:107]
v_bitop3_b32 v108, v108, v60, s99 bitop3:0xf6
v_bitop3_b32 v108, v108, v62, s99 bitop3:0xf6
s_waitcnt vmcnt(5)
v_mfma_f32_16x16x32_bf16 v[104:107], v[24:27], v[64:67], v[104:107]
v_bitop3_b32 v108, v108, v64, s99 bitop3:0xf6
v_bitop3_b32 v108, v108, v66, s99 bitop3:0xf6
s_waitcnt vmcnt(4)
v_mfma_f32_16x16x32_bf16 v[104:107], v[24:27], v[68:71], v[104:107]
v_bitop3_b32 v108, v108, v68, s99 bitop3:0xf6
v_bitop3_b32 v108, v108, v70, s99 bitop3:0xf6
v_and_b32 v108, 1, v108
v_cmp_ne_u32 vcc, 0, v108
s_nop 2
s_cbranch_vccnz L_Rfast_rs1_38_n_45
s_nop 7
s_branch L_Rfast_rok_39
L_Rfast_rs1_38_n_45:
s_add_u32 s74, s74, 1
s_cmp_lt_u32 s74, 131072
s_cbranch_scc1 L_Rfast_rs1_38_l
s_endpgm
L_Rfast_lre_40:
s_mov_b32 s74, 0
s_or_b32 exec_lo, vcc_lo, 1
s_mov_b32 exec_hi, vcc_hi
global_load_dwordx4 v[56:59], v2, s[62:63] sc1
global_load_dwordx4 v[60:63], v2, s[62:63] offset:1024 sc1
global_load_dwordx2 v[64:65], v3, s[62:63] offset:2048 sc1
L_Rfast_lre_40_l:
global_load_dwordx4 v[56:59], v2, s[62:63] sc1
global_load_dwordx4 v[60:63], v2, s[62:63] offset:1024 sc1
global_load_dwordx2 v[64:65], v3, s[62:63] offset:2048 sc1
s_add_u32 s74, s74, 1
s_waitcnt vmcnt(3)
v_xor_b32 v104, s99, v56
v_bitop3_b32 v104, v104, v58, s99 bitop3:0xf6
v_bitop3_b32 v104, v104, v60, s99 bitop3:0xf6
v_bitop3_b32 v104, v104, v62, s99 bitop3:0xf6
v_bitop3_b32 v104, v104, v64, s99 bitop3:0xf6
v_and_b32 v104, 1, v104
v_cmp_ne_u32 vcc, 0, v104
s_nop 2
s_cbranch_vccz L_Rfast_lre_40_ok
s_or_b32 exec_lo, vcc_lo, 1
s_mov_b32 exec_hi, vcc_hi
s_cmp_lt_u32 s74, 131072
s_cbranch_scc1 L_Rfast_lre_40_l
s_endpgm
L_Rfast_lre_40_ok:
s_mov_b64 exec, -1
s_waitcnt vmcnt(0)
s_branch L_Rfast_lok_41
L_Rfast_gs1_42:
s_mov_b32 s74, 0
s_or_b32 exec_lo, vcc_lo, 1
s_mov_b32 exec_hi, vcc_hi
global_load_dwordx4 v[112:115], v2, s[64:65] sc1
global_load_dwordx4 v[116:119], v2, s[64:65] offset:1024 sc1
global_load_dwordx2 v[120:121], v3, s[64:65] offset:2048 sc1
L_Rfast_gs1_42_l:
global_load_dwordx4 v[112:115], v2, s[64:65] sc1
global_load_dwordx4 v[116:119], v2, s[64:65] offset:1024 sc1
global_load_dwordx2 v[120:121], v3, s[64:65] offset:2048 sc1
s_add_u32 s74, s74, 1
s_waitcnt vmcnt(3)
v_xor_b32 v104, s99, v112
v_bitop3_b32 v104, v104, v114, s99 bitop3:0xf6
v_bitop3_b32 v104, v104, v116, s99 bitop3:0xf6
v_bitop3_b32 v104, v104, v118, s99 bitop3:0xf6
v_bitop3_b32 v104, v104, v120, s99 bitop3:0xf6
v_and_b32 v104, 1, v104
v_cmp_ne_u32 vcc, 0, v104
s_nop 2
s_cbranch_vccz L_Rfast_gs1_42_ok
s_or_b32 exec_lo, vcc_lo, 1
s_mov_b32 exec_hi, vcc_hi
s_cmp_lt_u32 s74, 131072
s_cbranch_scc1 L_Rfast_gs1_42_l
s_endpgm
L_Rfast_gs1_42_ok:
s_mov_b64 exec, -1
s_branch L_Rfast_gok_43
L_Rslow_start:
s_mov_b32 s41, 0
s_mov_b32 s96, 0
s_mov_b32 s97, 0
s_mov_b32 s99, 0
s_lshl_b32 s44, s36, 13
s_add_u32 s66, s30, 16777216
s_addc_u32 s67, s31, 0
s_add_u32 s66, s66, s44
s_addc_u32 s67, s67, 0
s_lshl_b32 s45, s32, 11
s_add_u32 s66, s66, s45
s_addc_u32 s67, s67, 0
s_add_u32 s68, s30, 33554432
s_addc_u32 s69, s31, 0
s_add_u32 s68, s68, s44
s_addc_u32 s69, s69, 0
s_lshl_b32 s45, s37, 2
s_add_u32 s45, s45, s32
s_lshl_b32 s46, s45, 10
s_add_u32 s68, s68, s46
s_addc_u32 s69, s69, 0
s_lshl_b32 s44, s36, 12
s_add_u32 s70, s30, 67108864
s_addc_u32 s71, s31, 0
s_add_u32 s70, s70, s44
s_addc_u32 s71, s71, 0
s_and_b32 s95, s32, 1
s_lshl_b32 s47, s37, 1
s_add_u32 s95, s95, s47
s_lshl_b32 s95, s95, 10
s_add_u32 s70, s70, s95
s_addc_u32 s71, s71, 0
s_add_u32 s72, s30, 75497472
s_addc_u32 s73, s31, 0
s_add_u32 s72, s72, s44
s_addc_u32 s73, s73, 0
s_lshl_b32 s46, s45, 9
s_add_u32 s72, s72, s46
s_addc_u32 s73, s73, 0
s_lshl_b32 s44, s36, 1
s_add_u32 s44, s44, s37
s_lshl_b32 s44, s44, 6
s_add_u32 s44, s44, 16384
s_add_u32 s100, s30, s44
s_addc_u32 s101, s31, 0
v_lshrrev_b32 v56, 4, v2
v_and_b32 v57, 3, v56
v_lshlrev_b32 v57, 2, v57
v_bfe_u32 v58, v56, 2, 1
v_mul_u32_u24 v58, 4096, v58
v_add_u32 v57, v57, v58
s_lshl_b32 s44, s36, 6
v_add_u32 v19, s44, v57
s_mul_i32 s45, s38, 10240
s_mul_i32 s46, s32, 2560
s_add_u32 s45, s45, s46
s_add_u32 s8, s30, 5242880
s_addc_u32 s9, s31, 0
s_add_u32 s8, s8, s45
s_addc_u32 s9, s9, 0
s_mul_i32 s45, s35, 327680
s_add_u32 s45, s45, 5242880
s_cmp_eq_u32 s40, 0
s_cselect_b32 s45, 8388608, s45
s_add_u32 s10, s30, s45
s_addc_u32 s11, s31, 0
s_min_u32 s47, s39, 79
s_mul_i32 s45, s35, 10240
s_lshl_b32 s46, s47, 7
s_add_u32 s46, s46, s45
s_add_u32 s46, s46, 4194304
s_lshl_b32 s44, s47, 7
s_sub_u32 s45, s44, 7680
s_add_u32 s45, s45, 16384
s_cmp_ge_u32 s47, 60
s_cselect_b32 s44, s45, s44
s_lshl_b32 s45, s35, 15
s_add_u32 s44, s44, s45
s_add_u32 s44, s44, s86
s_add_u32 s44, s44, 4325376
s_lshl_b32 s47, s38, 8
s_add_u32 s47, s47, 10485760
s_cmp_eq_u32 s40, 0
s_cselect_b32 s44, s47, s44
s_cselect_b32 s46, s47, s46
s_add_u32 s12, s30, s44
s_addc_u32 s13, s31, 0
s_add_u32 s14, s30, s46
s_addc_u32 s15, s31, 0
s_mov_b32 s46, s32
s_mul_i32 s45, s35, 10240
s_mul_i32 s47, s46, 2560
s_add_u32 s44, s45, s47
s_add_u32 s44, s44, 4194304
s_add_u32 s16, s30, s44
s_addc_u32 s17, s31, 0
s_cmp_eq_u32 s46, 3
s_cselect_b32 s47, 16384, s47
s_xor_b32 s45, s35, 1
s_lshl_b32 s45, s45, 15
s_add_u32 s44, s45, s47
s_add_u32 s44, s44, s86
s_add_u32 s44, s44, 4325376
s_add_u32 s18, s30, s44
s_addc_u32 s19, s31, 0
s_mov_b32 s85, 0
s_mov_b32 s24, -1
s_mov_b32 s25, 0
s_lshl_b32 s45, s34, 7
s_add_u32 s45, s45, s86
s_add_u32 s45, s45, 4344320
s_lshl_b32 s44, s35, 15
s_add_u32 s44, s44, s45
s_add_u32 s80, s30, s44
s_addc_u32 s81, s31, 0
s_xor_b32 s44, s35, 1
s_lshl_b32 s44, s44, 15
s_add_u32 s44, s44, s45
s_add_u32 s82, s30, s44
s_addc_u32 s83, s31, 0
s_mov_b32 s76, s70
s_mov_b32 s77, s71
s_mov_b32 s78, s72
s_mov_b32 s79, s73
s_lshl_b32 s44, s38, 2
s_add_u32 s44, s44, s32
s_lshl_b32 s44, s44, 10
s_add_u32 s44, s44, 8388608
s_add_u32 s70, s30, s44
s_addc_u32 s71, s31, 0
s_add_u32 s72, s30, s44
s_addc_u32 s73, s31, 0
s_lshl_b32 s87, 1, s32
v_mov_b32 v158, 0
s_mov_b32 s94, 1
s_branch L_Rslow_fs_47
L_Rslow_prime_46:
s_lshl_b32 s44, s32, 11
s_add_u32 m0, s44, 141312
s_add_u32 s98, s44, 149504
global_load_lds_dwordx4 v2, s[66:67] sc1
global_load_lds_dwordx4 v2, s[66:67] offset:1024 sc1
s_add_u32 s66, s66, 262144
s_addc_u32 s67, s67, 0
s_mov_b32 s94, 2
s_add_u32 s48, s8, s96
s_addc_u32 s49, s9, 0
s_add_u32 s50, s10, s96
s_addc_u32 s51, s11, 0
s_add_u32 s52, s50, 81920
s_addc_u32 s53, s51, 0
s_add_u32 s54, s52, 81920
s_addc_u32 s55, s53, 0
s_add_u32 s56, s54, 81920
s_addc_u32 s57, s55, 0
v_mov_b64 v[32:33], 0
v_mov_b64 v[34:35], 0
v_mov_b64 v[36:37], 0
v_mov_b64 v[38:39], 0
v_mov_b64 v[40:41], 0
v_mov_b64 v[42:43], 0
v_mov_b64 v[44:45], 0
v_mov_b64 v[46:47], 0
v_mov_b64 v[48:49], 0
v_mov_b64 v[50:51], 0
s_waitcnt vmcnt(0)
L_Rslow_loop:
s_barrier
ds_read_b64_tr_b16 v[56:57], v4 offset:0
ds_read_b64_tr_b16 v[58:59], v5 offset:0
ds_read_b64_tr_b16 v[60:61], v4 offset:1024
ds_read_b64_tr_b16 v[62:63], v5 offset:1024
ds_read_b64_tr_b16 v[64:65], v4 offset:2048
ds_read_b64_tr_b16 v[66:67], v5 offset:2048
ds_read_b64_tr_b16 v[68:69], v4 offset:3072
ds_read_b64_tr_b16 v[70:71], v5 offset:3072
s_waitcnt lgkmcnt(6)
v_smfmac_f32_16x16x64_bf16 v[32:35], v[56:59], a[0:7], v1
v_cmp_gt_u32 vcc, s94, v0
ds_read_b64_tr_b16 v[72:73], v4 offset:4096
v_smfmac_f32_16x16x64_bf16 v[36:39], v[56:59], a[8:15], v1
s_nop 0
s_cbranch_vccnz L_Rslow_fs_49
L_Rslow_fret_48:
ds_read_b64_tr_b16 v[74:75], v5 offset:4096
v_smfmac_f32_16x16x64_bf16 v[40:43], v[56:59], a[16:23], v1
s_lshr_b32 s99, s41, 1
s_and_b32 s99, s99, 1
ds_read_b128 v[96:99], v11 offset:0
global_load_dwordx4 v[52:55], v2, s[68:69] sc1
v_smfmac_f32_16x16x64_bf16 v[44:47], v[56:59], a[240:247], v1
ds_read_b128 v[100:103], v11 offset:1024
s_waitcnt lgkmcnt(8)
v_smfmac_f32_16x16x64_bf16 v[32:35], v[60:63], a[24:31], v1
ds_read_b64_tr_b16 v[76:77], v4 offset:5120
v_smfmac_f32_16x16x64_bf16 v[36:39], v[60:63], a[32:39], v1
ds_read_b64_tr_b16 v[78:79], v5 offset:5120
v_smfmac_f32_16x16x64_bf16 v[40:43], v[60:63], a[40:47], v1
ds_read_b128 v[104:107], v11 offset:2048
s_mov_b32 m0, s98
s_nop 0
global_load_lds_dwordx4 v2, s[66:67] sc1
v_smfmac_f32_16x16x64_bf16 v[44:47], v[60:63], a[248:255], v1
ds_read_b128 v[108:111], v11 offset:3072
s_waitcnt lgkmcnt(10)
v_smfmac_f32_16x16x64_bf16 v[32:35], v[64:67], a[48:55], v1
ds_read_b64_tr_b16 v[80:81], v4 offset:6144
v_smfmac_f32_16x16x64_bf16 v[36:39], v[64:67], a[56:63], v1
ds_read_b64_tr_b16 v[82:83], v5 offset:6144
v_smfmac_f32_16x16x64_bf16 v[40:43], v[64:67], a[64:71], v1
ds_read_b64_tr_b16 v[84:85], v4 offset:7168
global_load_lds_dwordx4 v2, s[66:67] offset:1024 sc1
v_smfmac_f32_16x16x64_bf16 v[44:47], v[64:67], v[160:167], v1
ds_read_b64_tr_b16 v[86:87], v5 offset:7168
s_waitcnt lgkmcnt(12)
v_smfmac_f32_16x16x64_bf16 v[32:35], v[68:71], a[72:79], v1
ds_read_b64_tr_b16 v[88:89], v4 offset:8192
v_smfmac_f32_16x16x64_bf16 v[36:39], v[68:71], a[80:87], v1
ds_read_b64_tr_b16 v[90:91], v5 offset:8192
v_smfmac_f32_16x16x64_bf16 v[40:43], v[68:71], a[88:95], v1
ds_read_b64_tr_b16 v[92:93], v4 offset:9216
global_store_dwordx4 v2, v[152:155], s[70:71] sc1
v_smfmac_f32_16x16x64_bf16 v[44:47], v[68:71], v[168:175], v1
s_waitcnt lgkmcnt(14)
ds_read_b64_tr_b16 v[94:95], v5 offset:9216
s_waitcnt lgkmcnt(14)
v_smfmac_f32_16x16x64_bf16 v[32:35], v[72:75], a[96:103], v1
v_smfmac_f32_16x16x64_bf16 v[36:39], v[72:75], a[104:111], v1
v_smfmac_f32_16x16x64_bf16 v[40:43], v[72:75], a[112:119], v1
global_store_dwordx2 v3, v[156:157], s[72:73] sc1
s_waitcnt lgkmcnt(12)
v_smfmac_f32_16x16x64_bf16 v[44:47], v[72:75], v[96:103], v1
s_waitcnt lgkmcnt(10)
v_smfmac_f32_16x16x64_bf16 v[32:35], v[76:79], a[120:127], v1
ds_read_b128 v[96:99], v11 offset:4096
v_smfmac_f32_16x16x64_bf16 v[36:39], v[76:79], a[128:135], v1
ds_read_b128 v[100:103], v11 offset:5120
v_smfmac_f32_16x16x64_bf16 v[40:43], v[76:79], a[136:143], v1
s_waitcnt vmcnt(5)
ds_read_b128 v[112:115], v9 offset:0
s_mov_b64 exec, 1
global_store_dword v3, v158, s[100:101] sc1
s_mov_b64 exec, -1
global_load_dword v0, v19, s[30:31] sc1
s_waitcnt lgkmcnt(11)
v_smfmac_f32_16x16x64_bf16 v[44:47], v[76:79], v[104:111], v1
ds_read_b128 v[116:119], v9 offset:1024
s_waitcnt lgkmcnt(10)
v_smfmac_f32_16x16x64_bf16 v[32:35], v[80:83], a[144:151], v1
ds_read_b128 v[104:107], v11 offset:6144
v_smfmac_f32_16x16x64_bf16 v[36:39], v[80:83], a[152:159], v1
ds_read_b128 v[108:111], v11 offset:7168
v_smfmac_f32_16x16x64_bf16 v[40:43], v[80:83], a[160:167], v1
ds_read_b128 v[120:123], v9 offset:2048
s_waitcnt lgkmcnt(5)
v_smfmac_f32_16x16x64_bf16 v[44:47], v[80:83], v[96:103], v1
ds_read_b128 v[124:127], v9 offset:3072
v_smfmac_f32_16x16x64_bf16 v[32:35], v[84:87], a[168:175], v1
ds_read_b128 v[96:99], v11 offset:8192
v_smfmac_f32_16x16x64_bf16 v[36:39], v[84:87], a[176:183], v1
ds_read_b128 v[100:103], v11 offset:9216
v_smfmac_f32_16x16x64_bf16 v[40:43], v[84:87], a[184:191], v1
ds_read_b128 v[128:131], v9 offset:4096
s_waitcnt lgkmcnt(5)
v_smfmac_f32_16x16x64_bf16 v[44:47], v[84:87], v[104:111], v1
ds_read_b128 v[132:135], v9 offset:5120
v_smfmac_f32_16x16x64_bf16 v[32:35], v[88:91], a[192:199], v1
ds_read_b128 v[104:107], v11 offset:10240
v_smfmac_f32_16x16x64_bf16 v[36:39], v[88:91], a[200:207], v1
ds_read_b128 v[108:111], v11 offset:11264
v_smfmac_f32_16x16x64_bf16 v[40:43], v[88:91], a[208:215], v1
ds_read_b128 v[136:139], v9 offset:6144
s_waitcnt lgkmcnt(5)
v_smfmac_f32_16x16x64_bf16 v[44:47], v[88:91], v[96:103], v1
ds_read_b128 v[140:143], v9 offset:7168
v_smfmac_f32_16x16x64_bf16 v[32:35], v[92:95], a[216:223], v1
v_smfmac_f32_16x16x64_bf16 v[36:39], v[92:95], a[224:231], v1
v_smfmac_f32_16x16x64_bf16 v[40:43], v[92:95], a[232:239], v1
s_waitcnt lgkmcnt(2)
v_smfmac_f32_16x16x64_bf16 v[44:47], v[92:95], v[104:111], v1
s_nop 3
v_pk_add_f32 v[32:33], v[32:33], v[34:35]
v_pk_add_f32 v[36:37], v[36:37], v[38:39]
v_pk_add_f32 v[40:41], v[40:41], v[42:43]
s_nop 0
v_pk_add_f32 v[44:45], v[44:45], v[46:47]
v_cvt_pk_bf16_f32 v34, v32, v33
v_cvt_pk_bf16_f32 v38, v36, v37
v_cvt_pk_bf16_f32 v42, v40, v41
v_cvt_pk_bf16_f32 v46, v44, v45
ds_write2st64_b32 v6, v34, v38 offset0:0 offset1:2
ds_write2st64_b32 v7, v42, v46 offset0:0 offset1:2
v_smfmac_f32_16x16x64_bf16 v[48:51], v[56:59], v[176:183], v1
v_smfmac_f32_16x16x64_bf16 v[48:51], v[60:63], v[184:191], v1
v_smfmac_f32_16x16x64_bf16 v[48:51], v[64:67], v[192:199], v1
s_waitcnt lgkmcnt(0)
s_barrier
ds_read_b64_tr_b16 v[144:145], v8 offset:0
ds_read_b64_tr_b16 v[146:147], v8 offset:512
ds_read_b64_tr_b16 v[148:149], v8 offset:1024
ds_read_b64_tr_b16 v[150:151], v8 offset:1536
ds_read_b64_tr_b16 v[152:153], v8 offset:2048
ds_read_b64_tr_b16 v[154:155], v8 offset:2560
ds_read_b64_tr_b16 v[156:157], v8 offset:3072
ds_read_b64_tr_b16 v[158:159], v8 offset:3584
v_smfmac_f32_16x16x64_bf16 v[48:51], v[68:71], v[200:207], v1
ds_read_b128 v[56:59], v10 offset:0
v_smfmac_f32_16x16x64_bf16 v[48:51], v[72:75], v[208:215], v1
ds_read_b128 v[60:63], v10 offset:1024
v_smfmac_f32_16x16x64_bf16 v[48:51], v[76:79], v[216:223], v1
ds_read_b128 v[96:99], v10 offset:10240
v_smfmac_f32_16x16x64_bf16 v[48:51], v[80:83], v[224:231], v1
ds_read_b128 v[100:103], v10 offset:11264
v_smfmac_f32_16x16x64_bf16 v[48:51], v[84:87], v[232:239], v1
ds_read_b128 v[64:67], v10 offset:2048
v_smfmac_f32_16x16x64_bf16 v[48:51], v[88:91], v[240:247], v1
ds_read_b128 v[68:71], v10 offset:3072
v_smfmac_f32_16x16x64_bf16 v[48:51], v[92:95], v[248:255], v1
ds_read_b128 v[104:107], v10 offset:12288
s_waitcnt lgkmcnt(13)
v_mfma_f32_16x16x32_bf16 v[32:35], v[144:147], v[144:147], v[28:31]
ds_read_b128 v[108:111], v10 offset:13312
v_mfma_f32_16x16x32_bf16 v[36:39], v[112:115], v[144:147], 0
ds_read_b128 v[72:75], v10 offset:4096
v_mfma_f32_16x16x32_bf16 v[40:43], v[116:119], v[144:147], 0
s_waitcnt lgkmcnt(14)
ds_read_b128 v[76:79], v10 offset:5120
s_waitcnt lgkmcnt(14)
v_mfma_f32_16x16x32_bf16 v[32:35], v[148:151], v[148:151], v[32:35]
ds_read_b128 v[80:83], v10 offset:6144
v_pk_add_f32 v[48:49], v[48:49], v[50:51]
v_mfma_f32_16x16x32_bf16 v[36:39], v[120:123], v[148:151], v[36:39]
s_waitcnt lgkmcnt(14)
ds_read_b128 v[84:87], v10 offset:7168
v_cvt_pk_bf16_f32 v50, v48, v49
v_mfma_f32_16x16x32_bf16 v[40:43], v[124:127], v[148:151], v[40:43]
s_waitcnt lgkmcnt(14)
ds_write_b32 v14, v50
s_waitcnt lgkmcnt(14)
ds_read_b64 v[44:45], v15
v_mfma_f32_16x16x32_bf16 v[32:35], v[152:155], v[152:155], v[32:35]
s_waitcnt lgkmcnt(14)
ds_read_b128 v[88:91], v10 offset:8192
v_mfma_f32_16x16x32_bf16 v[36:39], v[128:131], v[152:155], v[36:39]
s_waitcnt lgkmcnt(14)
ds_read_b128 v[92:95], v10 offset:9216
v_mfma_f32_16x16x32_bf16 v[40:43], v[132:135], v[152:155], v[40:43]
v_mfma_f32_16x16x32_bf16 v[32:35], v[156:159], v[156:159], v[32:35]
v_mfma_f32_16x16x32_bf16 v[36:39], v[136:139], v[156:159], v[36:39]
v_mfma_f32_16x16x32_bf16 v[40:43], v[140:143], v[156:159], v[40:43]
s_waitcnt vmcnt(6)
s_cmp_eq_u32 s41, 63
s_cbranch_scc1 L_Rslow_finish
s_nop 2
v_max3_f32 v46, v32, v33, v34
v_max3_f32 v47, v35, v36, v37
v_max3_f32 v46, v46, v38, v39
v_max3_f32 v47, v47, v40, v41
v_max3_f32 v46, v46, v42, v43
v_max_f32 v46, v46, v47
v_mov_b32 v47, v46
v_mov_b64 v[112:113], 0
v_mov_b64 v[114:115], 0
v_permlane32_swap_b32 v46, v47
v_max_f32 v46, v46, v47
v_mov_b32 v47, v46
v_mov_b64 v[116:117], 0
v_mov_b64 v[118:119], 0
v_permlane16_swap_b32 v46, v47
v_max_f32 v46, v46, v47
v_mul_f32 v46, s88, v46
v_pk_fma_f32 v[32:33], v[32:33], s[88:89], v[46:47] op_sel_hi:[1,1,0] neg_lo:[0,0,1] neg_hi:[0,0,1]
v_pk_fma_f32 v[34:35], v[34:35], s[88:89], v[46:47] op_sel_hi:[1,1,0] neg_lo:[0,0,1] neg_hi:[0,0,1]
v_pk_fma_f32 v[36:37], v[36:37], s[88:89], v[46:47] op_sel_hi:[1,1,0] neg_lo:[0,0,1] neg_hi:[0,0,1]
v_pk_fma_f32 v[38:39], v[38:39], s[88:89], v[46:47] op_sel_hi:[1,1,0] neg_lo:[0,0,1] neg_hi:[0,0,1]
v_pk_fma_f32 v[40:41], v[40:41], s[88:89], v[46:47] op_sel_hi:[1,1,0] neg_lo:[0,0,1] neg_hi:[0,0,1]
v_pk_fma_f32 v[42:43], v[42:43], s[88:89], v[46:47] op_sel_hi:[1,1,0] neg_lo:[0,0,1] neg_hi:[0,0,1]
v_exp_f32 v36, v36
v_exp_f32 v37, v37
v_exp_f32 v38, v38
v_exp_f32 v39, v39
v_exp_f32 v40, v40
v_exp_f32 v41, v41
v_exp_f32 v42, v42
v_exp_f32 v43, v43
v_exp_f32 v32, v32
v_cvt_pk_bf16_f32 v48, v36, v37
v_cvt_pk_bf16_f32 v49, v38, v39
v_cvt_pk_bf16_f32 v50, v40, v41
v_cvt_pk_bf16_f32 v51, v42, v43
v_exp_f32 v33, v33
v_exp_f32 v34, v34
v_mfma_f32_16x16x32_bf16 v[36:39], v[20:23], v[48:51], 0
v_exp_f32 v35, v35
v_mfma_f32_16x16x32_bf16 v[40:43], v[52:55], v[48:51], 0
v_cvt_pk_bf16_f32 v46, v32, v33
v_cvt_pk_bf16_f32 v47, v34, v35
s_waitcnt lgkmcnt(14)
ds_read_b128 v[152:155], v10 offset:14336
s_waitcnt lgkmcnt(14)
ds_read_b128 v[156:159], v10 offset:15360
s_waitcnt lgkmcnt(14)
ds_read_b128 v[48:51], v10 offset:18432
s_waitcnt lgkmcnt(14)
ds_read_b128 v[52:55], v10 offset:19456
s_waitcnt lgkmcnt(6)
v_mfma_f32_16x16x16_bf16 v[36:39], v[20:21], v[46:47], v[36:39]
v_mfma_f32_16x16x16_bf16 v[40:43], v[44:45], v[46:47], v[40:43]
v_mov_b64 v[120:121], 0
v_mov_b64 v[122:123], 0
v_mov_b64 v[124:125], 0
v_mov_b64 v[126:127], 0
v_mov_b64 v[128:129], 0
v_mov_b64 v[130:131], 0
v_mov_b64 v[132:133], 0
v_rcp_f32 v36, v36
v_mov_b64 v[134:135], 0
v_pk_mul_f32 v[40:41], v[40:41], v[36:37] op_sel_hi:[1,0]
v_pk_mul_f32 v[42:43], v[42:43], v[36:37] op_sel_hi:[1,0]
v_cvt_pk_bf16_f32 v40, v40, v41
v_cvt_pk_bf16_f32 v41, v42, v43
s_mov_b64 exec, s[92:93]
ds_write_b64 v12, v[40:41]
s_mov_b64 exec, -1
v_mov_b64 v[136:137], 0
v_mov_b64 v[138:139], 0
v_mov_b64 v[140:141], 0
v_mov_b64 v[142:143], 0
v_mov_b64 v[144:145], 0
v_mov_b64 v[146:147], 0
v_mov_b64 v[148:149], 0
v_mov_b64 v[150:151], 0
s_cmp_ge_u32 s41, 62
s_cbranch_scc1 L_Rslow_efm_50
L_Rslow_efm_50_r:
s_waitcnt lgkmcnt(0)
s_barrier
ds_read_b128 v[32:35], v13
ds_read_b128 v[36:39], v10 offset:16384
ds_read_b128 v[40:43], v10 offset:17408
s_cmp_ge_u32 s41, 62
s_cbranch_scc1 L_Rslow_efm2_51
L_Rslow_efm2_51_r:
s_waitcnt lgkmcnt(2)
v_smfmac_f32_16x16x64_bf16 v[112:115], v[32:35], v[56:63], v1
v_smfmac_f32_16x16x64_bf16 v[116:119], v[32:35], v[64:71], v1
v_smfmac_f32_16x16x64_bf16 v[120:123], v[32:35], v[72:79], v1
v_smfmac_f32_16x16x64_bf16 v[124:127], v[32:35], v[80:87], v1
v_smfmac_f32_16x16x64_bf16 v[128:131], v[32:35], v[88:95], v1
v_smfmac_f32_16x16x64_bf16 v[132:135], v[32:35], v[96:103], v1
v_smfmac_f32_16x16x64_bf16 v[136:139], v[32:35], v[104:111], v1
v_smfmac_f32_16x16x64_bf16 v[140:143], v[32:35], v[152:159], v1
v_add_u32 v156, s95, v8
v_pk_add_f32 v[112:113], v[112:113], v[114:115]
v_smfmac_f32_16x16x64_bf16 v[148:151], v[32:35], v[48:55], v1
v_pk_add_f32 v[116:117], v[116:117], v[118:119]
s_waitcnt lgkmcnt(0)
v_smfmac_f32_16x16x64_bf16 v[144:147], v[32:35], v[36:43], v1
ds_read_b64_tr_b16 v[152:153], v156
ds_read_b64_tr_b16 v[154:155], v156 offset:512
v_cvt_pk_bf16_f32 v112, v112, v113
v_cvt_pk_bf16_f32 v113, v116, v117
v_and_or_b32 v112, v112, -2, s99
v_pk_add_f32 v[120:121], v[120:121], v[122:123]
v_pk_add_f32 v[124:125], v[124:125], v[126:127]
v_cvt_pk_bf16_f32 v114, v120, v121
v_cvt_pk_bf16_f32 v115, v124, v125
v_and_or_b32 v114, v114, -2, s99
global_store_dwordx4 v2, v[112:115], s[48:49] offset:0 sc1
v_pk_add_f32 v[128:129], v[128:129], v[130:131]
v_pk_add_f32 v[132:133], v[132:133], v[134:135]
v_cvt_pk_bf16_f32 v128, v128, v129
v_cvt_pk_bf16_f32 v129, v132, v133
v_and_or_b32 v128, v128, -2, s99
v_pk_add_f32 v[136:137], v[136:137], v[138:139]
v_pk_add_f32 v[140:141], v[140:141], v[142:143]
v_cvt_pk_bf16_f32 v130, v136, v137
v_cvt_pk_bf16_f32 v131, v140, v141
v_and_or_b32 v130, v130, -2, s99
global_store_dwordx4 v2, v[128:131], s[48:49] offset:1024 sc1
v_pk_add_f32 v[144:145], v[144:145], v[146:147]
v_pk_add_f32 v[148:149], v[148:149], v[150:151]
v_cvt_pk_bf16_f32 v144, v144, v145
v_cvt_pk_bf16_f32 v145, v148, v149
v_and_or_b32 v144, v144, -2, s99
global_store_dwordx2 v3, v[144:145], s[48:49] offset:2048 sc1
s_add_u32 s58, s12, s85
s_addc_u32 s59, s13, 0
s_add_u32 s60, s14, s97
s_addc_u32 s61, s15, 0
s_add_u32 s62, s16, s97
s_addc_u32 s63, s17, 0
s_add_u32 s64, s18, s85
s_addc_u32 s65, s19, 0
s_cmp_eq_u32 s40, 0
s_cbranch_scc1 L_Rslow_nored_52
s_sleep 5
global_load_dwordx4 v[56:59], v18, s[50:51] sc1
global_load_dwordx4 v[60:63], v18, s[52:53] sc1
global_load_dwordx4 v[64:67], v18, s[54:55] sc1
global_load_dwordx4 v[68:71], v18, s[56:57] sc1
s_sleep 3
global_load_dwordx4 v[72:75], v18, s[50:51] sc1
global_load_dwordx4 v[76:79], v18, s[52:53] sc1
global_load_dwordx4 v[80:83], v18, s[54:55] sc1
global_load_dwordx4 v[84:87], v18, s[56:57] sc1
s_waitcnt vmcnt(7)
v_mfma_f32_16x16x32_bf16 v[104:107], v[24:27], v[56:59], 0
v_xor_b32 v108, s99, v56
v_bitop3_b32 v108, v108, v58, s99 bitop3:0xf6
s_waitcnt vmcnt(6)
v_mfma_f32_16x16x32_bf16 v[104:107], v[24:27], v[60:63], v[104:107]
v_bitop3_b32 v108, v108, v60, s99 bitop3:0xf6
v_bitop3_b32 v108, v108, v62, s99 bitop3:0xf6
s_waitcnt vmcnt(5)
v_mfma_f32_16x16x32_bf16 v[104:107], v[24:27], v[64:67], v[104:107]
v_bitop3_b32 v108, v108, v64, s99 bitop3:0xf6
v_bitop3_b32 v108, v108, v66, s99 bitop3:0xf6
s_waitcnt vmcnt(4)
v_mfma_f32_16x16x32_bf16 v[104:107], v[24:27], v[68:71], v[104:107]
v_bitop3_b32 v108, v108, v68, s99 bitop3:0xf6
v_bitop3_b32 v108, v108, v70, s99 bitop3:0xf6
v_and_b32 v108, 1, v108
v_cmp_ne_u32 vcc, 0, v108
s_nop 2
s_cbranch_vccnz L_Rslow_rs1_54
L_Rslow_rok_55:
v_add_f32_dpp v104, v104, v104 row_ror:8 row_mask:0xf bank_mask:0xf
v_add_f32_dpp v105, v105, v105 row_ror:8 row_mask:0xf bank_mask:0xf
v_add_f32_dpp v106, v106, v106 row_ror:8 row_mask:0xf bank_mask:0xf
v_add_f32_dpp v107, v107, v107 row_ror:8 row_mask:0xf bank_mask:0xf
v_cvt_pk_bf16_f32 v112, v104, v105
v_cvt_pk_bf16_f32 v113, v106, v107
s_nop 0
v_permlane16_swap_b32 v112, v114
v_permlane16_swap_b32 v113, v115
v_and_or_b32 v112, v112, -2, s99
v_and_or_b32 v114, v114, -2, s99
s_mov_b64 exec, 0xff
global_store_dwordx4 v2, v[112:115], s[58:59] sc1
global_store_dwordx4 v2, v[112:115], s[60:61] sc1
s_mov_b64 exec, -1
L_Rslow_redj_53:
s_barrier
s_waitcnt lgkmcnt(0)
v_mov_b64 v[156:157], v[44:45]
v_mov_b32 v158, s41
v_mov_b64 v[32:33], 0
v_mov_b64 v[34:35], 0
v_mov_b64 v[36:37], 0
v_mov_b64 v[38:39], 0
v_mov_b64 v[40:41], 0
v_mov_b64 v[42:43], 0
v_mov_b64 v[44:45], 0
v_mov_b64 v[46:47], 0
v_mov_b64 v[48:49], 0
v_mov_b64 v[50:51], 0
s_sleep 6
global_load_dwordx4 v[56:59], v2, s[62:63] sc1
global_load_dwordx4 v[60:63], v2, s[62:63] offset:1024 sc1
global_load_dwordx2 v[64:65], v3, s[62:63] offset:2048 sc1
global_load_dwordx4 v[112:115], v2, s[64:65] sc1
global_load_dwordx4 v[116:119], v2, s[64:65] offset:1024 sc1
global_load_dwordx2 v[120:121], v3, s[64:65] offset:2048 sc1
s_add_u32 s41, s41, 1
s_xor_b32 s96, s96, 655360
s_xor_b32 s97, s97, 20480
s_xor_b32 s85, s85, 65536
s_add_u32 s48, s8, s96
s_addc_u32 s49, s9, 0
s_add_u32 s50, s10, s96
s_addc_u32 s51, s11, 0
s_add_u32 s52, s50, 81920
s_addc_u32 s53, s51, 0
s_add_u32 s54, s52, 81920
s_addc_u32 s55, s53, 0
s_add_u32 s56, s54, 81920
s_addc_u32 s57, s55, 0
s_and_b32 s44, s41, 1
s_lshl_b32 s44, s44, 13
s_add_u32 s44, s44, 141312
v_add_u32 v9, s44, v2
s_xor_b32 s44, s41, 1
s_and_b32 s44, s44, 1
s_lshl_b32 s44, s44, 13
s_add_u32 s44, s44, 141312
s_lshl_b32 s45, s32, 11
s_add_u32 s98, s44, s45
s_cmp_lt_u32 s41, 63
s_cselect_b32 s44, 262144, 0
s_add_u32 s66, s66, s44
s_addc_u32 s67, s67, 0
s_add_u32 s68, s68, 262144
s_addc_u32 s69, s69, 0
s_add_u32 s94, s41, 2
s_min_u32 s94, s94, 64
s_mov_b32 s70, s76
s_mov_b32 s71, s77
s_mov_b32 s72, s78
s_mov_b32 s73, s79
s_add_u32 s76, s76, 131072
s_addc_u32 s77, s77, 0
s_add_u32 s78, s78, 131072
s_addc_u32 s79, s79, 0
s_waitcnt vmcnt(3)
v_xor_b32 v104, s99, v56
v_bitop3_b32 v104, v104, v58, s99 bitop3:0xf6
v_bitop3_b32 v104, v104, v60, s99 bitop3:0xf6
v_bitop3_b32 v104, v104, v62, s99 bitop3:0xf6
v_bitop3_b32 v104, v104, v64, s99 bitop3:0xf6
v_and_b32 v104, 1, v104
v_cmp_ne_u32 vcc, 0, v104
s_nop 2
s_cbranch_vccnz L_Rslow_lre_56
L_Rslow_lok_57:
v_lshlrev_b32 v68, 16, v56
v_and_b32 v69, 0xffff0000, v56
v_lshlrev_b32 v70, 16, v57
v_and_b32 v71, 0xffff0000, v57
v_lshlrev_b32 v72, 16, v58
v_and_b32 v73, 0xffff0000, v58
v_lshlrev_b32 v74, 16, v59
v_and_b32 v75, 0xffff0000, v59
v_lshlrev_b32 v76, 16, v60
v_and_b32 v77, 0xffff0000, v60
v_lshlrev_b32 v78, 16, v61
v_and_b32 v79, 0xffff0000, v61
v_lshlrev_b32 v80, 16, v62
v_and_b32 v81, 0xffff0000, v62
v_lshlrev_b32 v82, 16, v63
v_and_b32 v83, 0xffff0000, v63
v_lshlrev_b32 v84, 16, v64
v_and_b32 v85, 0xffff0000, v64
v_lshlrev_b32 v86, 16, v65
v_and_b32 v87, 0xffff0000, v65
s_waitcnt vmcnt(0)
v_xor_b32 v104, s99, v112
v_bitop3_b32 v104, v104, v114, s99 bitop3:0xf6
v_bitop3_b32 v104, v104, v116, s99 bitop3:0xf6
v_bitop3_b32 v104, v104, v118, s99 bitop3:0xf6
v_bitop3_b32 v104, v104, v120, s99 bitop3:0xf6
v_and_b32 v104, 1, v104
v_cmp_ne_u32 vcc, 0, v104
s_nop 2
s_cbranch_vccnz L_Rslow_gs1_58
L_Rslow_gok_59:
v_dot2_f32_bf16 v68, v112, s90, v68
v_dot2_f32_bf16 v69, v112, s91, v69
v_dot2_f32_bf16 v70, v113, s90, v70
v_dot2_f32_bf16 v71, v113, s91, v71
v_dot2_f32_bf16 v72, v114, s90, v72
v_dot2_f32_bf16 v73, v114, s91, v73
v_dot2_f32_bf16 v74, v115, s90, v74
v_dot2_f32_bf16 v75, v115, s91, v75
v_cvt_pk_bf16_f32 v56, v68, v69
v_cvt_pk_bf16_f32 v57, v70, v71
ds_write_b64 v17, v[56:57] offset:0
v_dot2_f32_bf16 v76, v116, s90, v76
v_dot2_f32_bf16 v77, v116, s91, v77
v_dot2_f32_bf16 v78, v117, s90, v78
v_dot2_f32_bf16 v79, v117, s91, v79
v_cvt_pk_bf16_f32 v58, v72, v73
v_cvt_pk_bf16_f32 v59, v74, v75
ds_write_b64 v17, v[58:59] offset:512
v_dot2_f32_bf16 v80, v118, s90, v80
v_dot2_f32_bf16 v81, v118, s91, v81
v_dot2_f32_bf16 v82, v119, s90, v82
v_dot2_f32_bf16 v83, v119, s91, v83
v_cvt_pk_bf16_f32 v60, v76, v77
v_cvt_pk_bf16_f32 v61, v78, v79
ds_write_b64 v17, v[60:61] offset:1024
v_dot2_f32_bf16 v84, v120, s90, v84
v_dot2_f32_bf16 v85, v120, s91, v85
v_dot2_f32_bf16 v86, v121, s90, v86
v_dot2_f32_bf16 v87, v121, s91, v87
v_cvt_pk_bf16_f32 v62, v80, v81
v_cvt_pk_bf16_f32 v63, v82, v83
ds_write_b64 v17, v[62:63] offset:1536
v_cvt_pk_bf16_f32 v64, v84, v85
v_cvt_pk_bf16_f32 v65, v86, v87
ds_write_b64 v17, v[64:65] offset:2048
s_waitcnt lgkmcnt(0)
s_branch L_Rslow_loop
L_Rslow_finish:
s_waitcnt lgkmcnt(0)
v_add_u32 v60, s95, v8
ds_read_b64_tr_b16 v[56:57], v60
ds_read_b64_tr_b16 v[58:59], v60 offset:512
s_waitcnt lgkmcnt(0)
global_store_dwordx4 v2, v[56:59], s[76:77] sc1
global_store_dwordx2 v3, v[44:45], s[78:79] sc1
s_waitcnt vmcnt(0)
s_barrier
s_cmp_eq_u32 s32, 0
s_cbranch_scc0 L_Rslow_end
s_mov_b64 exec, 1
v_mov_b32 v146, 64
global_store_dword v3, v146, s[100:101] sc1
s_waitcnt vmcnt(0)
L_Rslow_end:
s_endpgm
L_Rslow_fs_47:
s_mov_b32 s74, 0
L_Rslow_fs_47_l:
global_load_dword v0, v19, s[30:31] sc1
s_waitcnt vmcnt(0)
v_cmp_gt_u32 vcc, s94, v0
s_nop 2
s_cbranch_vccz L_Rslow_prime_46
s_sleep 2
s_add_u32 s74, s74, 1
s_cmp_lt_u32 s74, 131072
s_cbranch_scc1 L_Rslow_fs_47_l
s_endpgm
L_Rslow_fs_49:
s_mov_b32 s74, 0
L_Rslow_fs_49_l:
global_load_dword v0, v19, s[30:31] sc1
s_waitcnt vmcnt(0)
v_cmp_gt_u32 vcc, s94, v0
s_nop 2
s_cbranch_vccz L_Rslow_fret_48
s_sleep 2
s_add_u32 s74, s74, 1
s_cmp_lt_u32 s74, 131072
s_cbranch_scc1 L_Rslow_fs_49_l
s_endpgm
L_Rslow_efm_50:
s_waitcnt vmcnt(0)
s_branch L_Rslow_efm_50_r
L_Rslow_efm2_51:
s_mov_b64 exec, 1
v_mov_b32 v46, s41
global_store_dword v3, v46, s[100:101] sc1
s_mov_b64 exec, -1
s_branch L_Rslow_efm2_51_r
L_Rslow_nored_52:
s_branch L_Rslow_redj_53
L_Rslow_rs1_54:
s_mov_b32 s74, 0
L_Rslow_rs1_54_l:
global_load_dwordx4 v[56:59], v18, s[50:51] sc1
global_load_dwordx4 v[60:63], v18, s[52:53] sc1
global_load_dwordx4 v[64:67], v18, s[54:55] sc1
global_load_dwordx4 v[68:71], v18, s[56:57] sc1
s_waitcnt vmcnt(7)
v_mfma_f32_16x16x32_bf16 v[104:107], v[24:27], v[72:75], 0
v_xor_b32 v108, s99, v72
v_bitop3_b32 v108, v108, v74, s99 bitop3:0xf6
s_waitcnt vmcnt(6)
v_mfma_f32_16x16x32_bf16 v[104:107], v[24:27], v[76:79], v[104:107]
v_bitop3_b32 v108, v108, v76, s99 bitop3:0xf6
v_bitop3_b32 v108, v108, v78, s99 bitop3:0xf6
s_waitcnt vmcnt(5)
v_mfma_f32_16x16x32_bf16 v[104:107], v[24:27], v[80:83], v[104:107]
v_bitop3_b32 v108, v108, v80, s99 bitop3:0xf6
v_bitop3_b32 v108, v108, v82, s99 bitop3:0xf6
s_waitcnt vmcnt(4)
v_mfma_f32_16x16x32_bf16 v[104:107], v[24:27], v[84:87], v[104:107]
v_bitop3_b32 v108, v108, v84, s99 bitop3:0xf6
v_bitop3_b32 v108, v108, v86, s99 bitop3:0xf6
v_and_b32 v108, 1, v108
v_cmp_ne_u32 vcc, 0, v108
s_nop 2
s_cbranch_vccnz L_Rslow_rs1_54_n_60
s_nop 7
s_branch L_Rslow_rok_55
L_Rslow_rs1_54_n_60:
global_load_dwordx4 v[72:75], v18, s[50:51] sc1
global_load_dwordx4 v[76:79], v18, s[52:53] sc1
global_load_dwordx4 v[80:83], v18, s[54:55] sc1
global_load_dwordx4 v[84:87], v18, s[56:57] sc1
s_waitcnt vmcnt(7)
v_mfma_f32_16x16x32_bf16 v[104:107], v[24:27], v[56:59], 0
v_xor_b32 v108, s99, v56
v_bitop3_b32 v108, v108, v58, s99 bitop3:0xf6
s_waitcnt vmcnt(6)
v_mfma_f32_16x16x32_bf16 v[104:107], v[24:27], v[60:63], v[104:107]
v_bitop3_b32 v108, v108, v60, s99 bitop3:0xf6
v_bitop3_b32 v108, v108, v62, s99 bitop3:0xf6
s_waitcnt vmcnt(5)
v_mfma_f32_16x16x32_bf16 v[104:107], v[24:27], v[64:67], v[104:107]
v_bitop3_b32 v108, v108, v64, s99 bitop3:0xf6
v_bitop3_b32 v108, v108, v66, s99 bitop3:0xf6
s_waitcnt vmcnt(4)
v_mfma_f32_16x16x32_bf16 v[104:107], v[24:27], v[68:71], v[104:107]
v_bitop3_b32 v108, v108, v68, s99 bitop3:0xf6
v_bitop3_b32 v108, v108, v70, s99 bitop3:0xf6
v_and_b32 v108, 1, v108
v_cmp_ne_u32 vcc, 0, v108
s_nop 2
s_cbranch_vccnz L_Rslow_rs1_54_n_61
s_nop 7
s_branch L_Rslow_rok_55
L_Rslow_rs1_54_n_61:
s_add_u32 s74, s74, 1
s_cmp_lt_u32 s74, 131072
s_cbranch_scc1 L_Rslow_rs1_54_l
s_endpgm
L_Rslow_lre_56:
s_mov_b32 s74, 0
s_or_b32 exec_lo, vcc_lo, 1
s_mov_b32 exec_hi, vcc_hi
global_load_dwordx4 v[56:59], v2, s[62:63] sc1
global_load_dwordx4 v[60:63], v2, s[62:63] offset:1024 sc1
global_load_dwordx2 v[64:65], v3, s[62:63] offset:2048 sc1
L_Rslow_lre_56_l:
global_load_dwordx4 v[56:59], v2, s[62:63] sc1
global_load_dwordx4 v[60:63], v2, s[62:63] offset:1024 sc1
global_load_dwordx2 v[64:65], v3, s[62:63] offset:2048 sc1
s_add_u32 s74, s74, 1
s_waitcnt vmcnt(3)
v_xor_b32 v104, s99, v56
v_bitop3_b32 v104, v104, v58, s99 bitop3:0xf6
v_bitop3_b32 v104, v104, v60, s99 bitop3:0xf6
v_bitop3_b32 v104, v104, v62, s99 bitop3:0xf6
v_bitop3_b32 v104, v104, v64, s99 bitop3:0xf6
v_and_b32 v104, 1, v104
v_cmp_ne_u32 vcc, 0, v104
s_nop 2
s_cbranch_vccz L_Rslow_lre_56_ok
s_or_b32 exec_lo, vcc_lo, 1
s_mov_b32 exec_hi, vcc_hi
s_cmp_lt_u32 s74, 131072
s_cbranch_scc1 L_Rslow_lre_56_l
s_endpgm
L_Rslow_lre_56_ok:
s_mov_b64 exec, -1
s_waitcnt vmcnt(0)
s_branch L_Rslow_lok_57
L_Rslow_gs1_58:
s_mov_b32 s74, 0
s_or_b32 exec_lo, vcc_lo, 1
s_mov_b32 exec_hi, vcc_hi
global_load_dwordx4 v[112:115], v2, s[64:65] sc1
global_load_dwordx4 v[116:119], v2, s[64:65] offset:1024 sc1
global_load_dwordx2 v[120:121], v3, s[64:65] offset:2048 sc1
L_Rslow_gs1_58_l:
global_load_dwordx4 v[112:115], v2, s[64:65] sc1
global_load_dwordx4 v[116:119], v2, s[64:65] offset:1024 sc1
global_load_dwordx2 v[120:121], v3, s[64:65] offset:2048 sc1
s_add_u32 s74, s74, 1
s_waitcnt vmcnt(3)
v_xor_b32 v104, s99, v112
v_bitop3_b32 v104, v104, v114, s99 bitop3:0xf6
v_bitop3_b32 v104, v104, v116, s99 bitop3:0xf6
v_bitop3_b32 v104, v104, v118, s99 bitop3:0xf6
v_bitop3_b32 v104, v104, v120, s99 bitop3:0xf6
v_and_b32 v104, 1, v104
v_cmp_ne_u32 vcc, 0, v104
s_nop 2
s_cbranch_vccz L_Rslow_gs1_58_ok
s_or_b32 exec_lo, vcc_lo, 1
s_mov_b32 exec_hi, vcc_hi
s_cmp_lt_u32 s74, 131072
s_cbranch_scc1 L_Rslow_gs1_58_l
s_endpgm
L_Rslow_gs1_58_ok:
s_mov_b64 exec, -1
s_branch L_Rslow_gok_59
L_A:
s_lshl_b32 s34, s34, 2
s_add_u32 s34, s34, s32
s_lshr_b32 s56, s34, 5
s_and_b32 s34, s34, 31
s_cmp_eq_u32 s32, 0
s_cbranch_scc0 L_wi_A_ok
s_mov_b32 s57, 0
v_and_b32 v8, 63, v0
v_and_b32 v6, 3, v8
v_bfe_u32 v7, v8, 2, 1
v_lshl_add_u32 v6, v7, 5, v6
v_lshlrev_b32 v6, 2, v6
v_cmp_eq_u32 vcc, 8, v8
v_mov_b32 v7, 40
s_nop 0
v_cndmask_b32 v6, v6, v7, vcc
v_cmp_lt_u32 vcc, 8, v8
v_mov_b32 v7, 44
s_nop 0
v_cndmask_b32 v6, v6, v7, vcc
L_wi_A:
global_load_dword v7, v6, s[28:29] sc1
s_waitcnt vmcnt(0)
v_readlane_b32 s58, v7, 0
v_readlane_b32 s59, v7, 1
s_nop 2
s_add_u32 s58, s58, s59
v_readlane_b32 s59, v7, 2
s_nop 2
s_add_u32 s58, s58, s59
v_readlane_b32 s59, v7, 3
s_nop 2
s_add_u32 s58, s58, s59
v_readlane_b32 s59, v7, 4
s_nop 2
s_add_u32 s58, s58, s59
v_readlane_b32 s59, v7, 5
s_nop 2
s_add_u32 s58, s58, s59
v_readlane_b32 s59, v7, 6
s_nop 2
s_add_u32 s58, s58, s59
v_readlane_b32 s59, v7, 7
s_nop 2
s_add_u32 s58, s58, s59
v_readlane_b32 s59, v7, 8
s_nop 2
s_add_u32 s58, s58, s59
s_cmp_ge_u32 s58, 256
s_cbranch_scc1 L_wi_A_ok
s_sleep 32
s_add_u32 s57, s57, 1
s_cmp_lt_u32 s57, 0x20000
s_cbranch_scc1 L_wi_A
s_endpgm
L_wi_A_ok:
s_barrier
v_and_b32 v5, 63, v0
v_lshlrev_b32 v1, 4, v5
v_lshlrev_b32 v2, 3, v5
v_and_b32 v20, 15, v5
v_lshrrev_b32 v21, 2, v20
v_and_b32 v22, 3, v20
v_lshlrev_b32 v23, 12, v21
v_lshl_add_u32 v23, v22, 2, v23
s_lshl_b32 s35, s34, 6
v_add_u32 v23, s35, v23
v_and_b32 v24, 1, v20
v_lshlrev_b32 v24, 6, v24
s_lshl_b32 s35, s34, 7
s_add_u32 s35, s35, 16384
v_add_u32 v24, s35, v24
v_cmp_gt_u32 vcc, 3, v21
s_nop 1
v_cndmask_b32 v3, v24, v23, vcc
v_cmp_le_u32 s[42:43], 3, v21
v_mov_b32 v8, 0x3f803f80
v_mov_b32 v9, 0x3f803f80
v_mov_b32 v10, 0x3f803f80
v_mov_b32 v11, 0x3f803f80
v_lshrrev_b32 v20, 4, v5
v_and_b32 v21, 15, v5
v_mov_b32 v22, 0xff800000
v_mov_b32 v23, 0
v_cmp_gt_u32 vcc, 2, v20
s_nop 1
v_cndmask_b32 v12, v23, v22, vcc
v_cndmask_b32 v13, v23, v22, vcc
v_cndmask_b32 v14, v23, v22, vcc
v_cndmask_b32 v15, v23, v22, vcc
v_lshl_add_u32 v24, v20, 2, 0
v_cmp_gt_u32 vcc, v24, v21
s_nop 1
v_cndmask_b32 v16, v23, v22, vcc
v_lshl_add_u32 v24, v20, 2, 1
v_cmp_gt_u32 vcc, v24, v21
s_nop 1
v_cndmask_b32 v17, v23, v22, vcc
v_lshl_add_u32 v24, v20, 2, 2
v_cmp_gt_u32 vcc, v24, v21
s_nop 1
v_cndmask_b32 v18, v23, v22, vcc
v_lshl_add_u32 v24, v20, 2, 3
v_cmp_gt_u32 vcc, v24, v21
s_nop 1
v_cndmask_b32 v19, v23, v22, vcc
s_mov_b32 s40, 0x3e0293ee
s_mov_b32 s41, s40
s_mov_b32 s36, s56
s_mov_b32 s60, 0
s_mov_b32 s61, 0
v_add_u32 v6, 4096, v1
L_A_loop:
s_lshl_b32 s35, s36, 5
s_add_u32 s35, s35, s34
s_lshl_b32 s39, s35, 13
s_add_u32 s54, s30, 83886080
s_addc_u32 s55, s31, 0
s_add_u32 s54, s54, s39
s_addc_u32 s55, s55, 0
s_lshl_b32 s39, s35, 12
s_add_u32 s50, s30, 67108864
s_addc_u32 s51, s31, 0
s_add_u32 s50, s50, s39
s_addc_u32 s51, s51, 0
s_add_u32 s52, s30, 75497472
s_addc_u32 s53, s31, 0
s_add_u32 s52, s52, s39
s_addc_u32 s53, s53, 0
s_add_u32 s37, s36, 1
s_and_b32 s35, s36, 3
s_lshl_b32 s35, s35, 5
s_add_u32 s35, s35, s34
s_lshl_b32 s35, s35, 6
s_add_u32 s35, s35, 20480
v_mov_b32 v4, s35
s_cmp_eq_u32 s60, 1
s_cbranch_scc1 L_A_pref
s_mov_b32 s38, 0
L_A_wa:
global_load_dword v20, v3, s[30:31] sc1
s_waitcnt vmcnt(0)
v_cmp_gt_u32 vcc, s37, v20
s_nop 2
s_andn2_b64 vcc, vcc, s[42:43]
s_cbranch_vccnz L_A_wa_s_62
s_lshl_b32 s35, s36, 5
s_add_u32 s35, s35, s34
s_lshl_b32 s39, s35, 13
s_add_u32 s44, s30, 16777216
s_addc_u32 s45, s31, 0
s_add_u32 s44, s44, s39
s_addc_u32 s45, s45, 0
s_add_u32 s46, s30, 50331648
s_addc_u32 s47, s31, 0
s_add_u32 s46, s46, s39
s_addc_u32 s47, s47, 0
s_add_u32 s48, s30, 33554432
s_addc_u32 s49, s31, 0
s_add_u32 s48, s48, s39
s_addc_u32 s49, s49, 0
global_load_dwordx4 v[32:35], v1, s[44:45] offset:0 sc1
global_load_dwordx4 v[36:39], v1, s[44:45] offset:1024 sc1
global_load_dwordx4 v[40:43], v1, s[44:45] offset:2048 sc1
global_load_dwordx4 v[44:47], v1, s[44:45] offset:3072 sc1
global_load_dwordx4 v[48:51], v6, s[44:45] offset:0 sc1
global_load_dwordx4 v[52:55], v6, s[44:45] offset:1024 sc1
global_load_dwordx4 v[56:59], v6, s[44:45] offset:2048 sc1
global_load_dwordx4 v[60:63], v6, s[44:45] offset:3072 sc1
global_load_dwordx4 v[64:67], v1, s[46:47] offset:0 sc1
global_load_dwordx4 v[68:71], v1, s[46:47] offset:1024 sc1
global_load_dwordx4 v[72:75], v1, s[46:47] offset:2048 sc1
global_load_dwordx4 v[76:79], v1, s[46:47] offset:3072 sc1
global_load_dwordx4 v[80:83], v6, s[46:47] offset:0 sc1
global_load_dwordx4 v[84:87], v6, s[46:47] offset:1024 sc1
global_load_dwordx4 v[88:91], v6, s[46:47] offset:2048 sc1
global_load_dwordx4 v[92:95], v6, s[46:47] offset:3072 sc1
global_load_dwordx4 v[96:99], v1, s[48:49] offset:0 sc1
global_load_dwordx4 v[100:103], v1, s[48:49] offset:1024 sc1
global_load_dwordx4 v[104:107], v1, s[48:49] offset:2048 sc1
global_load_dwordx4 v[108:111], v1, s[48:49] offset:3072 sc1
global_load_dwordx4 v[112:115], v6, s[48:49] offset:0 sc1
global_load_dwordx4 v[116:119], v6, s[48:49] offset:1024 sc1
global_load_dwordx4 v[120:123], v6, s[48:49] offset:2048 sc1
global_load_dwordx4 v[124:127], v6, s[48:49] offset:3072 sc1
L_A_pref:
s_waitcnt vmcnt(8)
v_mfma_f32_16x16x32_bf16 v[168:171], v[32:35], v[64:67], v[16:19]
v_mfma_f32_16x16x32_bf16 v[172:175], v[32:35], v[68:71], 0
v_mfma_f32_16x16x32_bf16 v[176:179], v[36:39], v[68:71], v[16:19]
v_mfma_f32_16x16x32_bf16 v[168:171], v[40:43], v[72:75], v[168:171]
v_mfma_f32_16x16x32_bf16 v[172:175], v[40:43], v[76:79], v[172:175]
v_mfma_f32_16x16x32_bf16 v[176:179], v[44:47], v[76:79], v[176:179]
v_mfma_f32_16x16x32_bf16 v[168:171], v[48:51], v[80:83], v[168:171]
v_mfma_f32_16x16x32_bf16 v[172:175], v[48:51], v[84:87], v[172:175]
v_mfma_f32_16x16x32_bf16 v[176:179], v[52:55], v[84:87], v[176:179]
v_mfma_f32_16x16x32_bf16 v[168:171], v[56:59], v[88:91], v[168:171]
v_mfma_f32_16x16x32_bf16 v[172:175], v[56:59], v[92:95], v[172:175]
v_mfma_f32_16x16x32_bf16 v[176:179], v[60:63], v[92:95], v[176:179]
s_mov_b32 s38, 0
L_A_wb:
global_load_dword v20, v3, s[30:31] sc1
s_waitcnt vmcnt(0)
v_cmp_gt_u32 vcc, s37, v20
s_nop 2
s_cbranch_vccnz L_A_wb_s_63
v_cmp_gt_u32 vcc, 64, v20
s_nop 2
s_andn2_b64 vcc, vcc, s[42:43]
s_cmp_eq_u64 vcc, 0
s_cselect_b32 s61, 1, 0
global_load_dwordx4 v[128:131], v1, s[50:51] offset:0 sc1
global_load_dwordx4 v[132:135], v1, s[50:51] offset:1024 sc1
global_load_dwordx4 v[136:139], v1, s[50:51] offset:2048 sc1
global_load_dwordx4 v[140:143], v1, s[50:51] offset:3072 sc1
global_load_dwordx2 v[144:145], v2, s[52:53] offset:0 sc1
global_load_dwordx2 v[146:147], v2, s[52:53] offset:512 sc1
global_load_dwordx2 v[148:149], v2, s[52:53] offset:1024 sc1
global_load_dwordx2 v[150:151], v2, s[52:53] offset:1536 sc1
global_load_dwordx2 v[152:153], v2, s[52:53] offset:2048 sc1
global_load_dwordx2 v[154:155], v2, s[52:53] offset:2560 sc1
global_load_dwordx2 v[156:157], v2, s[52:53] offset:3072 sc1
global_load_dwordx2 v[158:159], v2, s[52:53] offset:3584 sc1
s_waitcnt vmcnt(8)
v_mfma_f32_16x16x32_bf16 v[160:163], v[128:131], v[64:67], v[12:15]
v_mfma_f32_16x16x32_bf16 v[164:167], v[128:131], v[68:71], v[12:15]
v_mfma_f32_16x16x32_bf16 v[160:163], v[132:135], v[72:75], v[160:163]
v_mfma_f32_16x16x32_bf16 v[164:167], v[132:135], v[76:79], v[164:167]
v_mfma_f32_16x16x32_bf16 v[160:163], v[136:139], v[80:83], v[160:163]
v_mfma_f32_16x16x32_bf16 v[164:167], v[136:139], v[84:87], v[164:167]
v_mfma_f32_16x16x32_bf16 v[160:163], v[140:143], v[88:91], v[160:163]
v_mfma_f32_16x16x32_bf16 v[164:167], v[140:143], v[92:95], v[164:167]
s_nop 6
v_max3_f32 v20, v160, v161, v162
v_max3_f32 v20, v20, v163, v168
v_max3_f32 v20, v20, v169, v170
v_max_f32 v20, v20, v171
v_mov_b32 v21, v20
s_nop 1
v_permlane32_swap_b32 v20, v21
v_max_f32 v20, v20, v21
v_mov_b32 v21, v20
s_nop 1
v_permlane16_swap_b32 v20, v21
v_max_f32 v20, v20, v21
v_mul_f32 v20, s40, v20
v_fma_f32 v160, v160, s40, -v20
v_fma_f32 v161, v161, s40, -v20
v_fma_f32 v162, v162, s40, -v20
v_fma_f32 v163, v163, s40, -v20
v_fma_f32 v168, v168, s40, -v20
v_fma_f32 v169, v169, s40, -v20
v_fma_f32 v170, v170, s40, -v20
v_fma_f32 v171, v171, s40, -v20
v_exp_f32 v160, v160
v_exp_f32 v161, v161
v_exp_f32 v162, v162
v_exp_f32 v163, v163
v_exp_f32 v168, v168
v_exp_f32 v169, v169
v_exp_f32 v170, v170
v_exp_f32 v171, v171
v_max3_f32 v22, v164, v165, v166
v_max3_f32 v22, v22, v167, v172
v_max3_f32 v22, v22, v173, v174
v_max3_f32 v22, v22, v175, v176
v_max3_f32 v22, v22, v177, v178
v_max_f32 v22, v22, v179
v_mov_b32 v23, v22
s_nop 1
v_permlane32_swap_b32 v22, v23
v_max_f32 v22, v22, v23
v_mov_b32 v23, v22
s_nop 1
v_permlane16_swap_b32 v22, v23
v_max_f32 v22, v22, v23
v_mul_f32 v22, s40, v22
v_fma_f32 v164, v164, s40, -v22
v_fma_f32 v165, v165, s40, -v22
v_fma_f32 v166, v166, s40, -v22
v_fma_f32 v167, v167, s40, -v22
v_fma_f32 v172, v172, s40, -v22
v_fma_f32 v173, v173, s40, -v22
v_fma_f32 v174, v174, s40, -v22
v_fma_f32 v175, v175, s40, -v22
v_fma_f32 v176, v176, s40, -v22
v_fma_f32 v177, v177, s40, -v22
v_fma_f32 v178, v178, s40, -v22
v_fma_f32 v179, v179, s40, -v22
v_exp_f32 v164, v164
v_exp_f32 v165, v165
v_exp_f32 v166, v166
v_exp_f32 v167, v167
v_exp_f32 v172, v172
v_exp_f32 v173, v173
v_exp_f32 v174, v174
v_exp_f32 v175, v175
v_exp_f32 v176, v176
v_exp_f32 v177, v177
v_exp_f32 v178, v178
v_exp_f32 v179, v179
v_cvt_pk_bf16_f32 v40, v160, v161
v_cvt_pk_bf16_f32 v41, v162, v163
v_cvt_pk_bf16_f32 v42, v164, v165
v_cvt_pk_bf16_f32 v43, v166, v167
v_cvt_pk_bf16_f32 v32, v168, v169
v_cvt_pk_bf16_f32 v33, v170, v171
v_mov_b32 v34, 0
v_mov_b32 v35, 0
v_cvt_pk_bf16_f32 v36, v172, v173
v_cvt_pk_bf16_f32 v37, v174, v175
v_cvt_pk_bf16_f32 v38, v176, v177
v_cvt_pk_bf16_f32 v39, v178, v179
s_waitcnt vmcnt(0)
v_mfma_f32_16x16x32_bf16 v[244:247], v[8:11], v[32:35], 0
v_mfma_f32_16x16x32_bf16 v[248:251], v[8:11], v[36:39], 0
v_mfma_f32_16x16x32_bf16 v[180:183], v[96:99], v[32:35], 0
v_mfma_f32_16x16x32_bf16 v[184:187], v[96:99], v[36:39], 0
v_mfma_f32_16x16x32_bf16 v[188:191], v[100:103], v[32:35], 0
v_mfma_f32_16x16x32_bf16 v[192:195], v[100:103], v[36:39], 0
v_mfma_f32_16x16x32_bf16 v[196:199], v[104:107], v[32:35], 0
v_mfma_f32_16x16x32_bf16 v[200:203], v[104:107], v[36:39], 0
v_mfma_f32_16x16x32_bf16 v[204:207], v[108:111], v[32:35], 0
v_mfma_f32_16x16x32_bf16 v[208:211], v[108:111], v[36:39], 0
v_mfma_f32_16x16x32_bf16 v[212:215], v[112:115], v[32:35], 0
v_mfma_f32_16x16x32_bf16 v[216:219], v[112:115], v[36:39], 0
v_mfma_f32_16x16x32_bf16 v[220:223], v[116:119], v[32:35], 0
v_mfma_f32_16x16x32_bf16 v[224:227], v[116:119], v[36:39], 0
v_mfma_f32_16x16x32_bf16 v[228:231], v[120:123], v[32:35], 0
v_mfma_f32_16x16x32_bf16 v[232:235], v[120:123], v[36:39], 0
v_mfma_f32_16x16x32_bf16 v[236:239], v[124:127], v[32:35], 0
v_mfma_f32_16x16x32_bf16 v[240:243], v[124:127], v[36:39], 0
v_mfma_f32_16x16x16_bf16 v[244:247], v[8:9], v[40:41], v[244:247]
v_mfma_f32_16x16x16_bf16 v[248:251], v[8:9], v[42:43], v[248:251]
v_mfma_f32_16x16x16_bf16 v[180:183], v[144:145], v[40:41], v[180:183]
v_mfma_f32_16x16x16_bf16 v[184:187], v[144:145], v[42:43], v[184:187]
v_mfma_f32_16x16x16_bf16 v[188:191], v[146:147], v[40:41], v[188:191]
v_mfma_f32_16x16x16_bf16 v[192:195], v[146:147], v[42:43], v[192:195]
v_mfma_f32_16x16x16_bf16 v[196:199], v[148:149], v[40:41], v[196:199]
v_mfma_f32_16x16x16_bf16 v[200:203], v[148:149], v[42:43], v[200:203]
v_mfma_f32_16x16x16_bf16 v[204:207], v[150:151], v[40:41], v[204:207]
v_mfma_f32_16x16x16_bf16 v[208:211], v[150:151], v[42:43], v[208:211]
v_mfma_f32_16x16x16_bf16 v[212:215], v[152:153], v[40:41], v[212:215]
v_mfma_f32_16x16x16_bf16 v[216:219], v[152:153], v[42:43], v[216:219]
v_mfma_f32_16x16x16_bf16 v[220:223], v[154:155], v[40:41], v[220:223]
v_mfma_f32_16x16x16_bf16 v[224:227], v[154:155], v[42:43], v[224:227]
v_mfma_f32_16x16x16_bf16 v[228:231], v[156:157], v[40:41], v[228:231]
v_mfma_f32_16x16x16_bf16 v[232:235], v[156:157], v[42:43], v[232:235]
v_mfma_f32_16x16x16_bf16 v[236:239], v[158:159], v[40:41], v[236:239]
v_mfma_f32_16x16x16_bf16 v[240:243], v[158:159], v[42:43], v[240:243]
v_rcp_f32 v244, v244
v_rcp_f32 v248, v248
v_pk_mul_f32 v[180:181], v[180:181], v[244:245] op_sel_hi:[1,0]
v_pk_mul_f32 v[182:183], v[182:183], v[244:245] op_sel_hi:[1,0]
v_cvt_pk_bf16_f32 v180, v180, v181
v_cvt_pk_bf16_f32 v181, v182, v183
v_pk_mul_f32 v[184:185], v[184:185], v[248:249] op_sel_hi:[1,0]
v_pk_mul_f32 v[186:187], v[186:187], v[248:249] op_sel_hi:[1,0]
v_cvt_pk_bf16_f32 v182, v184, v185
v_cvt_pk_bf16_f32 v183, v186, v187
s_nop 0
v_permlane16_swap_b32 v180, v182
v_permlane16_swap_b32 v181, v183
global_store_dwordx4 v1, v[180:183], s[54:55] offset:0 sc1
v_pk_mul_f32 v[188:189], v[188:189], v[244:245] op_sel_hi:[1,0]
v_pk_mul_f32 v[190:191], v[190:191], v[244:245] op_sel_hi:[1,0]
v_cvt_pk_bf16_f32 v188, v188, v189
v_cvt_pk_bf16_f32 v189, v190, v191
v_pk_mul_f32 v[192:193], v[192:193], v[248:249] op_sel_hi:[1,0]
v_pk_mul_f32 v[194:195], v[194:195], v[248:249] op_sel_hi:[1,0]
v_cvt_pk_bf16_f32 v190, v192, v193
v_cvt_pk_bf16_f32 v191, v194, v195
s_nop 0
v_permlane16_swap_b32 v188, v190
v_permlane16_swap_b32 v189, v191
global_store_dwordx4 v1, v[188:191], s[54:55] offset:1024 sc1
v_pk_mul_f32 v[196:197], v[196:197], v[244:245] op_sel_hi:[1,0]
v_pk_mul_f32 v[198:199], v[198:199], v[244:245] op_sel_hi:[1,0]
v_cvt_pk_bf16_f32 v196, v196, v197
v_cvt_pk_bf16_f32 v197, v198, v199
v_pk_mul_f32 v[200:201], v[200:201], v[248:249] op_sel_hi:[1,0]
v_pk_mul_f32 v[202:203], v[202:203], v[248:249] op_sel_hi:[1,0]
v_cvt_pk_bf16_f32 v198, v200, v201
v_cvt_pk_bf16_f32 v199, v202, v203
s_nop 0
v_permlane16_swap_b32 v196, v198
v_permlane16_swap_b32 v197, v199
global_store_dwordx4 v1, v[196:199], s[54:55] offset:2048 sc1
v_pk_mul_f32 v[204:205], v[204:205], v[244:245] op_sel_hi:[1,0]
v_pk_mul_f32 v[206:207], v[206:207], v[244:245] op_sel_hi:[1,0]
v_cvt_pk_bf16_f32 v204, v204, v205
v_cvt_pk_bf16_f32 v205, v206, v207
v_pk_mul_f32 v[208:209], v[208:209], v[248:249] op_sel_hi:[1,0]
v_pk_mul_f32 v[210:211], v[210:211], v[248:249] op_sel_hi:[1,0]
v_cvt_pk_bf16_f32 v206, v208, v209
v_cvt_pk_bf16_f32 v207, v210, v211
s_nop 0
v_permlane16_swap_b32 v204, v206
v_permlane16_swap_b32 v205, v207
global_store_dwordx4 v1, v[204:207], s[54:55] offset:3072 sc1
v_pk_mul_f32 v[212:213], v[212:213], v[244:245] op_sel_hi:[1,0]
v_pk_mul_f32 v[214:215], v[214:215], v[244:245] op_sel_hi:[1,0]
v_cvt_pk_bf16_f32 v212, v212, v213
v_cvt_pk_bf16_f32 v213, v214, v215
v_pk_mul_f32 v[216:217], v[216:217], v[248:249] op_sel_hi:[1,0]
v_pk_mul_f32 v[218:219], v[218:219], v[248:249] op_sel_hi:[1,0]
v_cvt_pk_bf16_f32 v214, v216, v217
v_cvt_pk_bf16_f32 v215, v218, v219
s_nop 0
v_permlane16_swap_b32 v212, v214
v_permlane16_swap_b32 v213, v215
global_store_dwordx4 v6, v[212:215], s[54:55] offset:0 sc1
v_pk_mul_f32 v[220:221], v[220:221], v[244:245] op_sel_hi:[1,0]
v_pk_mul_f32 v[222:223], v[222:223], v[244:245] op_sel_hi:[1,0]
v_cvt_pk_bf16_f32 v220, v220, v221
v_cvt_pk_bf16_f32 v221, v222, v223
v_pk_mul_f32 v[224:225], v[224:225], v[248:249] op_sel_hi:[1,0]
v_pk_mul_f32 v[226:227], v[226:227], v[248:249] op_sel_hi:[1,0]
v_cvt_pk_bf16_f32 v222, v224, v225
v_cvt_pk_bf16_f32 v223, v226, v227
s_nop 0
v_permlane16_swap_b32 v220, v222
v_permlane16_swap_b32 v221, v223
global_store_dwordx4 v6, v[220:223], s[54:55] offset:1024 sc1
v_pk_mul_f32 v[228:229], v[228:229], v[244:245] op_sel_hi:[1,0]
v_pk_mul_f32 v[230:231], v[230:231], v[244:245] op_sel_hi:[1,0]
v_cvt_pk_bf16_f32 v228, v228, v229
v_cvt_pk_bf16_f32 v229, v230, v231
v_pk_mul_f32 v[232:233], v[232:233], v[248:249] op_sel_hi:[1,0]
v_pk_mul_f32 v[234:235], v[234:235], v[248:249] op_sel_hi:[1,0]
v_cvt_pk_bf16_f32 v230, v232, v233
v_cvt_pk_bf16_f32 v231, v234, v235
s_nop 0
v_permlane16_swap_b32 v228, v230
v_permlane16_swap_b32 v229, v231
global_store_dwordx4 v6, v[228:231], s[54:55] offset:2048 sc1
v_pk_mul_f32 v[236:237], v[236:237], v[244:245] op_sel_hi:[1,0]
v_pk_mul_f32 v[238:239], v[238:239], v[244:245] op_sel_hi:[1,0]
v_cvt_pk_bf16_f32 v236, v236, v237
v_cvt_pk_bf16_f32 v237, v238, v239
v_pk_mul_f32 v[240:241], v[240:241], v[248:249] op_sel_hi:[1,0]
v_pk_mul_f32 v[242:243], v[242:243], v[248:249] op_sel_hi:[1,0]
v_cvt_pk_bf16_f32 v238, v240, v241
v_cvt_pk_bf16_f32 v239, v242, v243
s_nop 0
v_permlane16_swap_b32 v236, v238
v_permlane16_swap_b32 v237, v239
global_store_dwordx4 v6, v[236:239], s[54:55] offset:3072 sc1
s_add_u32 s62, s36, 2
s_cmp_lt_u32 s62, 64
s_cselect_b32 s60, s61, 0
s_cmp_eq_u32 s60, 1
s_cbranch_scc0 L_A_nopf
s_lshl_b32 s35, s62, 5
s_add_u32 s35, s35, s34
s_lshl_b32 s39, s35, 13
s_add_u32 s44, s30, 16777216
s_addc_u32 s45, s31, 0
s_add_u32 s44, s44, s39
s_addc_u32 s45, s45, 0
s_add_u32 s46, s30, 50331648
s_addc_u32 s47, s31, 0
s_add_u32 s46, s46, s39
s_addc_u32 s47, s47, 0
s_add_u32 s48, s30, 33554432
s_addc_u32 s49, s31, 0
s_add_u32 s48, s48, s39
s_addc_u32 s49, s49, 0
global_load_dwordx4 v[32:35], v1, s[44:45] offset:0 sc1
global_load_dwordx4 v[36:39], v1, s[44:45] offset:1024 sc1
global_load_dwordx4 v[40:43], v1, s[44:45] offset:2048 sc1
global_load_dwordx4 v[44:47], v1, s[44:45] offset:3072 sc1
global_load_dwordx4 v[48:51], v6, s[44:45] offset:0 sc1
global_load_dwordx4 v[52:55], v6, s[44:45] offset:1024 sc1
global_load_dwordx4 v[56:59], v6, s[44:45] offset:2048 sc1
global_load_dwordx4 v[60:63], v6, s[44:45] offset:3072 sc1
global_load_dwordx4 v[64:67], v1, s[46:47] offset:0 sc1
global_load_dwordx4 v[68:71], v1, s[46:47] offset:1024 sc1
global_load_dwordx4 v[72:75], v1, s[46:47] offset:2048 sc1
global_load_dwordx4 v[76:79], v1, s[46:47] offset:3072 sc1
global_load_dwordx4 v[80:83], v6, s[46:47] offset:0 sc1
global_load_dwordx4 v[84:87], v6, s[46:47] offset:1024 sc1
global_load_dwordx4 v[88:91], v6, s[46:47] offset:2048 sc1
global_load_dwordx4 v[92:95], v6, s[46:47] offset:3072 sc1
global_load_dwordx4 v[96:99], v1, s[48:49] offset:0 sc1
global_load_dwordx4 v[100:103], v1, s[48:49] offset:1024 sc1
global_load_dwordx4 v[104:107], v1, s[48:49] offset:2048 sc1
global_load_dwordx4 v[108:111], v1, s[48:49] offset:3072 sc1
global_load_dwordx4 v[112:115], v6, s[48:49] offset:0 sc1
global_load_dwordx4 v[116:119], v6, s[48:49] offset:1024 sc1
global_load_dwordx4 v[120:123], v6, s[48:49] offset:2048 sc1
global_load_dwordx4 v[124:127], v6, s[48:49] offset:3072 sc1
s_waitcnt vmcnt(24)
s_branch L_A_pfd
L_A_nopf:
s_waitcnt vmcnt(0)
L_A_pfd:
s_mov_b64 exec, 1
v_mov_b32 v20, s37
global_store_dword v4, v20, s[30:31] sc1
s_mov_b64 exec, -1
s_add_u32 s36, s36, 2
s_cmp_lt_u32 s36, 64
s_cbranch_scc1 L_A_loop
s_waitcnt vmcnt(0)
s_endpgm
L_A_wa_s_62:
s_sleep 4
s_add_u32 s38, s38, 1
s_cmp_lt_u32 s38, 262144
s_cbranch_scc1 L_A_wa
s_endpgm
L_A_wb_s_63:
s_sleep 1
s_add_u32 s38, s38, 1
s_cmp_lt_u32 s38, 262144
s_cbranch_scc1 L_A_wb
s_endpgm
L_F_main:
s_mov_b32 s39, s35
v_and_b32 v0, 63, v0
s_cmp_eq_u32 s32, 0
s_cbranch_scc0 L_wfk_F_ok
s_mov_b32 s57, 0
v_mov_b32 v2, 0
L_wfk_F:
global_load_dword v3, v2, s[30:31] sc1
s_waitcnt vmcnt(0)
v_readfirstlane_b32 s58, v3
s_nop 2
s_cmp_ge_u32 s58, 1
s_cbranch_scc1 L_wfk_F_ok
s_sleep 16
s_add_u32 s57, s57, 1
s_cmp_lt_u32 s57, 0x4000
s_cbranch_scc1 L_wfk_F
L_wfk_F_ok:
s_barrier
v_lshlrev_b32 v1, 4, v0
v_lshrrev_b32 v2, 2, v0
v_mul_u32_u24 v2, 1280, v2
v_and_b32 v3, 3, v0
v_lshl_add_u32 v2, v3, 4, v2
s_lshl_b32 s40, s34, 6
s_mul_i32 s41, s32, 1310720
s_add_u32 s41, s41, s40
s_add_u32 s44, s18, s41
s_addc_u32 s45, s19, 0
s_mul_i32 s41, s32, 552960
s_add_u32 s41, s41, s40
s_add_u32 s46, s24, s41
s_addc_u32 s47, s25, 0
s_lshl_b32 s41, s32, 13
v_add_u32 v3, s41, v1
v_lshrrev_b32 v4, 5, v0
v_bfe_u32 v5, v0, 2, 2
v_bfe_u32 v6, v0, 4, 1
v_and_b32 v7, 3, v0
v_lshlrev_b32 v9, 5, v6
v_lshl_add_u32 v9, v7, 3, v9
v_lshl_add_u32 v9, v5, 6, v9
v_add_u32 v9, s41, v9
v_lshl_add_u32 v10, v4, 9, v9
v_lshl_add_u32 v11, v4, 8, v9
global_load_dwordx4 v[16:19], v2, s[44:45]
s_add_u32 s44, s44, 20480
s_addc_u32 s45, s45, 0
global_load_dwordx4 v[20:23], v2, s[44:45]
s_add_u32 s44, s44, 20480
s_addc_u32 s45, s45, 0
global_load_dwordx4 v[24:27], v2, s[44:45]
s_add_u32 s44, s44, 20480
s_addc_u32 s45, s45, 0
global_load_dwordx4 v[28:31], v2, s[44:45]
s_add_u32 s44, s44, 20480
s_addc_u32 s45, s45, 0
global_load_dwordx4 v[32:35], v2, s[44:45]
s_add_u32 s44, s44, 20480
s_addc_u32 s45, s45, 0
global_load_dwordx4 v[36:39], v2, s[44:45]
s_add_u32 s44, s44, 20480
s_addc_u32 s45, s45, 0
global_load_dwordx4 v[40:43], v2, s[44:45]
s_add_u32 s44, s44, 20480
s_addc_u32 s45, s45, 0
global_load_dwordx4 v[44:47], v2, s[44:45]
s_add_u32 s44, s44, 20480
s_addc_u32 s45, s45, 0
global_load_dwordx4 v[48:51], v2, s[44:45]
s_add_u32 s44, s44, 20480
s_addc_u32 s45, s45, 0
global_load_dwordx4 v[52:55], v2, s[44:45]
s_add_u32 s44, s44, 20480
s_addc_u32 s45, s45, 0
global_load_dwordx4 v[56:59], v2, s[44:45]
s_add_u32 s44, s44, 20480
s_addc_u32 s45, s45, 0
global_load_dwordx4 v[60:63], v2, s[44:45]
s_add_u32 s44, s44, 20480
s_addc_u32 s45, s45, 0
global_load_dwordx4 v[64:67], v2, s[44:45]
s_add_u32 s44, s44, 20480
s_addc_u32 s45, s45, 0
global_load_dwordx4 v[68:71], v2, s[44:45]
s_add_u32 s44, s44, 20480
s_addc_u32 s45, s45, 0
global_load_dwordx4 v[72:75], v2, s[44:45]
s_add_u32 s44, s44, 20480
s_addc_u32 s45, s45, 0
global_load_dwordx4 v[76:79], v2, s[44:45]
s_add_u32 s44, s44, 20480
s_addc_u32 s45, s45, 0
global_load_dwordx4 v[80:83], v2, s[44:45]
s_add_u32 s44, s44, 20480
s_addc_u32 s45, s45, 0
global_load_dwordx4 v[84:87], v2, s[44:45]
s_add_u32 s44, s44, 20480
s_addc_u32 s45, s45, 0
global_load_dwordx4 v[88:91], v2, s[44:45]
s_add_u32 s44, s44, 20480
s_addc_u32 s45, s45, 0
global_load_dwordx4 v[92:95], v2, s[44:45]
s_add_u32 s44, s44, 20480
s_addc_u32 s45, s45, 0
global_load_dwordx4 v[96:99], v2, s[44:45]
s_add_u32 s44, s44, 20480
s_addc_u32 s45, s45, 0
global_load_dwordx4 v[100:103], v2, s[44:45]
s_add_u32 s44, s44, 20480
s_addc_u32 s45, s45, 0
global_load_dwordx4 v[104:107], v2, s[44:45]
s_add_u32 s44, s44, 20480
s_addc_u32 s45, s45, 0
global_load_dwordx4 v[108:111], v2, s[44:45]
s_add_u32 s44, s44, 20480
s_addc_u32 s45, s45, 0
global_load_dwordx4 v[112:115], v2, s[44:45]
s_add_u32 s44, s44, 20480
s_addc_u32 s45, s45, 0
global_load_dwordx4 v[116:119], v2, s[44:45]
s_add_u32 s44, s44, 20480
s_addc_u32 s45, s45, 0
global_load_dwordx4 v[120:123], v2, s[44:45]
s_add_u32 s44, s44, 20480
s_addc_u32 s45, s45, 0
global_load_dwordx4 v[124:127], v2, s[44:45]
s_add_u32 s44, s44, 20480
s_addc_u32 s45, s45, 0
s_waitcnt vmcnt(24)
ds_write_b128 v3, v[16:19] offset:0
ds_write_b128 v3, v[20:23] offset:1024
ds_write_b128 v3, v[24:27] offset:2048
ds_write_b128 v3, v[28:31] offset:3072
ds_read_b64_tr_b16 a[0:1], v10 offset:0
ds_read_b64_tr_b16 a[2:3], v10 offset:256
ds_read_b64_tr_b16 a[4:5], v10 offset:1024
ds_read_b64_tr_b16 a[6:7], v10 offset:1280
ds_read_b64_tr_b16 a[8:9], v10 offset:2048
ds_read_b64_tr_b16 a[10:11], v10 offset:2304
ds_read_b64_tr_b16 a[12:13], v10 offset:3072
ds_read_b64_tr_b16 a[14:15], v10 offset:3328
s_waitcnt lgkmcnt(0)
global_load_dwordx4 v[128:131], v2, s[44:45]
s_add_u32 s44, s44, 20480
s_addc_u32 s45, s45, 0
global_load_dwordx4 v[132:135], v2, s[44:45]
s_add_u32 s44, s44, 20480
s_addc_u32 s45, s45, 0
global_load_dwordx4 v[136:139], v2, s[44:45]
s_add_u32 s44, s44, 20480
s_addc_u32 s45, s45, 0
global_load_dwordx4 v[140:143], v2, s[44:45]
s_add_u32 s44, s44, 20480
s_addc_u32 s45, s45, 0
s_waitcnt vmcnt(24)
ds_write_b128 v3, v[32:35] offset:4096
ds_write_b128 v3, v[36:39] offset:5120
ds_write_b128 v3, v[40:43] offset:6144
ds_write_b128 v3, v[44:47] offset:7168
ds_read_b64_tr_b16 a[16:17], v10 offset:4096
ds_read_b64_tr_b16 a[18:19], v10 offset:4352
ds_read_b64_tr_b16 a[20:21], v10 offset:5120
ds_read_b64_tr_b16 a[22:23], v10 offset:5376
ds_read_b64_tr_b16 a[24:25], v10 offset:6144
ds_read_b64_tr_b16 a[26:27], v10 offset:6400
ds_read_b64_tr_b16 a[28:29], v10 offset:7168
ds_read_b64_tr_b16 a[30:31], v10 offset:7424
s_waitcnt lgkmcnt(0)
global_load_dwordx4 v[16:19], v2, s[44:45]
s_add_u32 s44, s44, 20480
s_addc_u32 s45, s45, 0
global_load_dwordx4 v[20:23], v2, s[44:45]
s_add_u32 s44, s44, 20480
s_addc_u32 s45, s45, 0
global_load_dwordx4 v[24:27], v2, s[44:45]
s_add_u32 s44, s44, 20480
s_addc_u32 s45, s45, 0
global_load_dwordx4 v[28:31], v2, s[44:45]
s_add_u32 s44, s44, 20480
s_addc_u32 s45, s45, 0
s_waitcnt vmcnt(24)
ds_write_b128 v3, v[48:51] offset:0
ds_write_b128 v3, v[52:55] offset:1024
ds_write_b128 v3, v[56:59] offset:2048
ds_write_b128 v3, v[60:63] offset:3072
ds_read_b64_tr_b16 a[32:33], v10 offset:0
ds_read_b64_tr_b16 a[34:35], v10 offset:256
ds_read_b64_tr_b16 a[36:37], v10 offset:1024
ds_read_b64_tr_b16 a[38:39], v10 offset:1280
ds_read_b64_tr_b16 a[40:41], v10 offset:2048
ds_read_b64_tr_b16 a[42:43], v10 offset:2304
ds_read_b64_tr_b16 a[44:45], v10 offset:3072
ds_read_b64_tr_b16 a[46:47], v10 offset:3328
s_waitcnt lgkmcnt(0)
global_load_dwordx4 v[32:35], v2, s[44:45]
s_add_u32 s44, s44, 20480
s_addc_u32 s45, s45, 0
global_load_dwordx4 v[36:39], v2, s[44:45]
s_add_u32 s44, s44, 20480
s_addc_u32 s45, s45, 0
global_load_dwordx4 v[40:43], v2, s[44:45]
s_add_u32 s44, s44, 20480
s_addc_u32 s45, s45, 0
global_load_dwordx4 v[44:47], v2, s[44:45]
s_add_u32 s44, s44, 20480
s_addc_u32 s45, s45, 0
s_waitcnt vmcnt(24)
ds_write_b128 v3, v[64:67] offset:4096
ds_write_b128 v3, v[68:71] offset:5120
ds_write_b128 v3, v[72:75] offset:6144
ds_write_b128 v3, v[76:79] offset:7168
ds_read_b64_tr_b16 a[48:49], v10 offset:4096
ds_read_b64_tr_b16 a[50:51], v10 offset:4352
ds_read_b64_tr_b16 a[52:53], v10 offset:5120
ds_read_b64_tr_b16 a[54:55], v10 offset:5376
ds_read_b64_tr_b16 a[56:57], v10 offset:6144
ds_read_b64_tr_b16 a[58:59], v10 offset:6400
ds_read_b64_tr_b16 a[60:61], v10 offset:7168
ds_read_b64_tr_b16 a[62:63], v10 offset:7424
s_waitcnt lgkmcnt(0)
global_load_dwordx4 v[48:51], v2, s[44:45]
s_add_u32 s44, s44, 20480
s_addc_u32 s45, s45, 0
global_load_dwordx4 v[52:55], v2, s[44:45]
s_add_u32 s44, s44, 20480
s_addc_u32 s45, s45, 0
global_load_dwordx4 v[56:59], v2, s[44:45]
s_add_u32 s44, s44, 20480
s_addc_u32 s45, s45, 0
global_load_dwordx4 v[60:63], v2, s[44:45]
s_add_u32 s44, s44, 20480
s_addc_u32 s45, s45, 0
s_waitcnt vmcnt(24)
ds_write_b128 v3, v[80:83] offset:0
ds_write_b128 v3, v[84:87] offset:1024
ds_write_b128 v3, v[88:91] offset:2048
ds_write_b128 v3, v[92:95] offset:3072
ds_read_b64_tr_b16 a[64:65], v10 offset:0
ds_read_b64_tr_b16 a[66:67], v10 offset:256
ds_read_b64_tr_b16 a[68:69], v10 offset:1024
ds_read_b64_tr_b16 a[70:71], v10 offset:1280
ds_read_b64_tr_b16 a[72:73], v10 offset:2048
ds_read_b64_tr_b16 a[74:75], v10 offset:2304
ds_read_b64_tr_b16 a[76:77], v10 offset:3072
ds_read_b64_tr_b16 a[78:79], v10 offset:3328
s_waitcnt lgkmcnt(0)
global_load_dwordx4 v[64:67], v2, s[44:45]
s_add_u32 s44, s44, 20480
s_addc_u32 s45, s45, 0
global_load_dwordx4 v[68:71], v2, s[44:45]
s_add_u32 s44, s44, 20480
s_addc_u32 s45, s45, 0
global_load_dwordx4 v[72:75], v2, s[44:45]
s_add_u32 s44, s44, 20480
s_addc_u32 s45, s45, 0
global_load_dwordx4 v[76:79], v2, s[44:45]
s_add_u32 s44, s44, 20480
s_addc_u32 s45, s45, 0
s_waitcnt vmcnt(24)
ds_write_b128 v3, v[96:99] offset:4096
ds_write_b128 v3, v[100:103] offset:5120
ds_write_b128 v3, v[104:107] offset:6144
ds_write_b128 v3, v[108:111] offset:7168
ds_read_b64_tr_b16 a[80:81], v10 offset:4096
ds_read_b64_tr_b16 a[82:83], v10 offset:4352
ds_read_b64_tr_b16 a[84:85], v10 offset:5120
ds_read_b64_tr_b16 a[86:87], v10 offset:5376
ds_read_b64_tr_b16 a[88:89], v10 offset:6144
ds_read_b64_tr_b16 a[90:91], v10 offset:6400
ds_read_b64_tr_b16 a[92:93], v10 offset:7168
ds_read_b64_tr_b16 a[94:95], v10 offset:7424
s_waitcnt lgkmcnt(0)
global_load_dwordx4 v[80:83], v2, s[44:45]
s_add_u32 s44, s44, 20480
s_addc_u32 s45, s45, 0
global_load_dwordx4 v[84:87], v2, s[44:45]
s_add_u32 s44, s44, 20480
s_addc_u32 s45, s45, 0
global_load_dwordx4 v[88:91], v2, s[44:45]
s_add_u32 s44, s44, 20480
s_addc_u32 s45, s45, 0
global_load_dwordx4 v[92:95], v2, s[44:45]
s_add_u32 s44, s44, 20480
s_addc_u32 s45, s45, 0
s_waitcnt vmcnt(24)
ds_write_b128 v3, v[112:115] offset:0
ds_write_b128 v3, v[116:119] offset:1024
ds_write_b128 v3, v[120:123] offset:2048
ds_write_b128 v3, v[124:127] offset:3072
ds_read_b64_tr_b16 a[96:97], v10 offset:0
ds_read_b64_tr_b16 a[98:99], v10 offset:256
ds_read_b64_tr_b16 a[100:101], v10 offset:1024
ds_read_b64_tr_b16 a[102:103], v10 offset:1280
ds_read_b64_tr_b16 a[104:105], v10 offset:2048
ds_read_b64_tr_b16 a[106:107], v10 offset:2304
ds_read_b64_tr_b16 a[108:109], v10 offset:3072
ds_read_b64_tr_b16 a[110:111], v10 offset:3328
s_waitcnt lgkmcnt(0)
global_load_dwordx4 v[96:99], v2, s[44:45]
s_add_u32 s44, s44, 20480
s_addc_u32 s45, s45, 0
global_load_dwordx4 v[100:103], v2, s[44:45]
s_add_u32 s44, s44, 20480
s_addc_u32 s45, s45, 0
global_load_dwordx4 v[104:107], v2, s[44:45]
s_add_u32 s44, s44, 20480
s_addc_u32 s45, s45, 0
global_load_dwordx4 v[108:111], v2, s[44:45]
s_add_u32 s44, s44, 20480
s_addc_u32 s45, s45, 0
s_waitcnt vmcnt(24)
ds_write_b128 v3, v[128:131] offset:4096
ds_write_b128 v3, v[132:135] offset:5120
ds_write_b128 v3, v[136:139] offset:6144
ds_write_b128 v3, v[140:143] offset:7168
ds_read_b64_tr_b16 a[112:113], v10 offset:4096
ds_read_b64_tr_b16 a[114:115], v10 offset:4352
ds_read_b64_tr_b16 a[116:117], v10 offset:5120
ds_read_b64_tr_b16 a[118:119], v10 offset:5376
ds_read_b64_tr_b16 a[120:121], v10 offset:6144
ds_read_b64_tr_b16 a[122:123], v10 offset:6400
ds_read_b64_tr_b16 a[124:125], v10 offset:7168
ds_read_b64_tr_b16 a[126:127], v10 offset:7424
s_waitcnt lgkmcnt(0)
global_load_dwordx4 v[112:115], v2, s[44:45]
s_add_u32 s44, s44, 20480
s_addc_u32 s45, s45, 0
global_load_dwordx4 v[116:119], v2, s[44:45]
s_add_u32 s44, s44, 20480
s_addc_u32 s45, s45, 0
global_load_dwordx4 v[120:123], v2, s[44:45]
s_add_u32 s44, s44, 20480
s_addc_u32 s45, s45, 0
global_load_dwordx4 v[124:127], v2, s[44:45]
s_add_u32 s44, s44, 20480
s_addc_u32 s45, s45, 0
s_waitcnt vmcnt(24)
ds_write_b128 v3, v[16:19] offset:0
ds_write_b128 v3, v[20:23] offset:1024
ds_write_b128 v3, v[24:27] offset:2048
ds_write_b128 v3, v[28:31] offset:3072
ds_read_b64_tr_b16 a[128:129], v10 offset:0
ds_read_b64_tr_b16 a[130:131], v10 offset:256
ds_read_b64_tr_b16 a[132:133], v10 offset:1024
ds_read_b64_tr_b16 a[134:135], v10 offset:1280
ds_read_b64_tr_b16 a[136:137], v10 offset:2048
ds_read_b64_tr_b16 a[138:139], v10 offset:2304
ds_read_b64_tr_b16 a[140:141], v10 offset:3072
ds_read_b64_tr_b16 a[142:143], v10 offset:3328
s_waitcnt lgkmcnt(0)
global_load_dwordx4 v[128:131], v2, s[44:45]
s_add_u32 s44, s44, 20480
s_addc_u32 s45, s45, 0
global_load_dwordx4 v[132:135], v2, s[44:45]
s_add_u32 s44, s44, 20480
s_addc_u32 s45, s45, 0
global_load_dwordx4 v[136:139], v2, s[44:45]
s_add_u32 s44, s44, 20480
s_addc_u32 s45, s45, 0
global_load_dwordx4 v[140:143], v2, s[44:45]
s_add_u32 s44, s44, 20480
s_addc_u32 s45, s45, 0
s_waitcnt vmcnt(24)
ds_write_b128 v3, v[32:35] offset:4096
ds_write_b128 v3, v[36:39] offset:5120
ds_write_b128 v3, v[40:43] offset:6144
ds_write_b128 v3, v[44:47] offset:7168
ds_read_b64_tr_b16 a[144:145], v10 offset:4096
ds_read_b64_tr_b16 a[146:147], v10 offset:4352
ds_read_b64_tr_b16 a[148:149], v10 offset:5120
ds_read_b64_tr_b16 a[150:151], v10 offset:5376
ds_read_b64_tr_b16 a[152:153], v10 offset:6144
ds_read_b64_tr_b16 a[154:155], v10 offset:6400
ds_read_b64_tr_b16 a[156:157], v10 offset:7168
ds_read_b64_tr_b16 a[158:159], v10 offset:7424
s_waitcnt lgkmcnt(0)
global_load_dwordx4 v[16:19], v2, s[46:47]
s_add_u32 s46, s46, 20480
s_addc_u32 s47, s47, 0
global_load_dwordx4 v[20:23], v2, s[46:47]
s_add_u32 s46, s46, 20480
s_addc_u32 s47, s47, 0
global_load_dwordx4 v[24:27], v2, s[46:47]
s_add_u32 s46, s46, 20480
s_addc_u32 s47, s47, 0
global_load_dwordx4 v[28:31], v2, s[46:47]
s_add_u32 s46, s46, 20480
s_addc_u32 s47, s47, 0
s_waitcnt vmcnt(24)
ds_write_b128 v3, v[48:51] offset:0
ds_write_b128 v3, v[52:55] offset:1024
ds_write_b128 v3, v[56:59] offset:2048
ds_write_b128 v3, v[60:63] offset:3072
ds_read_b64_tr_b16 a[160:161], v10 offset:0
ds_read_b64_tr_b16 a[162:163], v10 offset:256
ds_read_b64_tr_b16 a[164:165], v10 offset:1024
ds_read_b64_tr_b16 a[166:167], v10 offset:1280
ds_read_b64_tr_b16 a[168:169], v10 offset:2048
ds_read_b64_tr_b16 a[170:171], v10 offset:2304
ds_read_b64_tr_b16 a[172:173], v10 offset:3072
ds_read_b64_tr_b16 a[174:175], v10 offset:3328
s_waitcnt lgkmcnt(0)
global_load_dwordx4 v[32:35], v2, s[46:47]
s_add_u32 s46, s46, 20480
s_addc_u32 s47, s47, 0
global_load_dwordx4 v[36:39], v2, s[46:47]
s_add_u32 s46, s46, 20480
s_addc_u32 s47, s47, 0
global_load_dwordx4 v[40:43], v2, s[46:47]
s_add_u32 s46, s46, 20480
s_addc_u32 s47, s47, 0
global_load_dwordx4 v[44:47], v2, s[46:47]
s_add_u32 s46, s46, 20480
s_addc_u32 s47, s47, 0
s_waitcnt vmcnt(24)
ds_write_b128 v3, v[64:67] offset:4096
ds_write_b128 v3, v[68:71] offset:5120
ds_write_b128 v3, v[72:75] offset:6144
ds_write_b128 v3, v[76:79] offset:7168
ds_read_b64_tr_b16 a[176:177], v10 offset:4096
ds_read_b64_tr_b16 a[178:179], v10 offset:4352
ds_read_b64_tr_b16 a[180:181], v10 offset:5120
ds_read_b64_tr_b16 a[182:183], v10 offset:5376
ds_read_b64_tr_b16 a[184:185], v10 offset:6144
ds_read_b64_tr_b16 a[186:187], v10 offset:6400
ds_read_b64_tr_b16 a[188:189], v10 offset:7168
ds_read_b64_tr_b16 a[190:191], v10 offset:7424
s_waitcnt lgkmcnt(0)
global_load_dwordx4 v[48:51], v2, s[46:47]
s_add_u32 s46, s46, 20480
s_addc_u32 s47, s47, 0
global_load_dwordx4 v[52:55], v2, s[46:47]
s_add_u32 s46, s46, 20480
s_addc_u32 s47, s47, 0
global_load_dwordx4 v[56:59], v2, s[46:47]
s_add_u32 s46, s46, 20480
s_addc_u32 s47, s47, 0
global_load_dwordx4 v[60:63], v2, s[46:47]
s_add_u32 s46, s46, 20480
s_addc_u32 s47, s47, 0
s_waitcnt vmcnt(24)
ds_write_b128 v3, v[80:83] offset:0
ds_write_b128 v3, v[84:87] offset:1024
ds_write_b128 v3, v[88:91] offset:2048
ds_write_b128 v3, v[92:95] offset:3072
ds_read_b64_tr_b16 a[192:193], v10 offset:0
ds_read_b64_tr_b16 a[194:195], v10 offset:256
ds_read_b64_tr_b16 a[196:197], v10 offset:1024
ds_read_b64_tr_b16 a[198:199], v10 offset:1280
ds_read_b64_tr_b16 a[200:201], v10 offset:2048
ds_read_b64_tr_b16 a[202:203], v10 offset:2304
ds_read_b64_tr_b16 a[204:205], v10 offset:3072
ds_read_b64_tr_b16 a[206:207], v10 offset:3328
s_waitcnt lgkmcnt(0)
global_load_dwordx4 v[64:67], v2, s[46:47]
s_add_u32 s46, s46, 20480
s_addc_u32 s47, s47, 0
global_load_dwordx4 v[68:71], v2, s[46:47]
s_add_u32 s46, s46, 20480
s_addc_u32 s47, s47, 0
global_load_dwordx4 v[72:75], v2, s[46:47]
s_add_u32 s46, s46, 20480
s_addc_u32 s47, s47, 0
global_load_dwordx4 v[76:79], v2, s[46:47]
s_add_u32 s46, s46, 20480
s_addc_u32 s47, s47, 0
s_waitcnt vmcnt(24)
ds_write_b128 v3, v[96:99] offset:4096
ds_write_b128 v3, v[100:103] offset:5120
ds_write_b128 v3, v[104:107] offset:6144
ds_write_b128 v3, v[108:111] offset:7168
ds_read_b64_tr_b16 a[208:209], v10 offset:4096
ds_read_b64_tr_b16 a[210:211], v10 offset:4352
ds_read_b64_tr_b16 a[212:213], v10 offset:5120
ds_read_b64_tr_b16 a[214:215], v10 offset:5376
ds_read_b64_tr_b16 a[216:217], v10 offset:6144
ds_read_b64_tr_b16 a[218:219], v10 offset:6400
ds_read_b64_tr_b16 a[220:221], v10 offset:7168
ds_read_b64_tr_b16 a[222:223], v10 offset:7424
s_waitcnt lgkmcnt(0)
global_load_dwordx4 v[80:83], v2, s[46:47]
s_add_u32 s46, s46, 20480
s_addc_u32 s47, s47, 0
global_load_dwordx4 v[84:87], v2, s[46:47]
s_add_u32 s46, s46, 20480
s_addc_u32 s47, s47, 0
global_load_dwordx4 v[88:91], v2, s[46:47]
s_add_u32 s46, s46, 20480
s_addc_u32 s47, s47, 0
global_load_dwordx4 v[92:95], v2, s[46:47]
s_add_u32 s46, s46, 20480
s_addc_u32 s47, s47, 0
s_waitcnt vmcnt(24)
ds_write_b128 v3, v[112:115] offset:0
ds_write_b128 v3, v[116:119] offset:1024
ds_write_b128 v3, v[120:123] offset:2048
ds_write_b128 v3, v[124:127] offset:3072
ds_read_b64_tr_b16 a[224:225], v10 offset:0
ds_read_b64_tr_b16 a[226:227], v10 offset:256
ds_read_b64_tr_b16 a[228:229], v10 offset:1024
ds_read_b64_tr_b16 a[230:231], v10 offset:1280
ds_read_b64_tr_b16 a[232:233], v10 offset:2048
ds_read_b64_tr_b16 a[234:235], v10 offset:2304
ds_read_b64_tr_b16 a[236:237], v10 offset:3072
ds_read_b64_tr_b16 a[238:239], v10 offset:3328
s_waitcnt lgkmcnt(0)
global_load_dwordx4 v[96:99], v2, s[46:47]
s_add_u32 s46, s46, 20480
s_addc_u32 s47, s47, 0
global_load_dwordx4 v[100:103], v2, s[46:47]
s_add_u32 s46, s46, 20480
s_addc_u32 s47, s47, 0
global_load_dwordx4 v[104:107], v2, s[46:47]
s_add_u32 s46, s46, 20480
s_addc_u32 s47, s47, 0
global_load_dwordx4 v[108:111], v2, s[46:47]
s_add_u32 s46, s46, 20480
s_addc_u32 s47, s47, 0
s_waitcnt vmcnt(24)
ds_write_b128 v3, v[128:131] offset:4096
ds_write_b128 v3, v[132:135] offset:5120
ds_write_b128 v3, v[136:139] offset:6144
ds_write_b128 v3, v[140:143] offset:7168
ds_read_b64_tr_b16 a[240:241], v10 offset:4096
ds_read_b64_tr_b16 a[242:243], v10 offset:4352
ds_read_b64_tr_b16 a[244:245], v10 offset:5120
ds_read_b64_tr_b16 a[246:247], v10 offset:5376
ds_read_b64_tr_b16 a[248:249], v10 offset:6144
ds_read_b64_tr_b16 a[250:251], v10 offset:6400
ds_read_b64_tr_b16 a[252:253], v10 offset:7168
ds_read_b64_tr_b16 a[254:255], v10 offset:7424
s_waitcnt lgkmcnt(0)
global_load_dwordx4 v[112:115], v2, s[46:47]
s_add_u32 s46, s46, 20480
s_addc_u32 s47, s47, 0
global_load_dwordx4 v[116:119], v2, s[46:47]
s_add_u32 s46, s46, 20480
s_addc_u32 s47, s47, 0
global_load_dwordx4 v[120:123], v2, s[46:47]
s_add_u32 s46, s46, 20480
s_addc_u32 s47, s47, 0
s_waitcnt vmcnt(23)
ds_write_b128 v3, v[16:19] offset:0
ds_write_b128 v3, v[20:23] offset:1024
ds_write_b128 v3, v[24:27] offset:2048
ds_write_b128 v3, v[28:31] offset:3072
ds_read_b64_tr_b16 v[148:149], v11 offset:0
ds_read_b64_tr_b16 v[150:151], v11 offset:512
ds_read_b64_tr_b16 v[152:153], v11 offset:1024
ds_read_b64_tr_b16 v[154:155], v11 offset:1536
ds_read_b64_tr_b16 v[156:157], v11 offset:2048
ds_read_b64_tr_b16 v[158:159], v11 offset:2560
ds_read_b64_tr_b16 v[160:161], v11 offset:3072
ds_read_b64_tr_b16 v[162:163], v11 offset:3584
s_waitcnt lgkmcnt(0)
s_waitcnt vmcnt(19)
ds_write_b128 v3, v[32:35] offset:4096
ds_write_b128 v3, v[36:39] offset:5120
ds_write_b128 v3, v[40:43] offset:6144
ds_write_b128 v3, v[44:47] offset:7168
ds_read_b64_tr_b16 v[164:165], v11 offset:4096
ds_read_b64_tr_b16 v[166:167], v11 offset:4608
ds_read_b64_tr_b16 v[168:169], v11 offset:5120
ds_read_b64_tr_b16 v[170:171], v11 offset:5632
ds_read_b64_tr_b16 v[172:173], v11 offset:6144
ds_read_b64_tr_b16 v[174:175], v11 offset:6656
ds_read_b64_tr_b16 v[176:177], v11 offset:7168
ds_read_b64_tr_b16 v[178:179], v11 offset:7680
s_waitcnt lgkmcnt(0)
s_waitcnt vmcnt(15)
ds_write_b128 v3, v[48:51] offset:0
ds_write_b128 v3, v[52:55] offset:1024
ds_write_b128 v3, v[56:59] offset:2048
ds_write_b128 v3, v[60:63] offset:3072
ds_read_b64_tr_b16 v[180:181], v11 offset:0
ds_read_b64_tr_b16 v[182:183], v11 offset:512
ds_read_b64_tr_b16 v[184:185], v11 offset:1024
ds_read_b64_tr_b16 v[186:187], v11 offset:1536
ds_read_b64_tr_b16 v[188:189], v11 offset:2048
ds_read_b64_tr_b16 v[190:191], v11 offset:2560
ds_read_b64_tr_b16 v[192:193], v11 offset:3072
ds_read_b64_tr_b16 v[194:195], v11 offset:3584
s_waitcnt lgkmcnt(0)
s_waitcnt vmcnt(11)
ds_write_b128 v3, v[64:67] offset:4096
ds_write_b128 v3, v[68:71] offset:5120
ds_write_b128 v3, v[72:75] offset:6144
ds_write_b128 v3, v[76:79] offset:7168
ds_read_b64_tr_b16 v[196:197], v11 offset:4096
ds_read_b64_tr_b16 v[198:199], v11 offset:4608
ds_read_b64_tr_b16 v[200:201], v11 offset:5120
ds_read_b64_tr_b16 v[202:203], v11 offset:5632
ds_read_b64_tr_b16 v[204:205], v11 offset:6144
ds_read_b64_tr_b16 v[206:207], v11 offset:6656
ds_read_b64_tr_b16 v[208:209], v11 offset:7168
ds_read_b64_tr_b16 v[210:211], v11 offset:7680
s_waitcnt lgkmcnt(0)
s_waitcnt vmcnt(7)
ds_write_b128 v3, v[80:83] offset:0
ds_write_b128 v3, v[84:87] offset:1024
ds_write_b128 v3, v[88:91] offset:2048
ds_write_b128 v3, v[92:95] offset:3072
ds_read_b64_tr_b16 v[212:213], v11 offset:0
ds_read_b64_tr_b16 v[214:215], v11 offset:512
ds_read_b64_tr_b16 v[216:217], v11 offset:1024
ds_read_b64_tr_b16 v[218:219], v11 offset:1536
ds_read_b64_tr_b16 v[220:221], v11 offset:2048
ds_read_b64_tr_b16 v[222:223], v11 offset:2560
ds_read_b64_tr_b16 v[224:225], v11 offset:3072
ds_read_b64_tr_b16 v[226:227], v11 offset:3584
s_waitcnt lgkmcnt(0)
s_waitcnt vmcnt(3)
ds_write_b128 v3, v[96:99] offset:4096
ds_write_b128 v3, v[100:103] offset:5120
ds_write_b128 v3, v[104:107] offset:6144
ds_write_b128 v3, v[108:111] offset:7168
ds_read_b64_tr_b16 v[228:229], v11 offset:4096
ds_read_b64_tr_b16 v[230:231], v11 offset:4608
ds_read_b64_tr_b16 v[232:233], v11 offset:5120
ds_read_b64_tr_b16 v[234:235], v11 offset:5632
ds_read_b64_tr_b16 v[236:237], v11 offset:6144
ds_read_b64_tr_b16 v[238:239], v11 offset:6656
ds_read_b64_tr_b16 v[240:241], v11 offset:7168
ds_read_b64_tr_b16 v[242:243], v11 offset:7680
s_waitcnt lgkmcnt(0)
s_waitcnt vmcnt(0)
ds_write_b128 v3, v[112:115] offset:0
ds_write_b128 v3, v[116:119] offset:1024
ds_write_b128 v3, v[120:123] offset:2048
ds_read_b64_tr_b16 v[244:245], v11 offset:0
ds_read_b64_tr_b16 v[246:247], v11 offset:512
ds_read_b64_tr_b16 v[248:249], v11 offset:1024
ds_read_b64_tr_b16 v[250:251], v11 offset:1536
ds_read_b64_tr_b16 v[252:253], v11 offset:2048
ds_read_b64_tr_b16 v[254:255], v11 offset:2560
s_waitcnt lgkmcnt(0)
s_barrier
v_and_b32 v2, 7, v0
s_lshl_b32 s40, s32, 3
v_add_u32 v2, s40, v2
v_lshlrev_b32 v2, 6, v2
v_add_u32 v2, 20480, v2
v_min_u32 v136, 55, v0
v_lshrrev_b32 v137, 2, v136
v_and_b32 v136, 3, v136
v_lshlrev_b32 v136, 2, v136
v_lshl_add_u32 v3, v137, 6, v136
v_add_u32 v3, 12288, v3
v_and_b32 v136, 31, v0
v_mul_u32_u24 v136, 1280, v136
v_lshrrev_b32 v137, 5, v0
v_lshl_add_u32 v136, v137, 3, v136
s_lshl_b32 s40, s34, 6
s_lshl_b32 s41, s32, 4
s_add_u32 s40, s40, s41
v_add_u32 v4, s40, v136
s_lshl_b32 s40, s32, 12
v_add_u32 v5, s40, v1
s_lshl_b32 s40, s32, 10
v_add_u32 v6, s40, v1
s_mov_b32 s36, s39
s_mov_b32 s56, 0
s_mov_b32 s57, 0
s_add_u32 s37, s36, 1
s_mov_b32 s38, 0
L_F_wh0:
global_load_dword v136, v3, s[30:31] sc1
s_waitcnt vmcnt(0)
v_cmp_gt_u32 vcc, s37, v136
s_nop 2
s_cbranch_vccnz L_F_wh0_s_64
s_mul_i32 s40, s36, 110592
s_mul_i32 s41, s32, 27648
s_add_u32 s40, s40, s41
s_add_u32 s46, s30, 104857600
s_addc_u32 s47, s31, 0
s_add_u32 s46, s46, s40
s_addc_u32 s47, s47, 0
global_load_dwordx4 v[40:43], v1, s[46:47] offset:0 sc1
global_load_dwordx4 v[44:47], v1, s[46:47] offset:1024 sc1
global_load_dwordx4 v[48:51], v1, s[46:47] offset:2048 sc1
global_load_dwordx4 v[52:55], v1, s[46:47] offset:3072 sc1
s_add_u32 s46, s46, 4096
s_addc_u32 s47, s47, 0
global_load_dwordx4 v[56:59], v1, s[46:47] offset:0 sc1
global_load_dwordx4 v[60:63], v1, s[46:47] offset:1024 sc1
global_load_dwordx4 v[64:67], v1, s[46:47] offset:2048 sc1
global_load_dwordx4 v[68:71], v1, s[46:47] offset:3072 sc1
s_add_u32 s46, s46, 4096
s_addc_u32 s47, s47, 0
global_load_dwordx4 v[72:75], v1, s[46:47] offset:0 sc1
global_load_dwordx4 v[76:79], v1, s[46:47] offset:1024 sc1
global_load_dwordx4 v[80:83], v1, s[46:47] offset:2048 sc1
global_load_dwordx4 v[84:87], v1, s[46:47] offset:3072 sc1
s_add_u32 s46, s46, 4096
s_addc_u32 s47, s47, 0
global_load_dwordx4 v[88:91], v1, s[46:47] offset:0 sc1
global_load_dwordx4 v[92:95], v1, s[46:47] offset:1024 sc1
global_load_dwordx4 v[96:99], v1, s[46:47] offset:2048 sc1
global_load_dwordx4 v[100:103], v1, s[46:47] offset:3072 sc1
s_add_u32 s46, s46, 4096
s_addc_u32 s47, s47, 0
global_load_dwordx4 v[104:107], v1, s[46:47] offset:0 sc1
global_load_dwordx4 v[108:111], v1, s[46:47] offset:1024 sc1
global_load_dwordx4 v[112:115], v1, s[46:47] offset:2048 sc1
global_load_dwordx4 v[116:119], v1, s[46:47] offset:3072 sc1
s_add_u32 s46, s46, 4096
s_addc_u32 s47, s47, 0
global_load_dwordx4 v[120:123], v1, s[46:47] offset:0 sc1
global_load_dwordx4 v[124:127], v1, s[46:47] offset:1024 sc1
global_load_dwordx4 v[128:131], v1, s[46:47] offset:2048 sc1
global_load_dwordx4 v[132:135], v1, s[46:47] offset:3072 sc1
s_add_u32 s46, s46, 4096
s_addc_u32 s47, s47, 0
s_waitcnt vmcnt(23)
v_mfma_f32_32x32x16_bf16 v[24:39], v[148:151], v[40:43], 0
global_load_dwordx4 v[40:43], v1, s[46:47] offset:0 sc1
s_waitcnt vmcnt(23)
v_mfma_f32_32x32x16_bf16 v[24:39], v[152:155], v[44:47], v[24:39]
global_load_dwordx4 v[44:47], v1, s[46:47] offset:1024 sc1
s_waitcnt vmcnt(23)
v_mfma_f32_32x32x16_bf16 v[24:39], v[156:159], v[48:51], v[24:39]
global_load_dwordx4 v[48:51], v1, s[46:47] offset:2048 sc1
s_waitcnt vmcnt(23)
v_mfma_f32_32x32x16_bf16 v[24:39], v[160:163], v[52:55], v[24:39]
s_waitcnt vmcnt(22)
v_mfma_f32_32x32x16_bf16 v[24:39], v[164:167], v[56:59], v[24:39]
s_waitcnt vmcnt(21)
v_mfma_f32_32x32x16_bf16 v[24:39], v[168:171], v[60:63], v[24:39]
s_waitcnt vmcnt(20)
v_mfma_f32_32x32x16_bf16 v[24:39], v[172:175], v[64:67], v[24:39]
s_waitcnt vmcnt(19)
v_mfma_f32_32x32x16_bf16 v[24:39], v[176:179], v[68:71], v[24:39]
s_waitcnt vmcnt(18)
v_mfma_f32_32x32x16_bf16 v[24:39], v[180:183], v[72:75], v[24:39]
s_waitcnt vmcnt(17)
v_mfma_f32_32x32x16_bf16 v[24:39], v[184:187], v[76:79], v[24:39]
s_waitcnt vmcnt(16)
v_mfma_f32_32x32x16_bf16 v[24:39], v[188:191], v[80:83], v[24:39]
s_waitcnt vmcnt(15)
v_mfma_f32_32x32x16_bf16 v[24:39], v[192:195], v[84:87], v[24:39]
s_waitcnt vmcnt(14)
v_mfma_f32_32x32x16_bf16 v[24:39], v[196:199], v[88:91], v[24:39]
s_waitcnt vmcnt(13)
v_mfma_f32_32x32x16_bf16 v[24:39], v[200:203], v[92:95], v[24:39]
s_waitcnt vmcnt(12)
v_mfma_f32_32x32x16_bf16 v[24:39], v[204:207], v[96:99], v[24:39]
s_waitcnt vmcnt(11)
v_mfma_f32_32x32x16_bf16 v[24:39], v[208:211], v[100:103], v[24:39]
s_waitcnt vmcnt(10)
v_mfma_f32_32x32x16_bf16 v[24:39], v[212:215], v[104:107], v[24:39]
s_waitcnt vmcnt(9)
v_mfma_f32_32x32x16_bf16 v[24:39], v[216:219], v[108:111], v[24:39]
s_waitcnt vmcnt(8)
v_mfma_f32_32x32x16_bf16 v[24:39], v[220:223], v[112:115], v[24:39]
s_waitcnt vmcnt(7)
v_mfma_f32_32x32x16_bf16 v[24:39], v[224:227], v[116:119], v[24:39]
s_waitcnt vmcnt(6)
v_mfma_f32_32x32x16_bf16 v[24:39], v[228:231], v[120:123], v[24:39]
s_waitcnt vmcnt(5)
v_mfma_f32_32x32x16_bf16 v[24:39], v[232:235], v[124:127], v[24:39]
s_waitcnt vmcnt(4)
v_mfma_f32_32x32x16_bf16 v[24:39], v[236:239], v[128:131], v[24:39]
s_waitcnt vmcnt(3)
v_mfma_f32_32x32x16_bf16 v[24:39], v[240:243], v[132:135], v[24:39]
s_waitcnt vmcnt(2)
v_mfma_f32_32x32x16_bf16 v[24:39], v[244:247], v[40:43], v[24:39]
s_waitcnt vmcnt(1)
v_mfma_f32_32x32x16_bf16 v[24:39], v[248:251], v[44:47], v[24:39]
s_waitcnt vmcnt(0)
v_mfma_f32_32x32x16_bf16 v[24:39], v[252:255], v[48:51], v[24:39]
L_F_loop:
s_lshl_b32 s40, s36, 18
s_lshl_b32 s41, s32, 16
s_add_u32 s40, s40, s41
s_add_u32 s44, s30, 83886080
s_addc_u32 s45, s31, 0
s_add_u32 s44, s44, s40
s_addc_u32 s45, s45, 0
s_mul_i32 s40, s36, 40960
s_add_u32 s48, s8, s40
s_addc_u32 s49, s9, 0
s_add_u32 s50, s26, s40
s_addc_u32 s51, s27, 0
s_and_b32 s40, s36, 3
s_lshl_b32 s40, s40, 11
s_add_u32 s52, s30, s40
s_addc_u32 s53, s31, 0
s_add_u32 s37, s36, 1
s_add_u32 s54, s36, 3
s_min_u32 s54, s54, 63
s_add_u32 s55, s54, 1
s_cmp_eq_u32 s57, 1
s_cbranch_scc1 L_F_hall
s_mov_b32 s38, 0
L_F_wh:
global_load_dword v136, v3, s[30:31] sc1
s_waitcnt vmcnt(0)
v_cmp_gt_u32 vcc, s55, v136
s_nop 2
s_cbranch_vccnz L_F_wh_s_65
v_cmp_gt_u32 vcc, 64, v136
s_nop 2
s_cmp_eq_u64 vcc, 0
s_cselect_b32 s57, 1, 0
L_F_hall:
s_mul_i32 s40, s54, 110592
s_mul_i32 s41, s32, 27648
s_add_u32 s40, s40, s41
s_add_u32 s46, s30, 104857600
s_addc_u32 s47, s31, 0
s_add_u32 s46, s46, s40
s_addc_u32 s47, s47, 0
s_mov_b32 s38, 0
L_F_wo:
global_load_dword v136, v2, s[52:53] sc1
s_waitcnt vmcnt(0)
v_cmp_gt_u32 vcc, s37, v136
s_nop 2
s_cbranch_vccnz L_F_wo_s_66
global_load_dwordx2 v[138:139], v4, s[48:49]
global_load_dwordx4 v[40:43], v1, s[44:45] offset:0 sc1
global_load_dwordx4 v[44:47], v1, s[44:45] offset:1024 sc1
global_load_dwordx4 v[48:51], v1, s[44:45] offset:2048 sc1
global_load_dwordx4 v[52:55], v1, s[44:45] offset:3072 sc1
s_add_u32 s44, s44, 4096
s_addc_u32 s45, s45, 0
global_load_dwordx4 v[56:59], v1, s[44:45] offset:0 sc1
global_load_dwordx4 v[60:63], v1, s[44:45] offset:1024 sc1
global_load_dwordx4 v[64:67], v1, s[44:45] offset:2048 sc1
global_load_dwordx4 v[68:71], v1, s[44:45] offset:3072 sc1
s_add_u32 s44, s44, 4096
s_addc_u32 s45, s45, 0
global_load_dwordx4 v[72:75], v1, s[44:45] offset:0 sc1
global_load_dwordx4 v[76:79], v1, s[44:45] offset:1024 sc1
global_load_dwordx4 v[80:83], v1, s[44:45] offset:2048 sc1
global_load_dwordx4 v[84:87], v1, s[44:45] offset:3072 sc1
s_add_u32 s44, s44, 4096
s_addc_u32 s45, s45, 0
global_load_dwordx4 v[88:91], v1, s[44:45] offset:0 sc1
global_load_dwordx4 v[92:95], v1, s[44:45] offset:1024 sc1
global_load_dwordx4 v[96:99], v1, s[44:45] offset:2048 sc1
global_load_dwordx4 v[100:103], v1, s[44:45] offset:3072 sc1
s_add_u32 s44, s44, 4096
s_addc_u32 s45, s45, 0
global_load_dwordx4 v[104:107], v1, s[44:45] offset:0 sc1
global_load_dwordx4 v[108:111], v1, s[44:45] offset:1024 sc1
global_load_dwordx4 v[112:115], v1, s[44:45] offset:2048 sc1
global_load_dwordx4 v[116:119], v1, s[44:45] offset:3072 sc1
s_add_u32 s44, s44, 4096
s_addc_u32 s45, s45, 0
global_load_dwordx4 v[120:123], v1, s[44:45] offset:0 sc1
global_load_dwordx4 v[124:127], v1, s[44:45] offset:1024 sc1
global_load_dwordx4 v[128:131], v1, s[44:45] offset:2048 sc1
global_load_dwordx4 v[132:135], v1, s[44:45] offset:3072 sc1
s_add_u32 s44, s44, 4096
s_addc_u32 s45, s45, 0
s_waitcnt vmcnt(23)
v_mfma_f32_32x32x16_bf16 v[8:23], a[0:3], v[40:43], v[24:39]
global_load_dwordx4 v[40:43], v1, s[44:45] offset:0 sc1
s_waitcnt vmcnt(23)
v_mfma_f32_32x32x16_bf16 v[8:23], a[4:7], v[44:47], v[8:23]
global_load_dwordx4 v[44:47], v1, s[44:45] offset:1024 sc1
s_waitcnt vmcnt(23)
v_mfma_f32_32x32x16_bf16 v[8:23], a[8:11], v[48:51], v[8:23]
global_load_dwordx4 v[48:51], v1, s[44:45] offset:2048 sc1
s_waitcnt vmcnt(23)
v_mfma_f32_32x32x16_bf16 v[8:23], a[12:15], v[52:55], v[8:23]
global_load_dwordx4 v[52:55], v1, s[44:45] offset:3072 sc1
s_add_u32 s44, s44, 4096
s_addc_u32 s45, s45, 0
s_waitcnt vmcnt(23)
v_mfma_f32_32x32x16_bf16 v[8:23], a[16:19], v[56:59], v[8:23]
global_load_dwordx4 v[56:59], v1, s[44:45] offset:0 sc1
s_waitcnt vmcnt(23)
v_mfma_f32_32x32x16_bf16 v[8:23], a[20:23], v[60:63], v[8:23]
global_load_dwordx4 v[60:63], v1, s[44:45] offset:1024 sc1
s_waitcnt vmcnt(23)
v_mfma_f32_32x32x16_bf16 v[8:23], a[24:27], v[64:67], v[8:23]
global_load_dwordx4 v[64:67], v1, s[44:45] offset:2048 sc1
s_waitcnt vmcnt(23)
v_mfma_f32_32x32x16_bf16 v[8:23], a[28:31], v[68:71], v[8:23]
global_load_dwordx4 v[68:71], v1, s[44:45] offset:3072 sc1
s_add_u32 s44, s44, 4096
s_addc_u32 s45, s45, 0
s_waitcnt vmcnt(23)
v_mfma_f32_32x32x16_bf16 v[8:23], a[32:35], v[72:75], v[8:23]
global_load_dwordx4 v[72:75], v1, s[44:45] offset:0 sc1
s_waitcnt vmcnt(23)
v_mfma_f32_32x32x16_bf16 v[8:23], a[36:39], v[76:79], v[8:23]
global_load_dwordx4 v[76:79], v1, s[44:45] offset:1024 sc1
s_waitcnt vmcnt(23)
v_mfma_f32_32x32x16_bf16 v[8:23], a[40:43], v[80:83], v[8:23]
global_load_dwordx4 v[80:83], v1, s[44:45] offset:2048 sc1
s_waitcnt vmcnt(23)
v_mfma_f32_32x32x16_bf16 v[8:23], a[44:47], v[84:87], v[8:23]
global_load_dwordx4 v[84:87], v1, s[44:45] offset:3072 sc1
s_add_u32 s44, s44, 4096
s_addc_u32 s45, s45, 0
s_waitcnt vmcnt(23)
v_mfma_f32_32x32x16_bf16 v[8:23], a[48:51], v[88:91], v[8:23]
global_load_dwordx4 v[88:91], v1, s[44:45] offset:0 sc1
s_waitcnt vmcnt(23)
v_mfma_f32_32x32x16_bf16 v[8:23], a[52:55], v[92:95], v[8:23]
global_load_dwordx4 v[92:95], v1, s[44:45] offset:1024 sc1
s_waitcnt vmcnt(23)
v_mfma_f32_32x32x16_bf16 v[8:23], a[56:59], v[96:99], v[8:23]
global_load_dwordx4 v[96:99], v1, s[44:45] offset:2048 sc1
s_waitcnt vmcnt(23)
v_mfma_f32_32x32x16_bf16 v[8:23], a[60:63], v[100:103], v[8:23]
global_load_dwordx4 v[100:103], v1, s[44:45] offset:3072 sc1
s_add_u32 s44, s44, 4096
s_addc_u32 s45, s45, 0
s_waitcnt vmcnt(23)
v_mfma_f32_32x32x16_bf16 v[8:23], a[64:67], v[104:107], v[8:23]
global_load_dwordx4 v[104:107], v1, s[44:45] offset:0 sc1
s_waitcnt vmcnt(23)
v_mfma_f32_32x32x16_bf16 v[8:23], a[68:71], v[108:111], v[8:23]
global_load_dwordx4 v[108:111], v1, s[44:45] offset:1024 sc1
s_waitcnt vmcnt(23)
v_mfma_f32_32x32x16_bf16 v[8:23], a[72:75], v[112:115], v[8:23]
global_load_dwordx4 v[112:115], v1, s[44:45] offset:2048 sc1
s_waitcnt vmcnt(23)
v_mfma_f32_32x32x16_bf16 v[8:23], a[76:79], v[116:119], v[8:23]
global_load_dwordx4 v[116:119], v1, s[44:45] offset:3072 sc1
s_add_u32 s44, s44, 4096
s_addc_u32 s45, s45, 0
s_waitcnt vmcnt(23)
v_mfma_f32_32x32x16_bf16 v[8:23], a[80:83], v[120:123], v[8:23]
global_load_dwordx4 v[120:123], v1, s[44:45] offset:0 sc1
s_waitcnt vmcnt(23)
v_mfma_f32_32x32x16_bf16 v[8:23], a[84:87], v[124:127], v[8:23]
global_load_dwordx4 v[124:127], v1, s[44:45] offset:1024 sc1
s_waitcnt vmcnt(23)
v_mfma_f32_32x32x16_bf16 v[8:23], a[88:91], v[128:131], v[8:23]
global_load_dwordx4 v[128:131], v1, s[44:45] offset:2048 sc1
s_waitcnt vmcnt(23)
v_mfma_f32_32x32x16_bf16 v[8:23], a[92:95], v[132:135], v[8:23]
global_load_dwordx4 v[132:135], v1, s[44:45] offset:3072 sc1
s_add_u32 s44, s44, 4096
s_addc_u32 s45, s45, 0
s_waitcnt vmcnt(23)
v_mfma_f32_32x32x16_bf16 v[8:23], a[96:99], v[40:43], v[8:23]
global_load_dwordx4 v[40:43], v1, s[44:45] offset:0 sc1
s_waitcnt vmcnt(23)
v_mfma_f32_32x32x16_bf16 v[8:23], a[100:103], v[44:47], v[8:23]
global_load_dwordx4 v[44:47], v1, s[44:45] offset:1024 sc1
s_waitcnt vmcnt(23)
v_mfma_f32_32x32x16_bf16 v[8:23], a[104:107], v[48:51], v[8:23]
global_load_dwordx4 v[48:51], v1, s[44:45] offset:2048 sc1
s_waitcnt vmcnt(23)
v_mfma_f32_32x32x16_bf16 v[8:23], a[108:111], v[52:55], v[8:23]
global_load_dwordx4 v[52:55], v1, s[44:45] offset:3072 sc1
s_add_u32 s44, s44, 4096
s_addc_u32 s45, s45, 0
s_waitcnt vmcnt(23)
v_mfma_f32_32x32x16_bf16 v[8:23], a[112:115], v[56:59], v[8:23]
global_load_dwordx4 v[56:59], v1, s[44:45] offset:0 sc1
s_waitcnt vmcnt(23)
v_mfma_f32_32x32x16_bf16 v[8:23], a[116:119], v[60:63], v[8:23]
global_load_dwordx4 v[60:63], v1, s[44:45] offset:1024 sc1
s_waitcnt vmcnt(23)
v_mfma_f32_32x32x16_bf16 v[8:23], a[120:123], v[64:67], v[8:23]
global_load_dwordx4 v[64:67], v1, s[44:45] offset:2048 sc1
s_waitcnt vmcnt(23)
v_mfma_f32_32x32x16_bf16 v[8:23], a[124:127], v[68:71], v[8:23]
global_load_dwordx4 v[68:71], v1, s[44:45] offset:3072 sc1
s_add_u32 s44, s44, 4096
s_addc_u32 s45, s45, 0
s_waitcnt vmcnt(23)
v_mfma_f32_32x32x16_bf16 v[8:23], a[128:131], v[72:75], v[8:23]
global_load_dwordx4 v[72:75], v1, s[44:45] offset:0 sc1
s_waitcnt vmcnt(23)
v_mfma_f32_32x32x16_bf16 v[8:23], a[132:135], v[76:79], v[8:23]
global_load_dwordx4 v[76:79], v1, s[44:45] offset:1024 sc1
s_waitcnt vmcnt(23)
v_mfma_f32_32x32x16_bf16 v[8:23], a[136:139], v[80:83], v[8:23]
global_load_dwordx4 v[80:83], v1, s[44:45] offset:2048 sc1
s_waitcnt vmcnt(23)
v_mfma_f32_32x32x16_bf16 v[8:23], a[140:143], v[84:87], v[8:23]
global_load_dwordx4 v[84:87], v1, s[44:45] offset:3072 sc1
s_add_u32 s44, s44, 4096
s_addc_u32 s45, s45, 0
s_waitcnt vmcnt(23)
v_mfma_f32_32x32x16_bf16 v[8:23], a[144:147], v[88:91], v[8:23]
global_load_dwordx4 v[88:91], v1, s[44:45] offset:0 sc1
s_waitcnt vmcnt(23)
v_mfma_f32_32x32x16_bf16 v[8:23], a[148:151], v[92:95], v[8:23]
global_load_dwordx4 v[92:95], v1, s[44:45] offset:1024 sc1
s_waitcnt vmcnt(23)
v_mfma_f32_32x32x16_bf16 v[8:23], a[152:155], v[96:99], v[8:23]
global_load_dwordx4 v[96:99], v1, s[44:45] offset:2048 sc1
s_waitcnt vmcnt(23)
v_mfma_f32_32x32x16_bf16 v[8:23], a[156:159], v[100:103], v[8:23]
global_load_dwordx4 v[100:103], v1, s[44:45] offset:3072 sc1
s_add_u32 s44, s44, 4096
s_addc_u32 s45, s45, 0
s_waitcnt vmcnt(23)
v_mfma_f32_32x32x16_bf16 v[8:23], a[160:163], v[104:107], v[8:23]
global_load_dwordx4 v[104:107], v1, s[46:47] offset:0 sc1
s_waitcnt vmcnt(23)
v_mfma_f32_32x32x16_bf16 v[8:23], a[164:167], v[108:111], v[8:23]
global_load_dwordx4 v[108:111], v1, s[46:47] offset:1024 sc1
s_waitcnt vmcnt(23)
v_mfma_f32_32x32x16_bf16 v[8:23], a[168:171], v[112:115], v[8:23]
global_load_dwordx4 v[112:115], v1, s[46:47] offset:2048 sc1
s_waitcnt vmcnt(23)
v_mfma_f32_32x32x16_bf16 v[8:23], a[172:175], v[116:119], v[8:23]
global_load_dwordx4 v[116:119], v1, s[46:47] offset:3072 sc1
s_add_u32 s46, s46, 4096
s_addc_u32 s47, s47, 0
s_waitcnt vmcnt(23)
v_mfma_f32_32x32x16_bf16 v[8:23], a[176:179], v[120:123], v[8:23]
global_load_dwordx4 v[120:123], v1, s[46:47] offset:0 sc1
s_waitcnt vmcnt(23)
v_mfma_f32_32x32x16_bf16 v[8:23], a[180:183], v[124:127], v[8:23]
global_load_dwordx4 v[124:127], v1, s[46:47] offset:1024 sc1
s_waitcnt vmcnt(23)
v_mfma_f32_32x32x16_bf16 v[8:23], a[184:187], v[128:131], v[8:23]
global_load_dwordx4 v[128:131], v1, s[46:47] offset:2048 sc1
s_waitcnt vmcnt(23)
v_mfma_f32_32x32x16_bf16 v[8:23], a[188:191], v[132:135], v[8:23]
global_load_dwordx4 v[132:135], v1, s[46:47] offset:3072 sc1
s_add_u32 s46, s46, 4096
s_addc_u32 s47, s47, 0
s_waitcnt vmcnt(23)
v_mfma_f32_32x32x16_bf16 v[8:23], a[192:195], v[40:43], v[8:23]
global_load_dwordx4 v[40:43], v1, s[46:47] offset:0 sc1
s_waitcnt vmcnt(23)
v_mfma_f32_32x32x16_bf16 v[8:23], a[196:199], v[44:47], v[8:23]
global_load_dwordx4 v[44:47], v1, s[46:47] offset:1024 sc1
s_waitcnt vmcnt(23)
v_mfma_f32_32x32x16_bf16 v[8:23], a[200:203], v[48:51], v[8:23]
global_load_dwordx4 v[48:51], v1, s[46:47] offset:2048 sc1
s_waitcnt vmcnt(23)
v_mfma_f32_32x32x16_bf16 v[8:23], a[204:207], v[52:55], v[8:23]
global_load_dwordx4 v[52:55], v1, s[46:47] offset:3072 sc1
s_add_u32 s46, s46, 4096
s_addc_u32 s47, s47, 0
s_waitcnt vmcnt(23)
v_mfma_f32_32x32x16_bf16 v[8:23], a[208:211], v[56:59], v[8:23]
global_load_dwordx4 v[56:59], v1, s[46:47] offset:0 sc1
s_waitcnt vmcnt(23)
v_mfma_f32_32x32x16_bf16 v[8:23], a[212:215], v[60:63], v[8:23]
global_load_dwordx4 v[60:63], v1, s[46:47] offset:1024 sc1
s_waitcnt vmcnt(23)
v_mfma_f32_32x32x16_bf16 v[8:23], a[216:219], v[64:67], v[8:23]
global_load_dwordx4 v[64:67], v1, s[46:47] offset:2048 sc1
s_waitcnt vmcnt(23)
v_mfma_f32_32x32x16_bf16 v[8:23], a[220:223], v[68:71], v[8:23]
global_load_dwordx4 v[68:71], v1, s[46:47] offset:3072 sc1
s_add_u32 s46, s46, 4096
s_addc_u32 s47, s47, 0
s_waitcnt vmcnt(23)
v_mfma_f32_32x32x16_bf16 v[8:23], a[224:227], v[72:75], v[8:23]
global_load_dwordx4 v[72:75], v1, s[46:47] offset:0 sc1
s_waitcnt vmcnt(23)
v_mfma_f32_32x32x16_bf16 v[8:23], a[228:231], v[76:79], v[8:23]
global_load_dwordx4 v[76:79], v1, s[46:47] offset:1024 sc1
s_waitcnt vmcnt(23)
v_mfma_f32_32x32x16_bf16 v[8:23], a[232:235], v[80:83], v[8:23]
global_load_dwordx4 v[80:83], v1, s[46:47] offset:2048 sc1
s_waitcnt vmcnt(23)
v_mfma_f32_32x32x16_bf16 v[8:23], a[236:239], v[84:87], v[8:23]
global_load_dwordx4 v[84:87], v1, s[46:47] offset:3072 sc1
s_add_u32 s46, s46, 4096
s_addc_u32 s47, s47, 0
s_waitcnt vmcnt(23)
v_mfma_f32_32x32x16_bf16 v[8:23], a[240:243], v[88:91], v[8:23]
global_load_dwordx4 v[88:91], v1, s[46:47] offset:0 sc1
s_waitcnt vmcnt(23)
v_mfma_f32_32x32x16_bf16 v[8:23], a[244:247], v[92:95], v[8:23]
global_load_dwordx4 v[92:95], v1, s[46:47] offset:1024 sc1
s_waitcnt vmcnt(23)
v_mfma_f32_32x32x16_bf16 v[8:23], a[248:251], v[96:99], v[8:23]
global_load_dwordx4 v[96:99], v1, s[46:47] offset:2048 sc1
s_waitcnt vmcnt(23)
v_mfma_f32_32x32x16_bf16 v[8:23], a[252:255], v[100:103], v[8:23]
global_load_dwordx4 v[100:103], v1, s[46:47] offset:3072 sc1
s_add_u32 s46, s46, 4096
s_addc_u32 s47, s47, 0
s_xor_b32 s56, s56, 16384
s_add_u32 s40, s56, 32768
v_add_u32 v140, s40, v5
v_add_u32 v141, s40, v6
s_nop 4
ds_write_b128 v140, v[8:11] offset:0
ds_write_b128 v140, v[12:15] offset:1024
ds_write_b128 v140, v[16:19] offset:2048
ds_write_b128 v140, v[20:23] offset:3072
s_waitcnt lgkmcnt(0)
s_barrier
ds_read_b128 v[8:11], v141 offset:0
ds_read_b128 v[12:15], v141 offset:4096
ds_read_b128 v[16:19], v141 offset:8192
ds_read_b128 v[20:23], v141 offset:12288
s_waitcnt lgkmcnt(0)
v_add_f32 v8, v8, v12
v_add_f32 v16, v16, v20
v_add_f32 v9, v9, v13
v_add_f32 v17, v17, v21
v_add_f32 v10, v10, v14
v_add_f32 v18, v18, v22
v_add_f32 v11, v11, v15
v_add_f32 v19, v19, v23
v_add_f32 v8, v8, v16
v_add_f32 v9, v9, v17
v_add_f32 v10, v10, v18
v_add_f32 v11, v11, v19
v_lshlrev_b32 v12, 16, v138
v_and_b32 v13, 0xffff0000, v138
v_lshlrev_b32 v14, 16, v139
v_and_b32 v15, 0xffff0000, v139
v_add_f32 v8, v8, v12
v_add_f32 v9, v9, v13
v_add_f32 v10, v10, v14
v_add_f32 v11, v11, v15
v_cvt_pk_bf16_f32 v142, v8, v9
v_cvt_pk_bf16_f32 v143, v10, v11
global_store_dwordx2 v4, v[142:143], s[50:51]
s_cmp_ge_u32 s36, 61
s_cbranch_scc1 L_F_done
s_waitcnt vmcnt(24)
v_mfma_f32_32x32x16_bf16 v[24:39], v[148:151], v[104:107], 0
global_load_dwordx4 v[104:107], v1, s[46:47] offset:0 sc1
s_waitcnt vmcnt(24)
v_mfma_f32_32x32x16_bf16 v[24:39], v[152:155], v[108:111], v[24:39]
global_load_dwordx4 v[108:111], v1, s[46:47] offset:1024 sc1
s_waitcnt vmcnt(24)
v_mfma_f32_32x32x16_bf16 v[24:39], v[156:159], v[112:115], v[24:39]
global_load_dwordx4 v[112:115], v1, s[46:47] offset:2048 sc1
s_waitcnt vmcnt(24)
v_mfma_f32_32x32x16_bf16 v[24:39], v[160:163], v[116:119], v[24:39]
s_waitcnt vmcnt(23)
v_mfma_f32_32x32x16_bf16 v[24:39], v[164:167], v[120:123], v[24:39]
s_waitcnt vmcnt(22)
v_mfma_f32_32x32x16_bf16 v[24:39], v[168:171], v[124:127], v[24:39]
s_waitcnt vmcnt(21)
v_mfma_f32_32x32x16_bf16 v[24:39], v[172:175], v[128:131], v[24:39]
s_waitcnt vmcnt(20)
v_mfma_f32_32x32x16_bf16 v[24:39], v[176:179], v[132:135], v[24:39]
s_waitcnt vmcnt(19)
v_mfma_f32_32x32x16_bf16 v[24:39], v[180:183], v[40:43], v[24:39]
s_waitcnt vmcnt(18)
v_mfma_f32_32x32x16_bf16 v[24:39], v[184:187], v[44:47], v[24:39]
s_waitcnt vmcnt(17)
v_mfma_f32_32x32x16_bf16 v[24:39], v[188:191], v[48:51], v[24:39]
s_waitcnt vmcnt(16)
v_mfma_f32_32x32x16_bf16 v[24:39], v[192:195], v[52:55], v[24:39]
s_waitcnt vmcnt(15)
v_mfma_f32_32x32x16_bf16 v[24:39], v[196:199], v[56:59], v[24:39]
s_waitcnt vmcnt(14)
v_mfma_f32_32x32x16_bf16 v[24:39], v[200:203], v[60:63], v[24:39]
s_waitcnt vmcnt(13)
v_mfma_f32_32x32x16_bf16 v[24:39], v[204:207], v[64:67], v[24:39]
s_waitcnt vmcnt(12)
v_mfma_f32_32x32x16_bf16 v[24:39], v[208:211], v[68:71], v[24:39]
s_waitcnt vmcnt(11)
v_mfma_f32_32x32x16_bf16 v[24:39], v[212:215], v[72:75], v[24:39]
s_waitcnt vmcnt(10)
v_mfma_f32_32x32x16_bf16 v[24:39], v[216:219], v[76:79], v[24:39]
s_waitcnt vmcnt(9)
v_mfma_f32_32x32x16_bf16 v[24:39], v[220:223], v[80:83], v[24:39]
s_waitcnt vmcnt(8)
v_mfma_f32_32x32x16_bf16 v[24:39], v[224:227], v[84:87], v[24:39]
s_waitcnt vmcnt(7)
v_mfma_f32_32x32x16_bf16 v[24:39], v[228:231], v[88:91], v[24:39]
s_waitcnt vmcnt(6)
v_mfma_f32_32x32x16_bf16 v[24:39], v[232:235], v[92:95], v[24:39]
s_waitcnt vmcnt(5)
v_mfma_f32_32x32x16_bf16 v[24:39], v[236:239], v[96:99], v[24:39]
s_waitcnt vmcnt(4)
v_mfma_f32_32x32x16_bf16 v[24:39], v[240:243], v[100:103], v[24:39]
s_waitcnt vmcnt(2)
v_mfma_f32_32x32x16_bf16 v[24:39], v[244:247], v[104:107], v[24:39]
s_waitcnt vmcnt(1)
v_mfma_f32_32x32x16_bf16 v[24:39], v[248:251], v[108:111], v[24:39]
s_waitcnt vmcnt(0)
v_mfma_f32_32x32x16_bf16 v[24:39], v[252:255], v[112:115], v[24:39]
s_add_u32 s36, s36, 3
s_cmp_lt_u32 s36, 64
s_cbranch_scc1 L_F_loop
L_F_done:
s_waitcnt vmcnt(0)
s_endpgm
L_F_wh0_s_64:
s_sleep 4
s_add_u32 s38, s38, 1
s_cmp_lt_u32 s38, 262144
s_cbranch_scc1 L_F_wh0
s_endpgm
L_F_wh_s_65:
s_sleep 4
s_add_u32 s38, s38, 1
s_cmp_lt_u32 s38, 262144
s_cbranch_scc1 L_F_wh
s_endpgm
L_F_wo_s_66:
s_sleep 1
s_add_u32 s38, s38, 1
s_cmp_lt_u32 s38, 262144
s_cbranch_scc1 L_F_wo
s_endpgm
.section .rodata,"a"
.p2align 6
.amdhsa_kernel parallel_sum__memory_aug_recurrent_mem_tr__dense_activation_mish__prompt_kernel
  .amdhsa_next_free_vgpr 512
  .amdhsa_next_free_sgpr 102
  .amdhsa_accum_offset 256
  .amdhsa_group_segment_fixed_size 0
  .amdhsa_kernarg_size 112
  .amdhsa_user_sgpr_count 2
  .amdhsa_user_sgpr_kernarg_segment_ptr 1
  .amdhsa_system_sgpr_workgroup_id_x 1
.end_amdhsa_kernel
```
